```python
import torch

def _softmax(x, axis=-1):
    return torch.softmax(x, dim=axis)

def _gelu(x):
    return torch.nn.functional.gelu(x, approximate='tanh')

def _silu(x):
    return torch.nn.functional.silu(x)

def _sigmoid(x):
    return torch.sigmoid(x)

def _layernorm(x, axis=-1, eps=1e-05):
    m = x.mean(dim=axis, keepdim=True)
    v = x.var(dim=axis, keepdim=True, unbiased=False)
    return (x - m) / torch.sqrt(v + eps)

def _scatter_add(tgt, idx, src, axis=0):
    return tgt.clone().index_add_(axis, idx, src)

def _segment_sum(src, seg, n):
    out = torch.zeros((n,) + src.shape[1:], dtype=src.dtype)
    return out.index_add_(0, seg, src)

def _pad(x, pw):
    flat = tuple((v for pair in reversed(pw) for v in pair))
    return torch.nn.functional.pad(x, flat)
kernel_name = 'interleave_layers__memory_aug_recurrent_mem_tr__swiglu_ffn__prompt'

def setup_inputs():

    _w = lambda a: (lambda t: t.to(torch.bfloat16) if t.is_floating_point() else t)(torch.as_tensor(a))

    def _A_setup():
        B, S, Dm = (1, 2048, 448)
        H, Dh = (16, 256)
        M, seg = (8, 32)
        seg = min(seg, S)
        S = S // seg * seg
        return {'x': _w((lambda *s: torch.randn(*s, dtype=torch.bfloat16) * 0.05)(B, S, Dm)), 'mem0': _w((lambda *s: torch.randn(*s, dtype=torch.bfloat16) * 0.8)(B, M, Dm)), 'Wq': _w((lambda *s: torch.randn(*s, dtype=torch.bfloat16) * 1.6)(Dm, H, Dh) * Dm ** (-0.5)), 'Wk': _w((lambda *s: torch.randn(*s, dtype=torch.bfloat16) * 1.6)(Dm, H, Dh) * Dm ** (-0.5)), 'Wv': _w((lambda *s: torch.randn(*s, dtype=torch.bfloat16) * 0.8)(Dm, H, Dh) * Dm ** (-0.5)), 'Wo': _w((lambda *s: torch.randn(*s, dtype=torch.bfloat16) * 0.8)(H, Dh, Dm) * (H * Dh) ** (-0.5)), 'seg_len': seg}
    _A_in = _A_setup()

    def _B_setup():
        B, S, D, F = (1, 2048, 448, 1792)
        return {'x': _w((lambda *s: torch.randn(*s, dtype=torch.bfloat16) * 0.05)(B, S, D)), 'w_gate': _w((lambda *s: torch.randn(*s, dtype=torch.bfloat16) * 0.05)(D, F)), 'w_up': _w((lambda *s: torch.randn(*s, dtype=torch.bfloat16) * 0.05)(D, F)), 'w_down': _w((lambda *s: torch.randn(*s, dtype=torch.bfloat16) * 0.05)(F, D))}
    _B_in = _B_setup()
    return {'A_x': _A_in['x'], 'A_mem0': _A_in['mem0'], 'A_Wq': _A_in['Wq'], 'A_Wk': _A_in['Wk'], 'A_Wv': _A_in['Wv'], 'A_Wo': _A_in['Wo'], 'A_seg_len': _A_in['seg_len'], 'B_x': _B_in['x'], 'B_w_gate': _B_in['w_gate'], 'B_w_up': _B_in['w_up'], 'B_w_down': _B_in['w_down']}

def reference(A_x, A_mem0, A_Wq, A_Wk, A_Wv, A_Wo, A_seg_len, B_x, B_w_gate, B_w_up, B_w_down):

    def _A_ref(x, mem0, Wq, Wk, Wv, Wo, seg_len):
        B, S, Dm = x.shape
        H, Dh = (Wq.shape[1], Wq.shape[2])
        M = mem0.shape[1]
        scale = Dh ** (-0.5)
        n_seg = S // seg_len
        L = M + seg_len
        idx = torch.arange(L)
        mask = (idx[:, None] < M) | (idx[:, None] >= idx[None, :])
        mem = mem0
        outs = []
        for s in range(n_seg):
            xs = x[:, s * seg_len:(s + 1) * seg_len, :].clone()
            h = torch.concatenate([mem, xs], axis=1)
            q = torch.einsum('btd,dhe->bhte', h, Wq)
            k = torch.einsum('btd,dhe->bhte', h, Wk)
            v = torch.einsum('btd,dhe->bhte', h, Wv)
            scores = torch.einsum('bhqe,bhke->bhqk', q, k) * scale
            scores = torch.where(mask[None, None], scores, -1000000000.0)
            p = _softmax(scores, axis=-1)
            o = torch.einsum('bhqk,bhke->bhqe', p, v)
            o = torch.einsum('bhte,hed->btd', o, Wo)
            mem = o[:, :M, :].clone()
            outs.append(o[:, M:, :])
        return torch.concatenate(outs, axis=1)

    def _B_ref(x, w_gate, w_up, w_down):
        g = _silu(x @ w_gate)
        u = x @ w_up
        return g * u @ w_down
    x = A_x
    x = x + _A_ref(_layernorm(x, axis=-1), A_mem0, A_Wq, A_Wk, A_Wv, A_Wo, A_seg_len)
    x = x + _B_ref(_layernorm(x, axis=-1), B_w_gate, B_w_up, B_w_down)
    x = x + _A_ref(_layernorm(x, axis=-1), A_mem0, A_Wq, A_Wk, A_Wv, A_Wo, A_seg_len)
    x = x + _B_ref(_layernorm(x, axis=-1), B_w_gate, B_w_up, B_w_down)
    return x
```

```asm
; @launch grid=(256,1,1) block=(256,1,1) lds=135168
.amdgcn_target "amdgcn-amd-amdhsa--gfx950"
.text
.globl interleave_layers__memory_aug_recurrent_mem_tr__swiglu_ffn__prompt_kernel
.p2align 8
.type interleave_layers__memory_aug_recurrent_mem_tr__swiglu_ffn__prompt_kernel,@function
interleave_layers__memory_aug_recurrent_mem_tr__swiglu_ffn__prompt_kernel:
s_cmp_ge_u32 s2, 256
s_cbranch_scc1 L_done
s_load_dwordx4 s[36:39], s[0:1], 0
s_load_dwordx8 s[40:47], s[0:1], 16
s_load_dwordx4 s[4:7], s[0:1], 96
v_lshrrev_b32 v1, 6, v0
s_nop 0
v_readfirstlane_b32 s32, v1
v_and_b32 v0, 63, v0
v_lshlrev_b32 v1, 4, v0
s_and_b32 s3, s2, 7
s_lshl_b32 s3, s3, 5
s_lshr_b32 s33, s2, 3
s_add_u32 s3, s3, s33
s_lshr_b32 s33, s3, 7
s_bfe_u32 s34, s3, 0x40003
s_and_b32 s35, s3, 3
s_bfe_u32 s48, s3, 0x10002
s_waitcnt lgkmcnt(0)
s_mov_b32 s8, s6
s_mov_b32 s9, s7
s_mov_b32 s10, 268435456
s_mov_b32 s11, 0x20000
s_mov_b32 s12, s36
s_mov_b32 s13, s37
s_mov_b32 s14, 1835008
s_mov_b32 s15, 0x20000
s_mov_b32 s16, s38
s_mov_b32 s17, s39
s_mov_b32 s18, 7168
s_mov_b32 s19, 0x20000
s_cmp_eq_u32 s33, 0
s_cselect_b32 s20, s40, s44
s_cselect_b32 s21, s41, s45
s_cselect_b32 s24, s42, s46
s_cselect_b32 s25, s43, s47
s_mov_b32 s22, 3670016
s_mov_b32 s23, 0x20000
s_mov_b32 s26, 3670016
s_mov_b32 s27, 0x20000
v_lshrrev_b32 v2, 3, v0
s_and_b32 s49, s32, 1
s_lshr_b32 s50, s32, 1
v_lshl_add_u32 v3, s49, 3, v2
v_lshrrev_b32 v4, 2, v3
v_lshlrev_b32 v4, 3, v4
v_and_b32 v5, 3, v3
v_add_u32 v4, v4, v5
v_lshrrev_b32 v5, 1, v3
v_and_b32 v6, 7, v0
v_xor_b32 v5, v5, v6
v_lshlrev_b32 v5, 4, v5
v_lshl_add_u32 v10, v4, 13, v5
s_mul_i32 s51, s48, 224
s_lshl2_add_u32 s51, s50, s51
s_lshl_b32 s51, s51, 13
s_lshl_b32 s52, s34, 9
s_add_u32 s51, s51, s52
v_lshrrev_b32 v6, 4, v0
v_and_b32 v7, 15, v0
v_lshlrev_b32 v8, 2, v6
v_xor_b32 v7, v7, v8
v_mul_u32_u24 v11, 896, v6
v_lshl_add_u32 v11, v7, 4, v11
s_mul_i32 s53, s35, 7
s_lshr_b32 s54, s53, 1
s_lshl_b32 s54, s54, 6
s_mul_i32 s55, s34, 229376
s_add_u32 s54, s54, s55
s_mul_i32 s55, s32, 3584
s_add_u32 s54, s54, s55
s_lshl_b32 s57, s32, 10
s_add_u32 s58, s50, 0
s_min_u32 s58, s58, 6
s_add_u32 s58, s58, s53
s_lshr_b32 s59, s58, 1
s_lshl_b32 s59, s59, 5
s_and_b32 s58, s58, 1
s_lshl2_add_u32 s59, s58, s59
s_lshl_b32 s59, s59, 13
s_add_u32 s59, s59, s52
s_add_u32 s58, s54, 0
s_cmp_eq_u32 s33, 0
s_cselect_b32 s100, s59, s58
s_add_u32 s58, s50, 2
s_min_u32 s58, s58, 6
s_add_u32 s58, s58, s53
s_lshr_b32 s59, s58, 1
s_lshl_b32 s59, s59, 5
s_and_b32 s58, s58, 1
s_lshl2_add_u32 s59, s58, s59
s_lshl_b32 s59, s59, 13
s_add_u32 s59, s59, s52
s_add_u32 s58, s54, 14336
s_cmp_eq_u32 s33, 0
s_cselect_b32 s101, s59, s58
s_add_u32 s58, s50, 4
s_min_u32 s58, s58, 6
s_add_u32 s58, s58, s53
s_lshr_b32 s59, s58, 1
s_lshl_b32 s59, s59, 5
s_and_b32 s58, s58, 1
s_lshl2_add_u32 s59, s58, s59
s_lshl_b32 s59, s59, 13
s_add_u32 s59, s59, s52
s_add_u32 s58, s54, 28672
s_cmp_eq_u32 s33, 0
s_cselect_b32 s86, s59, s58
s_add_u32 s58, s50, 6
s_min_u32 s58, s58, 6
s_add_u32 s58, s58, s53
s_lshr_b32 s59, s58, 1
s_lshl_b32 s59, s59, 5
s_and_b32 s58, s58, 1
s_lshl2_add_u32 s59, s58, s59
s_lshl_b32 s59, s59, 13
s_add_u32 s59, s59, s52
s_add_u32 s58, s54, 43008
s_cmp_eq_u32 s33, 0
s_cselect_b32 s87, s59, s58
s_movk_i32 s85, 128
s_cselect_b32 s85, s85, 57344
s_cselect_b64 vcc, -1, 0
v_cndmask_b32 v11, v11, v10, vcc
v_mov_b32 v248, -1
v_mov_b32 v252, 0
v_mov_b32 v249, -1
v_mov_b32 v253, 0
v_mov_b32 v250, -1
v_mov_b32 v254, 0
v_mov_b32 v251, -1
v_mov_b32 v255, 0
s_lshl2_add_u32 s68, s2, s32
s_add_u32 s69, s68, 0
s_cmp_ge_u32 s69, 1216
s_cbranch_scc1 Lf_1
s_cmp_lt_u32 s69, 7
s_cbranch_scc1 Lf_1
s_sub_u32 s79, s69, 160
s_cmp_lt_u32 s79, 7
s_cbranch_scc1 Lf_1
s_lshl_b32 s69, s69, 10
s_add_u32 s69, s69, 117178368
buffer_store_dwordx4 v[248:251], v1, s[8:11], s69 offen sc1
Lf_1:
s_add_u32 s69, s68, 1024
s_cmp_ge_u32 s69, 1216
s_cbranch_scc1 Lf_2
s_cmp_lt_u32 s69, 7
s_cbranch_scc1 Lf_2
s_sub_u32 s79, s69, 160
s_cmp_lt_u32 s79, 7
s_cbranch_scc1 Lf_2
s_lshl_b32 s69, s69, 10
s_add_u32 s69, s69, 117178368
buffer_store_dwordx4 v[248:251], v1, s[8:11], s69 offen sc1
Lf_2:
s_cmp_ge_u32 s68, 144
s_cbranch_scc1 Lf_3
s_lshl_b32 s69, s68, 10
s_add_u32 s69, s69, 118423552
buffer_store_dwordx4 v[252:255], v1, s[8:11], s69 offen sc1
Lf_3:
s_lshl_b32 s78, s3, 7
s_add_u32 s78, s78, 118571008
s_cmp_eq_u32 s32, 0
s_cselect_b32 s88, s78, 0x7ff00000
buffer_store_dword v252, off, s[8:11], s88 sc1
v_and_b32 v2, 15, v0
v_lshrrev_b32 v3, 4, v0
v_mul_u32_u24 v12, 896, v2
v_lshl_add_u32 v12, v3, 4, v12
v_lshlrev_b32 v13, 3, v2
s_lshr_b32 s60, s2, 1
s_and_b32 s61, s2, 1
s_mul_i32 s61, s61, 7
s_add_u32 s62, s61, s32
s_add_u32 s63, s32, 4
s_min_u32 s63, s63, 6
s_add_u32 s63, s63, s61
s_mul_i32 s64, s60, 14336
s_lshl_b32 s65, s62, 6
s_add_u32 s65, s65, s64
buffer_load_dwordx4 v[228:231], v12, s[12:15], s65 offen
s_lshl_b32 s65, s63, 6
s_add_u32 s65, s65, s64
buffer_load_dwordx4 v[232:235], v12, s[12:15], s65 offen
v_and_b32 v4, 7, v0
v_mul_u32_u24 v14, 896, v4
v_lshl_add_u32 v14, v3, 5, v14
v_bfe_u32 v4, v0, 3, 1
v_lshl_add_u32 v14, v4, 2, v14
s_min_u32 s66, s60, 6
s_lshl_b32 s67, s66, 7
buffer_load_dword v236, v14, s[16:19], s67 offen offset:0
buffer_load_dword v237, v14, s[16:19], s67 offen offset:8
buffer_load_dword v238, v14, s[16:19], s67 offen offset:16
buffer_load_dword v239, v14, s[16:19], s67 offen offset:24
s_add_u32 m0, s57, 0
s_add_u32 s56, s51, 0
buffer_load_dwordx4 v10, s[20:23], s56 offen lds
s_add_u32 m0, s57, 4096
s_add_u32 s56, s51, 262144
buffer_load_dwordx4 v10, s[20:23], s56 offen lds
s_add_u32 m0, s57, 8192
s_add_u32 s56, s51, 524288
buffer_load_dwordx4 v10, s[20:23], s56 offen lds
s_add_u32 m0, s57, 12288
s_add_u32 s56, s51, 786432
buffer_load_dwordx4 v10, s[20:23], s56 offen lds
s_add_u32 m0, s57, 16384
s_add_u32 s56, s51, 1048576
buffer_load_dwordx4 v10, s[20:23], s56 offen lds
s_add_u32 m0, s57, 20480
s_add_u32 s56, s51, 1310720
buffer_load_dwordx4 v10, s[20:23], s56 offen lds
s_add_u32 m0, s57, 24576
s_add_u32 s56, s51, 1572864
buffer_load_dwordx4 v10, s[20:23], s56 offen lds
s_add_u32 m0, s57, 28672
s_mul_i32 s84, s85, 0
s_add_u32 s56, s100, s84
buffer_load_dwordx4 v11, s[24:27], s56 offen lds
s_add_u32 m0, s57, 32768
s_add_u32 s56, s101, s84
buffer_load_dwordx4 v11, s[24:27], s56 offen lds
s_add_u32 m0, s57, 36864
s_add_u32 s56, s86, s84
buffer_load_dwordx4 v11, s[24:27], s56 offen lds
s_add_u32 m0, s57, 40960
s_add_u32 s56, s87, s84
buffer_load_dwordx4 v11, s[24:27], s56 offen lds
s_waitcnt vmcnt(17)
s_barrier
s_mov_b32 s28, s4
s_mov_b32 s29, s5
s_mov_b32 s30, 256
s_mov_b32 s31, 0x20000
s_getreg_b32 s89, hwreg(HW_REG_XCC_ID)
s_and_b32 s89, s89, 7
s_lshl_b32 s69, s89, 5
s_cmp_eq_u32 s32, 0
s_cselect_b32 s69, s69, 0x7ff00000
v_mov_b32 v227, 1
s_mov_b64 exec, 1
buffer_atomic_add v227, off, s[28:31], s69 sc0 sc1
s_mov_b64 exec, -1
s_add_u32 m0, s57, 45056
s_add_u32 s56, s51, 128
buffer_load_dwordx4 v10, s[20:23], s56 offen lds
s_add_u32 m0, s57, 49152
s_add_u32 s56, s51, 262272
buffer_load_dwordx4 v10, s[20:23], s56 offen lds
s_add_u32 m0, s57, 53248
s_add_u32 s56, s51, 524416
buffer_load_dwordx4 v10, s[20:23], s56 offen lds
s_add_u32 m0, s57, 57344
s_add_u32 s56, s51, 786560
buffer_load_dwordx4 v10, s[20:23], s56 offen lds
s_add_u32 m0, s57, 61440
s_add_u32 s56, s51, 1048704
buffer_load_dwordx4 v10, s[20:23], s56 offen lds
s_add_u32 m0, s57, 65536
s_add_u32 s56, s51, 1310848
buffer_load_dwordx4 v10, s[20:23], s56 offen lds
s_add_u32 m0, s57, 69632
s_add_u32 s56, s51, 1572992
buffer_load_dwordx4 v10, s[20:23], s56 offen lds
s_add_u32 m0, s57, 73728
s_mul_i32 s84, s85, 1
s_add_u32 s56, s100, s84
buffer_load_dwordx4 v11, s[24:27], s56 offen lds
s_add_u32 m0, s57, 77824
s_add_u32 s56, s101, s84
buffer_load_dwordx4 v11, s[24:27], s56 offen lds
s_add_u32 m0, s57, 81920
s_add_u32 s56, s86, s84
buffer_load_dwordx4 v11, s[24:27], s56 offen lds
s_add_u32 m0, s57, 86016
s_add_u32 s56, s87, s84
buffer_load_dwordx4 v11, s[24:27], s56 offen lds
v_and_b32 v2, 15, v0
v_lshrrev_b32 v3, 4, v0
v_lshrrev_b32 v4, 1, v2
v_xor_b32 v5, v3, v4
v_lshlrev_b32 v5, 4, v5
v_lshl_add_u32 v5, v2, 7, v5
v_xor_b32 v6, 64, v5
s_lshl_b32 s69, s32, 13
v_add_u32 v7, s69, v5
v_add_u32 v8, s69, v6
s_cmp_eq_u32 s32, 3
s_cselect_b32 s70, 0, 4096
v_add_u32 v60, s70, v7
v_add_u32 v61, s70, v8
v_bfe_u32 v4, v0, 2, 2
v_lshl_add_u32 v9, v3, 3, v4
v_lshlrev_b32 v9, 8, v9
v_and_b32 v62, 3, v0
v_lshl_add_u32 v9, v62, 4, v9
v_lshlrev_b32 v63, 6, v4
s_and_b32 s71, s53, 1
s_add_u32 s72, s71, 0
s_lshr_b32 s73, s72, 1
s_lshl_b32 s73, s73, 6
s_and_b32 s72, s72, 1
s_lshl_b32 s72, s72, 3
v_xor_b32 v220, s73, v63
v_add3_u32 v220, v220, v9, s72
s_add_u32 s72, s71, 1
s_lshr_b32 s73, s72, 1
s_lshl_b32 s73, s73, 6
s_and_b32 s72, s72, 1
s_lshl_b32 s72, s72, 3
v_xor_b32 v221, s73, v63
v_add3_u32 v221, v221, v9, s72
s_add_u32 s72, s71, 2
s_lshr_b32 s73, s72, 1
s_lshl_b32 s73, s73, 6
s_and_b32 s72, s72, 1
s_lshl_b32 s72, s72, 3
v_xor_b32 v222, s73, v63
v_add3_u32 v222, v222, v9, s72
s_add_u32 s72, s71, 3
s_lshr_b32 s73, s72, 1
s_lshl_b32 s73, s73, 6
s_and_b32 s72, s72, 1
s_lshl_b32 s72, s72, 3
v_xor_b32 v223, s73, v63
v_add3_u32 v223, v223, v9, s72
s_add_u32 s72, s71, 4
s_lshr_b32 s73, s72, 1
s_lshl_b32 s73, s73, 6
s_and_b32 s72, s72, 1
s_lshl_b32 s72, s72, 3
v_xor_b32 v224, s73, v63
v_add3_u32 v224, v224, v9, s72
s_add_u32 s72, s71, 5
s_lshr_b32 s73, s72, 1
s_lshl_b32 s73, s73, 6
s_and_b32 s72, s72, 1
s_lshl_b32 s72, s72, 3
v_xor_b32 v225, s73, v63
v_add3_u32 v225, v225, v9, s72
s_add_u32 s72, s71, 6
s_lshr_b32 s73, s72, 1
s_lshl_b32 s73, s73, 6
s_and_b32 s72, s72, 1
s_lshl_b32 s72, s72, 3
v_xor_b32 v226, s73, v63
v_add3_u32 v226, v226, v9, s72
s_waitcnt vmcnt(22)
s_lshl_b32 s65, s62, 10
s_add_u32 s65, s65, s64
s_add_u32 s65, s65, 12845056
buffer_store_dwordx4 v[228:231], v1, s[8:11], s65 offen sc1
v_lshlrev_b32 v240, 16, v228
v_and_b32 v241, 0xffff0000, v228
v_add_f32 v244, v240, v241
v_mul_f32 v245, v240, v240
v_fmac_f32 v245, v241, v241
v_lshlrev_b32 v240, 16, v229
v_and_b32 v241, 0xffff0000, v229
v_add_f32 v244, v244, v240
v_fmac_f32 v245, v240, v240
v_add_f32 v244, v244, v241
v_fmac_f32 v245, v241, v241
v_lshlrev_b32 v240, 16, v230
v_and_b32 v241, 0xffff0000, v230
v_add_f32 v244, v244, v240
v_fmac_f32 v245, v240, v240
v_add_f32 v244, v244, v241
v_fmac_f32 v245, v241, v241
v_lshlrev_b32 v240, 16, v231
v_and_b32 v241, 0xffff0000, v231
v_add_f32 v244, v244, v240
v_fmac_f32 v245, v240, v240
v_add_f32 v244, v244, v241
v_fmac_f32 v245, v241, v241
v_mov_b32 v240, v244
v_mov_b32 v241, v245
s_nop 0
v_permlane16_swap_b32 v244, v240
v_permlane16_swap_b32 v245, v241
v_add_f32 v244, v244, v240
v_add_f32 v245, v245, v241
v_mov_b32 v240, v244
v_mov_b32 v241, v245
s_nop 0
v_permlane32_swap_b32 v244, v240
v_permlane32_swap_b32 v245, v241
v_add_f32 v244, v244, v240
v_add_f32 v245, v245, v241
s_lshl_b32 s65, s62, 7
s_and_b32 s69, s60, 1
s_mul_i32 s69, s69, 1792
s_add_u32 s65, s65, s69
s_lshr_b32 s69, s60, 1
s_lshl_b32 s69, s69, 12
s_add_u32 s65, s65, s69
s_add_u32 s65, s65, 118603776
buffer_store_dwordx2 v[244:245], v13, s[8:11], s65 offen sc1
s_lshl_b32 s65, s63, 10
s_add_u32 s65, s65, s64
s_add_u32 s65, s65, 12845056
buffer_store_dwordx4 v[232:235], v1, s[8:11], s65 offen sc1
v_lshlrev_b32 v240, 16, v232
v_and_b32 v241, 0xffff0000, v232
v_add_f32 v246, v240, v241
v_mul_f32 v247, v240, v240
v_fmac_f32 v247, v241, v241
v_lshlrev_b32 v240, 16, v233
v_and_b32 v241, 0xffff0000, v233
v_add_f32 v246, v246, v240
v_fmac_f32 v247, v240, v240
v_add_f32 v246, v246, v241
v_fmac_f32 v247, v241, v241
v_lshlrev_b32 v240, 16, v234
v_and_b32 v241, 0xffff0000, v234
v_add_f32 v246, v246, v240
v_fmac_f32 v247, v240, v240
v_add_f32 v246, v246, v241
v_fmac_f32 v247, v241, v241
v_lshlrev_b32 v240, 16, v235
v_and_b32 v241, 0xffff0000, v235
v_add_f32 v246, v246, v240
v_fmac_f32 v247, v240, v240
v_add_f32 v246, v246, v241
v_fmac_f32 v247, v241, v241
v_mov_b32 v240, v246
v_mov_b32 v241, v247
s_nop 0
v_permlane16_swap_b32 v246, v240
v_permlane16_swap_b32 v247, v241
v_add_f32 v246, v246, v240
v_add_f32 v247, v247, v241
v_mov_b32 v240, v246
v_mov_b32 v241, v247
s_nop 0
v_permlane32_swap_b32 v246, v240
v_permlane32_swap_b32 v247, v241
v_add_f32 v246, v246, v240
v_add_f32 v247, v247, v241
s_lshl_b32 s65, s63, 7
s_and_b32 s69, s60, 1
s_mul_i32 s69, s69, 1792
s_add_u32 s65, s65, s69
s_lshr_b32 s69, s60, 1
s_lshl_b32 s69, s69, 12
s_add_u32 s65, s65, s69
s_add_u32 s65, s65, 118603776
buffer_store_dwordx2 v[246:247], v13, s[8:11], s65 offen sc1
v_min_u32 v236, -2, v236
v_min_u32 v237, -2, v237
v_min_u32 v238, -2, v238
v_min_u32 v239, -2, v239
s_and_b32 s69, s2, 1
s_mul_i32 s69, s69, 163840
s_lshl_b32 s79, s66, 10
s_add_u32 s69, s69, s79
s_add_u32 s69, s69, 117178368
s_cmp_lt_u32 s2, 14
s_cselect_b32 s69, s69, 0x7ff00000
s_cmp_eq_u32 s32, 0
s_cselect_b32 s69, s69, 0x7ff00000
buffer_store_dwordx4 v[236:239], v1, s[8:11], s69 offen sc1
s_cmp_lg_u32 s33, 0
s_cbranch_scc1 LP_g1
s_waitcnt vmcnt(16)
s_barrier
ds_read_b128 v[176:179], v7 offset:0
ds_read_b128 v[180:183], v7 offset:2048
ds_read_b128 v[184:187], v60 offset:0
ds_read_b128 v[188:191], v60 offset:2048
ds_read_b128 v[192:195], v5 offset:28672
ds_read_b128 v[196:199], v5 offset:30720
ds_read_b128 v[200:203], v5 offset:32768
ds_read_b128 v[204:207], v5 offset:34816
ds_read_b128 v[208:211], v5 offset:36864
ds_read_b128 v[212:215], v5 offset:38912
ds_read_b128 v[216:219], v5 offset:40960
s_waitcnt lgkmcnt(0)
v_mfma_f32_16x16x32_bf16 v[64:67], v[176:179], v[192:195], 0
ds_read_b128 v[16:19], v8 offset:0
s_add_u32 m0, s57, 90112
s_add_u32 s56, s51, 256
buffer_load_dwordx4 v10, s[20:23], s56 offen lds
v_mfma_f32_16x16x32_bf16 v[68:71], v[176:179], v[196:199], 0
ds_read_b128 v[20:23], v8 offset:2048
s_add_u32 m0, s57, 94208
s_add_u32 s56, s51, 262400
buffer_load_dwordx4 v10, s[20:23], s56 offen lds
v_mfma_f32_16x16x32_bf16 v[72:75], v[176:179], v[200:203], 0
ds_read_b128 v[24:27], v61 offset:0
s_add_u32 m0, s57, 98304
s_add_u32 s56, s51, 524544
buffer_load_dwordx4 v10, s[20:23], s56 offen lds
v_mfma_f32_16x16x32_bf16 v[76:79], v[176:179], v[204:207], 0
ds_read_b128 v[28:31], v61 offset:2048
s_add_u32 m0, s57, 102400
s_add_u32 s56, s51, 786688
buffer_load_dwordx4 v10, s[20:23], s56 offen lds
v_mfma_f32_16x16x32_bf16 v[80:83], v[176:179], v[208:211], 0
ds_read_b128 v[32:35], v6 offset:28672
s_add_u32 m0, s57, 106496
s_add_u32 s56, s51, 1048832
buffer_load_dwordx4 v10, s[20:23], s56 offen lds
v_mfma_f32_16x16x32_bf16 v[84:87], v[176:179], v[212:215], 0
ds_read_b128 v[36:39], v6 offset:30720
s_add_u32 m0, s57, 110592
s_add_u32 s56, s51, 1310976
buffer_load_dwordx4 v10, s[20:23], s56 offen lds
v_mfma_f32_16x16x32_bf16 v[88:91], v[176:179], v[216:219], 0
ds_read_b128 v[40:43], v6 offset:32768
s_add_u32 m0, s57, 114688
s_add_u32 s56, s51, 1573120
buffer_load_dwordx4 v10, s[20:23], s56 offen lds
v_mfma_f32_16x16x32_bf16 v[92:95], v[180:183], v[192:195], 0
ds_read_b128 v[44:47], v6 offset:34816
s_add_u32 m0, s57, 118784
s_mul_i32 s84, s85, 2
s_add_u32 s56, s100, s84
buffer_load_dwordx4 v11, s[24:27], s56 offen lds
v_mfma_f32_16x16x32_bf16 v[96:99], v[180:183], v[196:199], 0
ds_read_b128 v[48:51], v6 offset:36864
s_add_u32 m0, s57, 122880
s_add_u32 s56, s101, s84
buffer_load_dwordx4 v11, s[24:27], s56 offen lds
v_mfma_f32_16x16x32_bf16 v[100:103], v[180:183], v[200:203], 0
ds_read_b128 v[52:55], v6 offset:38912
s_add_u32 m0, s57, 126976
s_add_u32 s56, s86, s84
buffer_load_dwordx4 v11, s[24:27], s56 offen lds
v_mfma_f32_16x16x32_bf16 v[104:107], v[180:183], v[204:207], 0
ds_read_b128 v[56:59], v6 offset:40960
s_add_u32 m0, s57, 131072
s_add_u32 s56, s87, s84
buffer_load_dwordx4 v11, s[24:27], s56 offen lds
v_mfma_f32_16x16x32_bf16 v[108:111], v[180:183], v[208:211], 0
v_mfma_f32_16x16x32_bf16 v[112:115], v[180:183], v[212:215], 0
v_mfma_f32_16x16x32_bf16 v[116:119], v[180:183], v[216:219], 0
v_mfma_f32_16x16x32_bf16 v[120:123], v[184:187], v[192:195], 0
v_mfma_f32_16x16x32_bf16 v[124:127], v[184:187], v[196:199], 0
v_mfma_f32_16x16x32_bf16 v[128:131], v[184:187], v[200:203], 0
v_mfma_f32_16x16x32_bf16 v[132:135], v[184:187], v[204:207], 0
v_mfma_f32_16x16x32_bf16 v[136:139], v[184:187], v[208:211], 0
v_mfma_f32_16x16x32_bf16 v[140:143], v[184:187], v[212:215], 0
v_mfma_f32_16x16x32_bf16 v[144:147], v[184:187], v[216:219], 0
v_mfma_f32_16x16x32_bf16 v[148:151], v[188:191], v[192:195], 0
v_mfma_f32_16x16x32_bf16 v[152:155], v[188:191], v[196:199], 0
v_mfma_f32_16x16x32_bf16 v[156:159], v[188:191], v[200:203], 0
v_mfma_f32_16x16x32_bf16 v[160:163], v[188:191], v[204:207], 0
v_mfma_f32_16x16x32_bf16 v[164:167], v[188:191], v[208:211], 0
v_mfma_f32_16x16x32_bf16 v[168:171], v[188:191], v[212:215], 0
v_mfma_f32_16x16x32_bf16 v[172:175], v[188:191], v[216:219], 0
s_waitcnt lgkmcnt(0)
s_waitcnt vmcnt(16)
s_barrier
v_add_u32 v5, 45056, v5
v_add_u32 v6, 45056, v6
v_add_u32 v7, 45056, v7
v_add_u32 v8, 45056, v8
v_add_u32 v60, 45056, v60
v_add_u32 v61, 45056, v61
v_add_u32 v220, 45056, v220
v_add_u32 v221, 45056, v221
v_add_u32 v222, 45056, v222
v_add_u32 v223, 45056, v223
v_add_u32 v224, 45056, v224
v_add_u32 v225, 45056, v225
v_add_u32 v226, 45056, v226
v_mfma_f32_16x16x32_bf16 v[64:67], v[16:19], v[32:35], v[64:67]
ds_read_b128 v[176:179], v7 offset:0
s_add_u32 m0, s57, 0
s_add_u32 s56, s51, 384
buffer_load_dwordx4 v10, s[20:23], s56 offen lds
v_mfma_f32_16x16x32_bf16 v[68:71], v[16:19], v[36:39], v[68:71]
ds_read_b128 v[180:183], v7 offset:2048
s_add_u32 m0, s57, 4096
s_add_u32 s56, s51, 262528
buffer_load_dwordx4 v10, s[20:23], s56 offen lds
v_mfma_f32_16x16x32_bf16 v[72:75], v[16:19], v[40:43], v[72:75]
ds_read_b128 v[184:187], v60 offset:0
s_add_u32 m0, s57, 8192
s_add_u32 s56, s51, 524672
buffer_load_dwordx4 v10, s[20:23], s56 offen lds
v_mfma_f32_16x16x32_bf16 v[76:79], v[16:19], v[44:47], v[76:79]
ds_read_b128 v[188:191], v60 offset:2048
s_add_u32 m0, s57, 12288
s_add_u32 s56, s51, 786816
buffer_load_dwordx4 v10, s[20:23], s56 offen lds
v_mfma_f32_16x16x32_bf16 v[80:83], v[16:19], v[48:51], v[80:83]
ds_read_b128 v[192:195], v5 offset:28672
s_add_u32 m0, s57, 16384
s_add_u32 s56, s51, 1048960
buffer_load_dwordx4 v10, s[20:23], s56 offen lds
v_mfma_f32_16x16x32_bf16 v[84:87], v[16:19], v[52:55], v[84:87]
ds_read_b128 v[196:199], v5 offset:30720
s_add_u32 m0, s57, 20480
s_add_u32 s56, s51, 1311104
buffer_load_dwordx4 v10, s[20:23], s56 offen lds
v_mfma_f32_16x16x32_bf16 v[88:91], v[16:19], v[56:59], v[88:91]
ds_read_b128 v[200:203], v5 offset:32768
s_add_u32 m0, s57, 24576
s_add_u32 s56, s51, 1573248
buffer_load_dwordx4 v10, s[20:23], s56 offen lds
v_mfma_f32_16x16x32_bf16 v[92:95], v[20:23], v[32:35], v[92:95]
ds_read_b128 v[204:207], v5 offset:34816
s_add_u32 m0, s57, 28672
s_mul_i32 s84, s85, 3
s_add_u32 s56, s100, s84
buffer_load_dwordx4 v11, s[24:27], s56 offen lds
v_mfma_f32_16x16x32_bf16 v[96:99], v[20:23], v[36:39], v[96:99]
ds_read_b128 v[208:211], v5 offset:36864
s_add_u32 m0, s57, 32768
s_add_u32 s56, s101, s84
buffer_load_dwordx4 v11, s[24:27], s56 offen lds
v_mfma_f32_16x16x32_bf16 v[100:103], v[20:23], v[40:43], v[100:103]
ds_read_b128 v[212:215], v5 offset:38912
s_add_u32 m0, s57, 36864
s_add_u32 s56, s86, s84
buffer_load_dwordx4 v11, s[24:27], s56 offen lds
v_mfma_f32_16x16x32_bf16 v[104:107], v[20:23], v[44:47], v[104:107]
ds_read_b128 v[216:219], v5 offset:40960
s_add_u32 m0, s57, 40960
s_add_u32 s56, s87, s84
buffer_load_dwordx4 v11, s[24:27], s56 offen lds
v_mfma_f32_16x16x32_bf16 v[108:111], v[20:23], v[48:51], v[108:111]
v_mfma_f32_16x16x32_bf16 v[112:115], v[20:23], v[52:55], v[112:115]
v_mfma_f32_16x16x32_bf16 v[116:119], v[20:23], v[56:59], v[116:119]
v_mfma_f32_16x16x32_bf16 v[120:123], v[24:27], v[32:35], v[120:123]
v_mfma_f32_16x16x32_bf16 v[124:127], v[24:27], v[36:39], v[124:127]
v_mfma_f32_16x16x32_bf16 v[128:131], v[24:27], v[40:43], v[128:131]
v_mfma_f32_16x16x32_bf16 v[132:135], v[24:27], v[44:47], v[132:135]
v_mfma_f32_16x16x32_bf16 v[136:139], v[24:27], v[48:51], v[136:139]
v_mfma_f32_16x16x32_bf16 v[140:143], v[24:27], v[52:55], v[140:143]
v_mfma_f32_16x16x32_bf16 v[144:147], v[24:27], v[56:59], v[144:147]
v_mfma_f32_16x16x32_bf16 v[148:151], v[28:31], v[32:35], v[148:151]
v_mfma_f32_16x16x32_bf16 v[152:155], v[28:31], v[36:39], v[152:155]
v_mfma_f32_16x16x32_bf16 v[156:159], v[28:31], v[40:43], v[156:159]
v_mfma_f32_16x16x32_bf16 v[160:163], v[28:31], v[44:47], v[160:163]
v_mfma_f32_16x16x32_bf16 v[164:167], v[28:31], v[48:51], v[164:167]
v_mfma_f32_16x16x32_bf16 v[168:171], v[28:31], v[52:55], v[168:171]
v_mfma_f32_16x16x32_bf16 v[172:175], v[28:31], v[56:59], v[172:175]
s_waitcnt lgkmcnt(0)
v_mfma_f32_16x16x32_bf16 v[64:67], v[176:179], v[192:195], v[64:67]
ds_read_b128 v[16:19], v8 offset:0
v_mfma_f32_16x16x32_bf16 v[68:71], v[176:179], v[196:199], v[68:71]
ds_read_b128 v[20:23], v8 offset:2048
v_mfma_f32_16x16x32_bf16 v[72:75], v[176:179], v[200:203], v[72:75]
ds_read_b128 v[24:27], v61 offset:0
v_mfma_f32_16x16x32_bf16 v[76:79], v[176:179], v[204:207], v[76:79]
ds_read_b128 v[28:31], v61 offset:2048
v_mfma_f32_16x16x32_bf16 v[80:83], v[176:179], v[208:211], v[80:83]
ds_read_b128 v[32:35], v6 offset:28672
v_mfma_f32_16x16x32_bf16 v[84:87], v[176:179], v[212:215], v[84:87]
ds_read_b128 v[36:39], v6 offset:30720
v_mfma_f32_16x16x32_bf16 v[88:91], v[176:179], v[216:219], v[88:91]
ds_read_b128 v[40:43], v6 offset:32768
v_mfma_f32_16x16x32_bf16 v[92:95], v[180:183], v[192:195], v[92:95]
ds_read_b128 v[44:47], v6 offset:34816
v_mfma_f32_16x16x32_bf16 v[96:99], v[180:183], v[196:199], v[96:99]
ds_read_b128 v[48:51], v6 offset:36864
v_mfma_f32_16x16x32_bf16 v[100:103], v[180:183], v[200:203], v[100:103]
ds_read_b128 v[52:55], v6 offset:38912
v_mfma_f32_16x16x32_bf16 v[104:107], v[180:183], v[204:207], v[104:107]
ds_read_b128 v[56:59], v6 offset:40960
v_mfma_f32_16x16x32_bf16 v[108:111], v[180:183], v[208:211], v[108:111]
v_mfma_f32_16x16x32_bf16 v[112:115], v[180:183], v[212:215], v[112:115]
v_mfma_f32_16x16x32_bf16 v[116:119], v[180:183], v[216:219], v[116:119]
v_mfma_f32_16x16x32_bf16 v[120:123], v[184:187], v[192:195], v[120:123]
v_mfma_f32_16x16x32_bf16 v[124:127], v[184:187], v[196:199], v[124:127]
v_mfma_f32_16x16x32_bf16 v[128:131], v[184:187], v[200:203], v[128:131]
v_mfma_f32_16x16x32_bf16 v[132:135], v[184:187], v[204:207], v[132:135]
v_mfma_f32_16x16x32_bf16 v[136:139], v[184:187], v[208:211], v[136:139]
v_mfma_f32_16x16x32_bf16 v[140:143], v[184:187], v[212:215], v[140:143]
v_mfma_f32_16x16x32_bf16 v[144:147], v[184:187], v[216:219], v[144:147]
v_mfma_f32_16x16x32_bf16 v[148:151], v[188:191], v[192:195], v[148:151]
v_mfma_f32_16x16x32_bf16 v[152:155], v[188:191], v[196:199], v[152:155]
v_mfma_f32_16x16x32_bf16 v[156:159], v[188:191], v[200:203], v[156:159]
v_mfma_f32_16x16x32_bf16 v[160:163], v[188:191], v[204:207], v[160:163]
v_mfma_f32_16x16x32_bf16 v[164:167], v[188:191], v[208:211], v[164:167]
v_mfma_f32_16x16x32_bf16 v[168:171], v[188:191], v[212:215], v[168:171]
v_mfma_f32_16x16x32_bf16 v[172:175], v[188:191], v[216:219], v[172:175]
s_waitcnt lgkmcnt(0)
s_waitcnt vmcnt(11)
s_barrier
v_add_u32 v5, 45056, v5
v_add_u32 v6, 45056, v6
v_add_u32 v7, 45056, v7
v_add_u32 v8, 45056, v8
v_add_u32 v60, 45056, v60
v_add_u32 v61, 45056, v61
v_add_u32 v220, 45056, v220
v_add_u32 v221, 45056, v221
v_add_u32 v222, 45056, v222
v_add_u32 v223, 45056, v223
v_add_u32 v224, 45056, v224
v_add_u32 v225, 45056, v225
v_add_u32 v226, 45056, v226
v_mfma_f32_16x16x32_bf16 v[64:67], v[16:19], v[32:35], v[64:67]
ds_read_b128 v[176:179], v7 offset:0
v_mfma_f32_16x16x32_bf16 v[68:71], v[16:19], v[36:39], v[68:71]
ds_read_b128 v[180:183], v7 offset:2048
v_mfma_f32_16x16x32_bf16 v[72:75], v[16:19], v[40:43], v[72:75]
ds_read_b128 v[184:187], v60 offset:0
v_mfma_f32_16x16x32_bf16 v[76:79], v[16:19], v[44:47], v[76:79]
ds_read_b128 v[188:191], v60 offset:2048
v_mfma_f32_16x16x32_bf16 v[80:83], v[16:19], v[48:51], v[80:83]
ds_read_b128 v[192:195], v5 offset:28672
v_mfma_f32_16x16x32_bf16 v[84:87], v[16:19], v[52:55], v[84:87]
ds_read_b128 v[196:199], v5 offset:30720
v_mfma_f32_16x16x32_bf16 v[88:91], v[16:19], v[56:59], v[88:91]
ds_read_b128 v[200:203], v5 offset:32768
v_mfma_f32_16x16x32_bf16 v[92:95], v[20:23], v[32:35], v[92:95]
ds_read_b128 v[204:207], v5 offset:34816
v_mfma_f32_16x16x32_bf16 v[96:99], v[20:23], v[36:39], v[96:99]
ds_read_b128 v[208:211], v5 offset:36864
v_mfma_f32_16x16x32_bf16 v[100:103], v[20:23], v[40:43], v[100:103]
ds_read_b128 v[212:215], v5 offset:38912
v_mfma_f32_16x16x32_bf16 v[104:107], v[20:23], v[44:47], v[104:107]
ds_read_b128 v[216:219], v5 offset:40960
v_mfma_f32_16x16x32_bf16 v[108:111], v[20:23], v[48:51], v[108:111]
v_mfma_f32_16x16x32_bf16 v[112:115], v[20:23], v[52:55], v[112:115]
v_mfma_f32_16x16x32_bf16 v[116:119], v[20:23], v[56:59], v[116:119]
v_mfma_f32_16x16x32_bf16 v[120:123], v[24:27], v[32:35], v[120:123]
v_mfma_f32_16x16x32_bf16 v[124:127], v[24:27], v[36:39], v[124:127]
v_mfma_f32_16x16x32_bf16 v[128:131], v[24:27], v[40:43], v[128:131]
v_mfma_f32_16x16x32_bf16 v[132:135], v[24:27], v[44:47], v[132:135]
v_mfma_f32_16x16x32_bf16 v[136:139], v[24:27], v[48:51], v[136:139]
v_mfma_f32_16x16x32_bf16 v[140:143], v[24:27], v[52:55], v[140:143]
v_mfma_f32_16x16x32_bf16 v[144:147], v[24:27], v[56:59], v[144:147]
v_mfma_f32_16x16x32_bf16 v[148:151], v[28:31], v[32:35], v[148:151]
v_mfma_f32_16x16x32_bf16 v[152:155], v[28:31], v[36:39], v[152:155]
v_mfma_f32_16x16x32_bf16 v[156:159], v[28:31], v[40:43], v[156:159]
v_mfma_f32_16x16x32_bf16 v[160:163], v[28:31], v[44:47], v[160:163]
v_mfma_f32_16x16x32_bf16 v[164:167], v[28:31], v[48:51], v[164:167]
v_mfma_f32_16x16x32_bf16 v[168:171], v[28:31], v[52:55], v[168:171]
v_mfma_f32_16x16x32_bf16 v[172:175], v[28:31], v[56:59], v[172:175]
s_waitcnt lgkmcnt(0)
v_mfma_f32_16x16x32_bf16 v[64:67], v[176:179], v[192:195], v[64:67]
ds_read_b128 v[16:19], v8 offset:0
v_mfma_f32_16x16x32_bf16 v[68:71], v[176:179], v[196:199], v[68:71]
ds_read_b128 v[20:23], v8 offset:2048
v_mfma_f32_16x16x32_bf16 v[72:75], v[176:179], v[200:203], v[72:75]
ds_read_b128 v[24:27], v61 offset:0
v_mfma_f32_16x16x32_bf16 v[76:79], v[176:179], v[204:207], v[76:79]
ds_read_b128 v[28:31], v61 offset:2048
v_mfma_f32_16x16x32_bf16 v[80:83], v[176:179], v[208:211], v[80:83]
ds_read_b128 v[32:35], v6 offset:28672
v_mfma_f32_16x16x32_bf16 v[84:87], v[176:179], v[212:215], v[84:87]
ds_read_b128 v[36:39], v6 offset:30720
v_mfma_f32_16x16x32_bf16 v[88:91], v[176:179], v[216:219], v[88:91]
ds_read_b128 v[40:43], v6 offset:32768
v_mfma_f32_16x16x32_bf16 v[92:95], v[180:183], v[192:195], v[92:95]
ds_read_b128 v[44:47], v6 offset:34816
v_mfma_f32_16x16x32_bf16 v[96:99], v[180:183], v[196:199], v[96:99]
ds_read_b128 v[48:51], v6 offset:36864
v_mfma_f32_16x16x32_bf16 v[100:103], v[180:183], v[200:203], v[100:103]
ds_read_b128 v[52:55], v6 offset:38912
v_mfma_f32_16x16x32_bf16 v[104:107], v[180:183], v[204:207], v[104:107]
ds_read_b128 v[56:59], v6 offset:40960
v_mfma_f32_16x16x32_bf16 v[108:111], v[180:183], v[208:211], v[108:111]
v_mfma_f32_16x16x32_bf16 v[112:115], v[180:183], v[212:215], v[112:115]
v_mfma_f32_16x16x32_bf16 v[116:119], v[180:183], v[216:219], v[116:119]
v_mfma_f32_16x16x32_bf16 v[120:123], v[184:187], v[192:195], v[120:123]
v_mfma_f32_16x16x32_bf16 v[124:127], v[184:187], v[196:199], v[124:127]
v_mfma_f32_16x16x32_bf16 v[128:131], v[184:187], v[200:203], v[128:131]
v_mfma_f32_16x16x32_bf16 v[132:135], v[184:187], v[204:207], v[132:135]
v_mfma_f32_16x16x32_bf16 v[136:139], v[184:187], v[208:211], v[136:139]
v_mfma_f32_16x16x32_bf16 v[140:143], v[184:187], v[212:215], v[140:143]
v_mfma_f32_16x16x32_bf16 v[144:147], v[184:187], v[216:219], v[144:147]
v_mfma_f32_16x16x32_bf16 v[148:151], v[188:191], v[192:195], v[148:151]
v_mfma_f32_16x16x32_bf16 v[152:155], v[188:191], v[196:199], v[152:155]
v_mfma_f32_16x16x32_bf16 v[156:159], v[188:191], v[200:203], v[156:159]
v_mfma_f32_16x16x32_bf16 v[160:163], v[188:191], v[204:207], v[160:163]
v_mfma_f32_16x16x32_bf16 v[164:167], v[188:191], v[208:211], v[164:167]
v_mfma_f32_16x16x32_bf16 v[168:171], v[188:191], v[212:215], v[168:171]
v_mfma_f32_16x16x32_bf16 v[172:175], v[188:191], v[216:219], v[172:175]
s_waitcnt lgkmcnt(0)
s_waitcnt vmcnt(0)
s_barrier
v_add_u32 v5, 4294877184, v5
v_add_u32 v6, 4294877184, v6
v_add_u32 v7, 4294877184, v7
v_add_u32 v8, 4294877184, v8
v_add_u32 v60, 4294877184, v60
v_add_u32 v61, 4294877184, v61
v_add_u32 v220, 4294877184, v220
v_add_u32 v221, 4294877184, v221
v_add_u32 v222, 4294877184, v222
v_add_u32 v223, 4294877184, v223
v_add_u32 v224, 4294877184, v224
v_add_u32 v225, 4294877184, v225
v_add_u32 v226, 4294877184, v226
v_mfma_f32_16x16x32_bf16 v[64:67], v[16:19], v[32:35], v[64:67]
ds_read_b128 v[176:179], v7 offset:0
v_mfma_f32_16x16x32_bf16 v[68:71], v[16:19], v[36:39], v[68:71]
ds_read_b128 v[180:183], v7 offset:2048
v_mfma_f32_16x16x32_bf16 v[72:75], v[16:19], v[40:43], v[72:75]
ds_read_b128 v[184:187], v60 offset:0
v_mfma_f32_16x16x32_bf16 v[76:79], v[16:19], v[44:47], v[76:79]
ds_read_b128 v[188:191], v60 offset:2048
v_mfma_f32_16x16x32_bf16 v[80:83], v[16:19], v[48:51], v[80:83]
ds_read_b128 v[192:195], v5 offset:28672
v_mfma_f32_16x16x32_bf16 v[84:87], v[16:19], v[52:55], v[84:87]
ds_read_b128 v[196:199], v5 offset:30720
v_mfma_f32_16x16x32_bf16 v[88:91], v[16:19], v[56:59], v[88:91]
ds_read_b128 v[200:203], v5 offset:32768
v_mfma_f32_16x16x32_bf16 v[92:95], v[20:23], v[32:35], v[92:95]
ds_read_b128 v[204:207], v5 offset:34816
v_mfma_f32_16x16x32_bf16 v[96:99], v[20:23], v[36:39], v[96:99]
ds_read_b128 v[208:211], v5 offset:36864
v_mfma_f32_16x16x32_bf16 v[100:103], v[20:23], v[40:43], v[100:103]
ds_read_b128 v[212:215], v5 offset:38912
v_mfma_f32_16x16x32_bf16 v[104:107], v[20:23], v[44:47], v[104:107]
ds_read_b128 v[216:219], v5 offset:40960
v_mfma_f32_16x16x32_bf16 v[108:111], v[20:23], v[48:51], v[108:111]
v_mfma_f32_16x16x32_bf16 v[112:115], v[20:23], v[52:55], v[112:115]
v_mfma_f32_16x16x32_bf16 v[116:119], v[20:23], v[56:59], v[116:119]
v_mfma_f32_16x16x32_bf16 v[120:123], v[24:27], v[32:35], v[120:123]
v_mfma_f32_16x16x32_bf16 v[124:127], v[24:27], v[36:39], v[124:127]
v_mfma_f32_16x16x32_bf16 v[128:131], v[24:27], v[40:43], v[128:131]
v_mfma_f32_16x16x32_bf16 v[132:135], v[24:27], v[44:47], v[132:135]
v_mfma_f32_16x16x32_bf16 v[136:139], v[24:27], v[48:51], v[136:139]
v_mfma_f32_16x16x32_bf16 v[140:143], v[24:27], v[52:55], v[140:143]
v_mfma_f32_16x16x32_bf16 v[144:147], v[24:27], v[56:59], v[144:147]
v_mfma_f32_16x16x32_bf16 v[148:151], v[28:31], v[32:35], v[148:151]
v_mfma_f32_16x16x32_bf16 v[152:155], v[28:31], v[36:39], v[152:155]
v_mfma_f32_16x16x32_bf16 v[156:159], v[28:31], v[40:43], v[156:159]
v_mfma_f32_16x16x32_bf16 v[160:163], v[28:31], v[44:47], v[160:163]
v_mfma_f32_16x16x32_bf16 v[164:167], v[28:31], v[48:51], v[164:167]
v_mfma_f32_16x16x32_bf16 v[168:171], v[28:31], v[52:55], v[168:171]
v_mfma_f32_16x16x32_bf16 v[172:175], v[28:31], v[56:59], v[172:175]
s_waitcnt lgkmcnt(0)
v_mfma_f32_16x16x32_bf16 v[64:67], v[176:179], v[192:195], v[64:67]
ds_read_b128 v[16:19], v8 offset:0
v_mfma_f32_16x16x32_bf16 v[68:71], v[176:179], v[196:199], v[68:71]
ds_read_b128 v[20:23], v8 offset:2048
v_mfma_f32_16x16x32_bf16 v[72:75], v[176:179], v[200:203], v[72:75]
ds_read_b128 v[24:27], v61 offset:0
v_mfma_f32_16x16x32_bf16 v[76:79], v[176:179], v[204:207], v[76:79]
ds_read_b128 v[28:31], v61 offset:2048
v_mfma_f32_16x16x32_bf16 v[80:83], v[176:179], v[208:211], v[80:83]
ds_read_b128 v[32:35], v6 offset:28672
v_mfma_f32_16x16x32_bf16 v[84:87], v[176:179], v[212:215], v[84:87]
ds_read_b128 v[36:39], v6 offset:30720
v_mfma_f32_16x16x32_bf16 v[88:91], v[176:179], v[216:219], v[88:91]
ds_read_b128 v[40:43], v6 offset:32768
v_mfma_f32_16x16x32_bf16 v[92:95], v[180:183], v[192:195], v[92:95]
ds_read_b128 v[44:47], v6 offset:34816
v_mfma_f32_16x16x32_bf16 v[96:99], v[180:183], v[196:199], v[96:99]
ds_read_b128 v[48:51], v6 offset:36864
v_mfma_f32_16x16x32_bf16 v[100:103], v[180:183], v[200:203], v[100:103]
ds_read_b128 v[52:55], v6 offset:38912
v_mfma_f32_16x16x32_bf16 v[104:107], v[180:183], v[204:207], v[104:107]
ds_read_b128 v[56:59], v6 offset:40960
v_mfma_f32_16x16x32_bf16 v[108:111], v[180:183], v[208:211], v[108:111]
v_mfma_f32_16x16x32_bf16 v[112:115], v[180:183], v[212:215], v[112:115]
v_mfma_f32_16x16x32_bf16 v[116:119], v[180:183], v[216:219], v[116:119]
v_mfma_f32_16x16x32_bf16 v[120:123], v[184:187], v[192:195], v[120:123]
v_mfma_f32_16x16x32_bf16 v[124:127], v[184:187], v[196:199], v[124:127]
v_mfma_f32_16x16x32_bf16 v[128:131], v[184:187], v[200:203], v[128:131]
v_mfma_f32_16x16x32_bf16 v[132:135], v[184:187], v[204:207], v[132:135]
v_mfma_f32_16x16x32_bf16 v[136:139], v[184:187], v[208:211], v[136:139]
v_mfma_f32_16x16x32_bf16 v[140:143], v[184:187], v[212:215], v[140:143]
v_mfma_f32_16x16x32_bf16 v[144:147], v[184:187], v[216:219], v[144:147]
v_mfma_f32_16x16x32_bf16 v[148:151], v[188:191], v[192:195], v[148:151]
v_mfma_f32_16x16x32_bf16 v[152:155], v[188:191], v[196:199], v[152:155]
v_mfma_f32_16x16x32_bf16 v[156:159], v[188:191], v[200:203], v[156:159]
v_mfma_f32_16x16x32_bf16 v[160:163], v[188:191], v[204:207], v[160:163]
v_mfma_f32_16x16x32_bf16 v[164:167], v[188:191], v[208:211], v[164:167]
v_mfma_f32_16x16x32_bf16 v[168:171], v[188:191], v[212:215], v[168:171]
v_mfma_f32_16x16x32_bf16 v[172:175], v[188:191], v[216:219], v[172:175]
s_waitcnt lgkmcnt(0)
v_mfma_f32_16x16x32_bf16 v[64:67], v[16:19], v[32:35], v[64:67]
v_mfma_f32_16x16x32_bf16 v[68:71], v[16:19], v[36:39], v[68:71]
v_mfma_f32_16x16x32_bf16 v[72:75], v[16:19], v[40:43], v[72:75]
v_mfma_f32_16x16x32_bf16 v[76:79], v[16:19], v[44:47], v[76:79]
v_mfma_f32_16x16x32_bf16 v[80:83], v[16:19], v[48:51], v[80:83]
v_mfma_f32_16x16x32_bf16 v[84:87], v[16:19], v[52:55], v[84:87]
v_mfma_f32_16x16x32_bf16 v[88:91], v[16:19], v[56:59], v[88:91]
v_mfma_f32_16x16x32_bf16 v[92:95], v[20:23], v[32:35], v[92:95]
v_mfma_f32_16x16x32_bf16 v[96:99], v[20:23], v[36:39], v[96:99]
v_mfma_f32_16x16x32_bf16 v[100:103], v[20:23], v[40:43], v[100:103]
v_mfma_f32_16x16x32_bf16 v[104:107], v[20:23], v[44:47], v[104:107]
v_mfma_f32_16x16x32_bf16 v[108:111], v[20:23], v[48:51], v[108:111]
v_mfma_f32_16x16x32_bf16 v[112:115], v[20:23], v[52:55], v[112:115]
v_mfma_f32_16x16x32_bf16 v[116:119], v[20:23], v[56:59], v[116:119]
v_mfma_f32_16x16x32_bf16 v[120:123], v[24:27], v[32:35], v[120:123]
v_mfma_f32_16x16x32_bf16 v[124:127], v[24:27], v[36:39], v[124:127]
v_mfma_f32_16x16x32_bf16 v[128:131], v[24:27], v[40:43], v[128:131]
v_mfma_f32_16x16x32_bf16 v[132:135], v[24:27], v[44:47], v[132:135]
v_mfma_f32_16x16x32_bf16 v[136:139], v[24:27], v[48:51], v[136:139]
v_mfma_f32_16x16x32_bf16 v[140:143], v[24:27], v[52:55], v[140:143]
v_mfma_f32_16x16x32_bf16 v[144:147], v[24:27], v[56:59], v[144:147]
v_mfma_f32_16x16x32_bf16 v[148:151], v[28:31], v[32:35], v[148:151]
v_mfma_f32_16x16x32_bf16 v[152:155], v[28:31], v[36:39], v[152:155]
v_mfma_f32_16x16x32_bf16 v[156:159], v[28:31], v[40:43], v[156:159]
v_mfma_f32_16x16x32_bf16 v[160:163], v[28:31], v[44:47], v[160:163]
v_mfma_f32_16x16x32_bf16 v[164:167], v[28:31], v[48:51], v[164:167]
v_mfma_f32_16x16x32_bf16 v[168:171], v[28:31], v[52:55], v[168:171]
v_mfma_f32_16x16x32_bf16 v[172:175], v[28:31], v[56:59], v[172:175]
s_mov_b32 s74, 0x3db8aa3b
s_branch LP_out
LP_g1:
s_waitcnt vmcnt(16)
s_barrier
ds_read_b128 v[176:179], v7 offset:0
ds_read_b128 v[180:183], v7 offset:2048
ds_read_b128 v[184:187], v60 offset:0
ds_read_b128 v[188:191], v60 offset:2048
ds_read_b64_tr_b16 v[192:193], v220 offset:28672
ds_read_b64_tr_b16 v[194:195], v220 offset:29696
ds_read_b64_tr_b16 v[196:197], v221 offset:28672
ds_read_b64_tr_b16 v[198:199], v221 offset:29696
ds_read_b64_tr_b16 v[200:201], v222 offset:28672
ds_read_b64_tr_b16 v[202:203], v222 offset:29696
ds_read_b64_tr_b16 v[204:205], v223 offset:28672
ds_read_b64_tr_b16 v[206:207], v223 offset:29696
ds_read_b64_tr_b16 v[208:209], v224 offset:28672
ds_read_b64_tr_b16 v[210:211], v224 offset:29696
ds_read_b64_tr_b16 v[212:213], v225 offset:28672
ds_read_b64_tr_b16 v[214:215], v225 offset:29696
ds_read_b64_tr_b16 v[216:217], v226 offset:28672
ds_read_b64_tr_b16 v[218:219], v226 offset:29696
s_waitcnt lgkmcnt(0)
v_mfma_f32_16x16x32_bf16 v[64:67], v[176:179], v[192:195], 0
ds_read_b128 v[16:19], v8 offset:0
s_add_u32 m0, s57, 90112
s_add_u32 s56, s51, 256
buffer_load_dwordx4 v10, s[20:23], s56 offen lds
v_mfma_f32_16x16x32_bf16 v[68:71], v[176:179], v[196:199], 0
ds_read_b128 v[20:23], v8 offset:2048
s_add_u32 m0, s57, 94208
s_add_u32 s56, s51, 262400
buffer_load_dwordx4 v10, s[20:23], s56 offen lds
v_mfma_f32_16x16x32_bf16 v[72:75], v[176:179], v[200:203], 0
ds_read_b128 v[24:27], v61 offset:0
s_add_u32 m0, s57, 98304
s_add_u32 s56, s51, 524544
buffer_load_dwordx4 v10, s[20:23], s56 offen lds
v_mfma_f32_16x16x32_bf16 v[76:79], v[176:179], v[204:207], 0
ds_read_b128 v[28:31], v61 offset:2048
s_add_u32 m0, s57, 102400
s_add_u32 s56, s51, 786688
buffer_load_dwordx4 v10, s[20:23], s56 offen lds
v_mfma_f32_16x16x32_bf16 v[80:83], v[176:179], v[208:211], 0
ds_read_b64_tr_b16 v[32:33], v220 offset:36864
s_add_u32 m0, s57, 106496
s_add_u32 s56, s51, 1048832
buffer_load_dwordx4 v10, s[20:23], s56 offen lds
v_mfma_f32_16x16x32_bf16 v[84:87], v[176:179], v[212:215], 0
ds_read_b64_tr_b16 v[34:35], v220 offset:37888
s_add_u32 m0, s57, 110592
s_add_u32 s56, s51, 1310976
buffer_load_dwordx4 v10, s[20:23], s56 offen lds
v_mfma_f32_16x16x32_bf16 v[88:91], v[176:179], v[216:219], 0
ds_read_b64_tr_b16 v[36:37], v221 offset:36864
s_add_u32 m0, s57, 114688
s_add_u32 s56, s51, 1573120
buffer_load_dwordx4 v10, s[20:23], s56 offen lds
v_mfma_f32_16x16x32_bf16 v[92:95], v[180:183], v[192:195], 0
ds_read_b64_tr_b16 v[38:39], v221 offset:37888
s_add_u32 m0, s57, 118784
s_mul_i32 s84, s85, 2
s_add_u32 s56, s100, s84
buffer_load_dwordx4 v11, s[24:27], s56 offen lds
v_mfma_f32_16x16x32_bf16 v[96:99], v[180:183], v[196:199], 0
ds_read_b64_tr_b16 v[40:41], v222 offset:36864
s_add_u32 m0, s57, 122880
s_add_u32 s56, s101, s84
buffer_load_dwordx4 v11, s[24:27], s56 offen lds
v_mfma_f32_16x16x32_bf16 v[100:103], v[180:183], v[200:203], 0
ds_read_b64_tr_b16 v[42:43], v222 offset:37888
s_add_u32 m0, s57, 126976
s_add_u32 s56, s86, s84
buffer_load_dwordx4 v11, s[24:27], s56 offen lds
v_mfma_f32_16x16x32_bf16 v[104:107], v[180:183], v[204:207], 0
ds_read_b64_tr_b16 v[44:45], v223 offset:36864
s_add_u32 m0, s57, 131072
s_add_u32 s56, s87, s84
buffer_load_dwordx4 v11, s[24:27], s56 offen lds
v_mfma_f32_16x16x32_bf16 v[108:111], v[180:183], v[208:211], 0
ds_read_b64_tr_b16 v[46:47], v223 offset:37888
v_mfma_f32_16x16x32_bf16 v[112:115], v[180:183], v[212:215], 0
ds_read_b64_tr_b16 v[48:49], v224 offset:36864
v_mfma_f32_16x16x32_bf16 v[116:119], v[180:183], v[216:219], 0
ds_read_b64_tr_b16 v[50:51], v224 offset:37888
v_mfma_f32_16x16x32_bf16 v[120:123], v[184:187], v[192:195], 0
ds_read_b64_tr_b16 v[52:53], v225 offset:36864
v_mfma_f32_16x16x32_bf16 v[124:127], v[184:187], v[196:199], 0
ds_read_b64_tr_b16 v[54:55], v225 offset:37888
v_mfma_f32_16x16x32_bf16 v[128:131], v[184:187], v[200:203], 0
ds_read_b64_tr_b16 v[56:57], v226 offset:36864
v_mfma_f32_16x16x32_bf16 v[132:135], v[184:187], v[204:207], 0
ds_read_b64_tr_b16 v[58:59], v226 offset:37888
v_mfma_f32_16x16x32_bf16 v[136:139], v[184:187], v[208:211], 0
v_mfma_f32_16x16x32_bf16 v[140:143], v[184:187], v[212:215], 0
v_mfma_f32_16x16x32_bf16 v[144:147], v[184:187], v[216:219], 0
v_mfma_f32_16x16x32_bf16 v[148:151], v[188:191], v[192:195], 0
v_mfma_f32_16x16x32_bf16 v[152:155], v[188:191], v[196:199], 0
v_mfma_f32_16x16x32_bf16 v[156:159], v[188:191], v[200:203], 0
v_mfma_f32_16x16x32_bf16 v[160:163], v[188:191], v[204:207], 0
v_mfma_f32_16x16x32_bf16 v[164:167], v[188:191], v[208:211], 0
v_mfma_f32_16x16x32_bf16 v[168:171], v[188:191], v[212:215], 0
v_mfma_f32_16x16x32_bf16 v[172:175], v[188:191], v[216:219], 0
s_waitcnt lgkmcnt(0)
s_waitcnt vmcnt(16)
s_barrier
v_add_u32 v5, 45056, v5
v_add_u32 v6, 45056, v6
v_add_u32 v7, 45056, v7
v_add_u32 v8, 45056, v8
v_add_u32 v60, 45056, v60
v_add_u32 v61, 45056, v61
v_add_u32 v220, 45056, v220
v_add_u32 v221, 45056, v221
v_add_u32 v222, 45056, v222
v_add_u32 v223, 45056, v223
v_add_u32 v224, 45056, v224
v_add_u32 v225, 45056, v225
v_add_u32 v226, 45056, v226
v_mfma_f32_16x16x32_bf16 v[64:67], v[16:19], v[32:35], v[64:67]
ds_read_b128 v[176:179], v7 offset:0
s_add_u32 m0, s57, 0
s_add_u32 s56, s51, 384
buffer_load_dwordx4 v10, s[20:23], s56 offen lds
v_mfma_f32_16x16x32_bf16 v[68:71], v[16:19], v[36:39], v[68:71]
ds_read_b128 v[180:183], v7 offset:2048
s_add_u32 m0, s57, 4096
s_add_u32 s56, s51, 262528
buffer_load_dwordx4 v10, s[20:23], s56 offen lds
v_mfma_f32_16x16x32_bf16 v[72:75], v[16:19], v[40:43], v[72:75]
ds_read_b128 v[184:187], v60 offset:0
s_add_u32 m0, s57, 8192
s_add_u32 s56, s51, 524672
buffer_load_dwordx4 v10, s[20:23], s56 offen lds
v_mfma_f32_16x16x32_bf16 v[76:79], v[16:19], v[44:47], v[76:79]
ds_read_b128 v[188:191], v60 offset:2048
s_add_u32 m0, s57, 12288
s_add_u32 s56, s51, 786816
buffer_load_dwordx4 v10, s[20:23], s56 offen lds
v_mfma_f32_16x16x32_bf16 v[80:83], v[16:19], v[48:51], v[80:83]
ds_read_b64_tr_b16 v[192:193], v220 offset:28672
s_add_u32 m0, s57, 16384
s_add_u32 s56, s51, 1048960
buffer_load_dwordx4 v10, s[20:23], s56 offen lds
v_mfma_f32_16x16x32_bf16 v[84:87], v[16:19], v[52:55], v[84:87]
ds_read_b64_tr_b16 v[194:195], v220 offset:29696
s_add_u32 m0, s57, 20480
s_add_u32 s56, s51, 1311104
buffer_load_dwordx4 v10, s[20:23], s56 offen lds
v_mfma_f32_16x16x32_bf16 v[88:91], v[16:19], v[56:59], v[88:91]
ds_read_b64_tr_b16 v[196:197], v221 offset:28672
s_add_u32 m0, s57, 24576
s_add_u32 s56, s51, 1573248
buffer_load_dwordx4 v10, s[20:23], s56 offen lds
v_mfma_f32_16x16x32_bf16 v[92:95], v[20:23], v[32:35], v[92:95]
ds_read_b64_tr_b16 v[198:199], v221 offset:29696
s_add_u32 m0, s57, 28672
s_mul_i32 s84, s85, 3
s_add_u32 s56, s100, s84
buffer_load_dwordx4 v11, s[24:27], s56 offen lds
v_mfma_f32_16x16x32_bf16 v[96:99], v[20:23], v[36:39], v[96:99]
ds_read_b64_tr_b16 v[200:201], v222 offset:28672
s_add_u32 m0, s57, 32768
s_add_u32 s56, s101, s84
buffer_load_dwordx4 v11, s[24:27], s56 offen lds
v_mfma_f32_16x16x32_bf16 v[100:103], v[20:23], v[40:43], v[100:103]
ds_read_b64_tr_b16 v[202:203], v222 offset:29696
s_add_u32 m0, s57, 36864
s_add_u32 s56, s86, s84
buffer_load_dwordx4 v11, s[24:27], s56 offen lds
v_mfma_f32_16x16x32_bf16 v[104:107], v[20:23], v[44:47], v[104:107]
ds_read_b64_tr_b16 v[204:205], v223 offset:28672
s_add_u32 m0, s57, 40960
s_add_u32 s56, s87, s84
buffer_load_dwordx4 v11, s[24:27], s56 offen lds
v_mfma_f32_16x16x32_bf16 v[108:111], v[20:23], v[48:51], v[108:111]
ds_read_b64_tr_b16 v[206:207], v223 offset:29696
v_mfma_f32_16x16x32_bf16 v[112:115], v[20:23], v[52:55], v[112:115]
ds_read_b64_tr_b16 v[208:209], v224 offset:28672
v_mfma_f32_16x16x32_bf16 v[116:119], v[20:23], v[56:59], v[116:119]
ds_read_b64_tr_b16 v[210:211], v224 offset:29696
v_mfma_f32_16x16x32_bf16 v[120:123], v[24:27], v[32:35], v[120:123]
ds_read_b64_tr_b16 v[212:213], v225 offset:28672
v_mfma_f32_16x16x32_bf16 v[124:127], v[24:27], v[36:39], v[124:127]
ds_read_b64_tr_b16 v[214:215], v225 offset:29696
v_mfma_f32_16x16x32_bf16 v[128:131], v[24:27], v[40:43], v[128:131]
ds_read_b64_tr_b16 v[216:217], v226 offset:28672
v_mfma_f32_16x16x32_bf16 v[132:135], v[24:27], v[44:47], v[132:135]
ds_read_b64_tr_b16 v[218:219], v226 offset:29696
v_mfma_f32_16x16x32_bf16 v[136:139], v[24:27], v[48:51], v[136:139]
v_mfma_f32_16x16x32_bf16 v[140:143], v[24:27], v[52:55], v[140:143]
v_mfma_f32_16x16x32_bf16 v[144:147], v[24:27], v[56:59], v[144:147]
v_mfma_f32_16x16x32_bf16 v[148:151], v[28:31], v[32:35], v[148:151]
v_mfma_f32_16x16x32_bf16 v[152:155], v[28:31], v[36:39], v[152:155]
v_mfma_f32_16x16x32_bf16 v[156:159], v[28:31], v[40:43], v[156:159]
v_mfma_f32_16x16x32_bf16 v[160:163], v[28:31], v[44:47], v[160:163]
v_mfma_f32_16x16x32_bf16 v[164:167], v[28:31], v[48:51], v[164:167]
v_mfma_f32_16x16x32_bf16 v[168:171], v[28:31], v[52:55], v[168:171]
v_mfma_f32_16x16x32_bf16 v[172:175], v[28:31], v[56:59], v[172:175]
s_waitcnt lgkmcnt(0)
v_mfma_f32_16x16x32_bf16 v[64:67], v[176:179], v[192:195], v[64:67]
ds_read_b128 v[16:19], v8 offset:0
v_mfma_f32_16x16x32_bf16 v[68:71], v[176:179], v[196:199], v[68:71]
ds_read_b128 v[20:23], v8 offset:2048
v_mfma_f32_16x16x32_bf16 v[72:75], v[176:179], v[200:203], v[72:75]
ds_read_b128 v[24:27], v61 offset:0
v_mfma_f32_16x16x32_bf16 v[76:79], v[176:179], v[204:207], v[76:79]
ds_read_b128 v[28:31], v61 offset:2048
v_mfma_f32_16x16x32_bf16 v[80:83], v[176:179], v[208:211], v[80:83]
ds_read_b64_tr_b16 v[32:33], v220 offset:36864
v_mfma_f32_16x16x32_bf16 v[84:87], v[176:179], v[212:215], v[84:87]
ds_read_b64_tr_b16 v[34:35], v220 offset:37888
v_mfma_f32_16x16x32_bf16 v[88:91], v[176:179], v[216:219], v[88:91]
ds_read_b64_tr_b16 v[36:37], v221 offset:36864
v_mfma_f32_16x16x32_bf16 v[92:95], v[180:183], v[192:195], v[92:95]
ds_read_b64_tr_b16 v[38:39], v221 offset:37888
v_mfma_f32_16x16x32_bf16 v[96:99], v[180:183], v[196:199], v[96:99]
ds_read_b64_tr_b16 v[40:41], v222 offset:36864
v_mfma_f32_16x16x32_bf16 v[100:103], v[180:183], v[200:203], v[100:103]
ds_read_b64_tr_b16 v[42:43], v222 offset:37888
v_mfma_f32_16x16x32_bf16 v[104:107], v[180:183], v[204:207], v[104:107]
ds_read_b64_tr_b16 v[44:45], v223 offset:36864
v_mfma_f32_16x16x32_bf16 v[108:111], v[180:183], v[208:211], v[108:111]
ds_read_b64_tr_b16 v[46:47], v223 offset:37888
v_mfma_f32_16x16x32_bf16 v[112:115], v[180:183], v[212:215], v[112:115]
ds_read_b64_tr_b16 v[48:49], v224 offset:36864
v_mfma_f32_16x16x32_bf16 v[116:119], v[180:183], v[216:219], v[116:119]
ds_read_b64_tr_b16 v[50:51], v224 offset:37888
v_mfma_f32_16x16x32_bf16 v[120:123], v[184:187], v[192:195], v[120:123]
ds_read_b64_tr_b16 v[52:53], v225 offset:36864
v_mfma_f32_16x16x32_bf16 v[124:127], v[184:187], v[196:199], v[124:127]
ds_read_b64_tr_b16 v[54:55], v225 offset:37888
v_mfma_f32_16x16x32_bf16 v[128:131], v[184:187], v[200:203], v[128:131]
ds_read_b64_tr_b16 v[56:57], v226 offset:36864
v_mfma_f32_16x16x32_bf16 v[132:135], v[184:187], v[204:207], v[132:135]
ds_read_b64_tr_b16 v[58:59], v226 offset:37888
v_mfma_f32_16x16x32_bf16 v[136:139], v[184:187], v[208:211], v[136:139]
v_mfma_f32_16x16x32_bf16 v[140:143], v[184:187], v[212:215], v[140:143]
v_mfma_f32_16x16x32_bf16 v[144:147], v[184:187], v[216:219], v[144:147]
v_mfma_f32_16x16x32_bf16 v[148:151], v[188:191], v[192:195], v[148:151]
v_mfma_f32_16x16x32_bf16 v[152:155], v[188:191], v[196:199], v[152:155]
v_mfma_f32_16x16x32_bf16 v[156:159], v[188:191], v[200:203], v[156:159]
v_mfma_f32_16x16x32_bf16 v[160:163], v[188:191], v[204:207], v[160:163]
v_mfma_f32_16x16x32_bf16 v[164:167], v[188:191], v[208:211], v[164:167]
v_mfma_f32_16x16x32_bf16 v[168:171], v[188:191], v[212:215], v[168:171]
v_mfma_f32_16x16x32_bf16 v[172:175], v[188:191], v[216:219], v[172:175]
s_waitcnt lgkmcnt(0)
s_waitcnt vmcnt(11)
s_barrier
v_add_u32 v5, 45056, v5
v_add_u32 v6, 45056, v6
v_add_u32 v7, 45056, v7
v_add_u32 v8, 45056, v8
v_add_u32 v60, 45056, v60
v_add_u32 v61, 45056, v61
v_add_u32 v220, 45056, v220
v_add_u32 v221, 45056, v221
v_add_u32 v222, 45056, v222
v_add_u32 v223, 45056, v223
v_add_u32 v224, 45056, v224
v_add_u32 v225, 45056, v225
v_add_u32 v226, 45056, v226
v_mfma_f32_16x16x32_bf16 v[64:67], v[16:19], v[32:35], v[64:67]
ds_read_b128 v[176:179], v7 offset:0
v_mfma_f32_16x16x32_bf16 v[68:71], v[16:19], v[36:39], v[68:71]
ds_read_b128 v[180:183], v7 offset:2048
v_mfma_f32_16x16x32_bf16 v[72:75], v[16:19], v[40:43], v[72:75]
ds_read_b128 v[184:187], v60 offset:0
v_mfma_f32_16x16x32_bf16 v[76:79], v[16:19], v[44:47], v[76:79]
ds_read_b128 v[188:191], v60 offset:2048
v_mfma_f32_16x16x32_bf16 v[80:83], v[16:19], v[48:51], v[80:83]
ds_read_b64_tr_b16 v[192:193], v220 offset:28672
v_mfma_f32_16x16x32_bf16 v[84:87], v[16:19], v[52:55], v[84:87]
ds_read_b64_tr_b16 v[194:195], v220 offset:29696
v_mfma_f32_16x16x32_bf16 v[88:91], v[16:19], v[56:59], v[88:91]
ds_read_b64_tr_b16 v[196:197], v221 offset:28672
v_mfma_f32_16x16x32_bf16 v[92:95], v[20:23], v[32:35], v[92:95]
ds_read_b64_tr_b16 v[198:199], v221 offset:29696
v_mfma_f32_16x16x32_bf16 v[96:99], v[20:23], v[36:39], v[96:99]
ds_read_b64_tr_b16 v[200:201], v222 offset:28672
v_mfma_f32_16x16x32_bf16 v[100:103], v[20:23], v[40:43], v[100:103]
ds_read_b64_tr_b16 v[202:203], v222 offset:29696
v_mfma_f32_16x16x32_bf16 v[104:107], v[20:23], v[44:47], v[104:107]
ds_read_b64_tr_b16 v[204:205], v223 offset:28672
v_mfma_f32_16x16x32_bf16 v[108:111], v[20:23], v[48:51], v[108:111]
ds_read_b64_tr_b16 v[206:207], v223 offset:29696
v_mfma_f32_16x16x32_bf16 v[112:115], v[20:23], v[52:55], v[112:115]
ds_read_b64_tr_b16 v[208:209], v224 offset:28672
v_mfma_f32_16x16x32_bf16 v[116:119], v[20:23], v[56:59], v[116:119]
ds_read_b64_tr_b16 v[210:211], v224 offset:29696
v_mfma_f32_16x16x32_bf16 v[120:123], v[24:27], v[32:35], v[120:123]
ds_read_b64_tr_b16 v[212:213], v225 offset:28672
v_mfma_f32_16x16x32_bf16 v[124:127], v[24:27], v[36:39], v[124:127]
ds_read_b64_tr_b16 v[214:215], v225 offset:29696
v_mfma_f32_16x16x32_bf16 v[128:131], v[24:27], v[40:43], v[128:131]
ds_read_b64_tr_b16 v[216:217], v226 offset:28672
v_mfma_f32_16x16x32_bf16 v[132:135], v[24:27], v[44:47], v[132:135]
ds_read_b64_tr_b16 v[218:219], v226 offset:29696
v_mfma_f32_16x16x32_bf16 v[136:139], v[24:27], v[48:51], v[136:139]
v_mfma_f32_16x16x32_bf16 v[140:143], v[24:27], v[52:55], v[140:143]
v_mfma_f32_16x16x32_bf16 v[144:147], v[24:27], v[56:59], v[144:147]
v_mfma_f32_16x16x32_bf16 v[148:151], v[28:31], v[32:35], v[148:151]
v_mfma_f32_16x16x32_bf16 v[152:155], v[28:31], v[36:39], v[152:155]
v_mfma_f32_16x16x32_bf16 v[156:159], v[28:31], v[40:43], v[156:159]
v_mfma_f32_16x16x32_bf16 v[160:163], v[28:31], v[44:47], v[160:163]
v_mfma_f32_16x16x32_bf16 v[164:167], v[28:31], v[48:51], v[164:167]
v_mfma_f32_16x16x32_bf16 v[168:171], v[28:31], v[52:55], v[168:171]
v_mfma_f32_16x16x32_bf16 v[172:175], v[28:31], v[56:59], v[172:175]
s_waitcnt lgkmcnt(0)
v_mfma_f32_16x16x32_bf16 v[64:67], v[176:179], v[192:195], v[64:67]
ds_read_b128 v[16:19], v8 offset:0
v_mfma_f32_16x16x32_bf16 v[68:71], v[176:179], v[196:199], v[68:71]
ds_read_b128 v[20:23], v8 offset:2048
v_mfma_f32_16x16x32_bf16 v[72:75], v[176:179], v[200:203], v[72:75]
ds_read_b128 v[24:27], v61 offset:0
v_mfma_f32_16x16x32_bf16 v[76:79], v[176:179], v[204:207], v[76:79]
ds_read_b128 v[28:31], v61 offset:2048
v_mfma_f32_16x16x32_bf16 v[80:83], v[176:179], v[208:211], v[80:83]
ds_read_b64_tr_b16 v[32:33], v220 offset:36864
v_mfma_f32_16x16x32_bf16 v[84:87], v[176:179], v[212:215], v[84:87]
ds_read_b64_tr_b16 v[34:35], v220 offset:37888
v_mfma_f32_16x16x32_bf16 v[88:91], v[176:179], v[216:219], v[88:91]
ds_read_b64_tr_b16 v[36:37], v221 offset:36864
v_mfma_f32_16x16x32_bf16 v[92:95], v[180:183], v[192:195], v[92:95]
ds_read_b64_tr_b16 v[38:39], v221 offset:37888
v_mfma_f32_16x16x32_bf16 v[96:99], v[180:183], v[196:199], v[96:99]
ds_read_b64_tr_b16 v[40:41], v222 offset:36864
v_mfma_f32_16x16x32_bf16 v[100:103], v[180:183], v[200:203], v[100:103]
ds_read_b64_tr_b16 v[42:43], v222 offset:37888
v_mfma_f32_16x16x32_bf16 v[104:107], v[180:183], v[204:207], v[104:107]
ds_read_b64_tr_b16 v[44:45], v223 offset:36864
v_mfma_f32_16x16x32_bf16 v[108:111], v[180:183], v[208:211], v[108:111]
ds_read_b64_tr_b16 v[46:47], v223 offset:37888
v_mfma_f32_16x16x32_bf16 v[112:115], v[180:183], v[212:215], v[112:115]
ds_read_b64_tr_b16 v[48:49], v224 offset:36864
v_mfma_f32_16x16x32_bf16 v[116:119], v[180:183], v[216:219], v[116:119]
ds_read_b64_tr_b16 v[50:51], v224 offset:37888
v_mfma_f32_16x16x32_bf16 v[120:123], v[184:187], v[192:195], v[120:123]
ds_read_b64_tr_b16 v[52:53], v225 offset:36864
v_mfma_f32_16x16x32_bf16 v[124:127], v[184:187], v[196:199], v[124:127]
ds_read_b64_tr_b16 v[54:55], v225 offset:37888
v_mfma_f32_16x16x32_bf16 v[128:131], v[184:187], v[200:203], v[128:131]
ds_read_b64_tr_b16 v[56:57], v226 offset:36864
v_mfma_f32_16x16x32_bf16 v[132:135], v[184:187], v[204:207], v[132:135]
ds_read_b64_tr_b16 v[58:59], v226 offset:37888
v_mfma_f32_16x16x32_bf16 v[136:139], v[184:187], v[208:211], v[136:139]
v_mfma_f32_16x16x32_bf16 v[140:143], v[184:187], v[212:215], v[140:143]
v_mfma_f32_16x16x32_bf16 v[144:147], v[184:187], v[216:219], v[144:147]
v_mfma_f32_16x16x32_bf16 v[148:151], v[188:191], v[192:195], v[148:151]
v_mfma_f32_16x16x32_bf16 v[152:155], v[188:191], v[196:199], v[152:155]
v_mfma_f32_16x16x32_bf16 v[156:159], v[188:191], v[200:203], v[156:159]
v_mfma_f32_16x16x32_bf16 v[160:163], v[188:191], v[204:207], v[160:163]
v_mfma_f32_16x16x32_bf16 v[164:167], v[188:191], v[208:211], v[164:167]
v_mfma_f32_16x16x32_bf16 v[168:171], v[188:191], v[212:215], v[168:171]
v_mfma_f32_16x16x32_bf16 v[172:175], v[188:191], v[216:219], v[172:175]
s_waitcnt lgkmcnt(0)
s_waitcnt vmcnt(0)
s_barrier
v_add_u32 v5, 4294877184, v5
v_add_u32 v6, 4294877184, v6
v_add_u32 v7, 4294877184, v7
v_add_u32 v8, 4294877184, v8
v_add_u32 v60, 4294877184, v60
v_add_u32 v61, 4294877184, v61
v_add_u32 v220, 4294877184, v220
v_add_u32 v221, 4294877184, v221
v_add_u32 v222, 4294877184, v222
v_add_u32 v223, 4294877184, v223
v_add_u32 v224, 4294877184, v224
v_add_u32 v225, 4294877184, v225
v_add_u32 v226, 4294877184, v226
v_mfma_f32_16x16x32_bf16 v[64:67], v[16:19], v[32:35], v[64:67]
ds_read_b128 v[176:179], v7 offset:0
v_mfma_f32_16x16x32_bf16 v[68:71], v[16:19], v[36:39], v[68:71]
ds_read_b128 v[180:183], v7 offset:2048
v_mfma_f32_16x16x32_bf16 v[72:75], v[16:19], v[40:43], v[72:75]
ds_read_b128 v[184:187], v60 offset:0
v_mfma_f32_16x16x32_bf16 v[76:79], v[16:19], v[44:47], v[76:79]
ds_read_b128 v[188:191], v60 offset:2048
v_mfma_f32_16x16x32_bf16 v[80:83], v[16:19], v[48:51], v[80:83]
ds_read_b64_tr_b16 v[192:193], v220 offset:28672
v_mfma_f32_16x16x32_bf16 v[84:87], v[16:19], v[52:55], v[84:87]
ds_read_b64_tr_b16 v[194:195], v220 offset:29696
v_mfma_f32_16x16x32_bf16 v[88:91], v[16:19], v[56:59], v[88:91]
ds_read_b64_tr_b16 v[196:197], v221 offset:28672
v_mfma_f32_16x16x32_bf16 v[92:95], v[20:23], v[32:35], v[92:95]
ds_read_b64_tr_b16 v[198:199], v221 offset:29696
v_mfma_f32_16x16x32_bf16 v[96:99], v[20:23], v[36:39], v[96:99]
ds_read_b64_tr_b16 v[200:201], v222 offset:28672
v_mfma_f32_16x16x32_bf16 v[100:103], v[20:23], v[40:43], v[100:103]
ds_read_b64_tr_b16 v[202:203], v222 offset:29696
v_mfma_f32_16x16x32_bf16 v[104:107], v[20:23], v[44:47], v[104:107]
ds_read_b64_tr_b16 v[204:205], v223 offset:28672
v_mfma_f32_16x16x32_bf16 v[108:111], v[20:23], v[48:51], v[108:111]
ds_read_b64_tr_b16 v[206:207], v223 offset:29696
v_mfma_f32_16x16x32_bf16 v[112:115], v[20:23], v[52:55], v[112:115]
ds_read_b64_tr_b16 v[208:209], v224 offset:28672
v_mfma_f32_16x16x32_bf16 v[116:119], v[20:23], v[56:59], v[116:119]
ds_read_b64_tr_b16 v[210:211], v224 offset:29696
v_mfma_f32_16x16x32_bf16 v[120:123], v[24:27], v[32:35], v[120:123]
ds_read_b64_tr_b16 v[212:213], v225 offset:28672
v_mfma_f32_16x16x32_bf16 v[124:127], v[24:27], v[36:39], v[124:127]
ds_read_b64_tr_b16 v[214:215], v225 offset:29696
v_mfma_f32_16x16x32_bf16 v[128:131], v[24:27], v[40:43], v[128:131]
ds_read_b64_tr_b16 v[216:217], v226 offset:28672
v_mfma_f32_16x16x32_bf16 v[132:135], v[24:27], v[44:47], v[132:135]
ds_read_b64_tr_b16 v[218:219], v226 offset:29696
v_mfma_f32_16x16x32_bf16 v[136:139], v[24:27], v[48:51], v[136:139]
v_mfma_f32_16x16x32_bf16 v[140:143], v[24:27], v[52:55], v[140:143]
v_mfma_f32_16x16x32_bf16 v[144:147], v[24:27], v[56:59], v[144:147]
v_mfma_f32_16x16x32_bf16 v[148:151], v[28:31], v[32:35], v[148:151]
v_mfma_f32_16x16x32_bf16 v[152:155], v[28:31], v[36:39], v[152:155]
v_mfma_f32_16x16x32_bf16 v[156:159], v[28:31], v[40:43], v[156:159]
v_mfma_f32_16x16x32_bf16 v[160:163], v[28:31], v[44:47], v[160:163]
v_mfma_f32_16x16x32_bf16 v[164:167], v[28:31], v[48:51], v[164:167]
v_mfma_f32_16x16x32_bf16 v[168:171], v[28:31], v[52:55], v[168:171]
v_mfma_f32_16x16x32_bf16 v[172:175], v[28:31], v[56:59], v[172:175]
s_waitcnt lgkmcnt(0)
v_mfma_f32_16x16x32_bf16 v[64:67], v[176:179], v[192:195], v[64:67]
ds_read_b128 v[16:19], v8 offset:0
v_mfma_f32_16x16x32_bf16 v[68:71], v[176:179], v[196:199], v[68:71]
ds_read_b128 v[20:23], v8 offset:2048
v_mfma_f32_16x16x32_bf16 v[72:75], v[176:179], v[200:203], v[72:75]
ds_read_b128 v[24:27], v61 offset:0
v_mfma_f32_16x16x32_bf16 v[76:79], v[176:179], v[204:207], v[76:79]
ds_read_b128 v[28:31], v61 offset:2048
v_mfma_f32_16x16x32_bf16 v[80:83], v[176:179], v[208:211], v[80:83]
ds_read_b64_tr_b16 v[32:33], v220 offset:36864
v_mfma_f32_16x16x32_bf16 v[84:87], v[176:179], v[212:215], v[84:87]
ds_read_b64_tr_b16 v[34:35], v220 offset:37888
v_mfma_f32_16x16x32_bf16 v[88:91], v[176:179], v[216:219], v[88:91]
ds_read_b64_tr_b16 v[36:37], v221 offset:36864
v_mfma_f32_16x16x32_bf16 v[92:95], v[180:183], v[192:195], v[92:95]
ds_read_b64_tr_b16 v[38:39], v221 offset:37888
v_mfma_f32_16x16x32_bf16 v[96:99], v[180:183], v[196:199], v[96:99]
ds_read_b64_tr_b16 v[40:41], v222 offset:36864
v_mfma_f32_16x16x32_bf16 v[100:103], v[180:183], v[200:203], v[100:103]
ds_read_b64_tr_b16 v[42:43], v222 offset:37888
v_mfma_f32_16x16x32_bf16 v[104:107], v[180:183], v[204:207], v[104:107]
ds_read_b64_tr_b16 v[44:45], v223 offset:36864
v_mfma_f32_16x16x32_bf16 v[108:111], v[180:183], v[208:211], v[108:111]
ds_read_b64_tr_b16 v[46:47], v223 offset:37888
v_mfma_f32_16x16x32_bf16 v[112:115], v[180:183], v[212:215], v[112:115]
ds_read_b64_tr_b16 v[48:49], v224 offset:36864
v_mfma_f32_16x16x32_bf16 v[116:119], v[180:183], v[216:219], v[116:119]
ds_read_b64_tr_b16 v[50:51], v224 offset:37888
v_mfma_f32_16x16x32_bf16 v[120:123], v[184:187], v[192:195], v[120:123]
ds_read_b64_tr_b16 v[52:53], v225 offset:36864
v_mfma_f32_16x16x32_bf16 v[124:127], v[184:187], v[196:199], v[124:127]
ds_read_b64_tr_b16 v[54:55], v225 offset:37888
v_mfma_f32_16x16x32_bf16 v[128:131], v[184:187], v[200:203], v[128:131]
ds_read_b64_tr_b16 v[56:57], v226 offset:36864
v_mfma_f32_16x16x32_bf16 v[132:135], v[184:187], v[204:207], v[132:135]
ds_read_b64_tr_b16 v[58:59], v226 offset:37888
v_mfma_f32_16x16x32_bf16 v[136:139], v[184:187], v[208:211], v[136:139]
v_mfma_f32_16x16x32_bf16 v[140:143], v[184:187], v[212:215], v[140:143]
v_mfma_f32_16x16x32_bf16 v[144:147], v[184:187], v[216:219], v[144:147]
v_mfma_f32_16x16x32_bf16 v[148:151], v[188:191], v[192:195], v[148:151]
v_mfma_f32_16x16x32_bf16 v[152:155], v[188:191], v[196:199], v[152:155]
v_mfma_f32_16x16x32_bf16 v[156:159], v[188:191], v[200:203], v[156:159]
v_mfma_f32_16x16x32_bf16 v[160:163], v[188:191], v[204:207], v[160:163]
v_mfma_f32_16x16x32_bf16 v[164:167], v[188:191], v[208:211], v[164:167]
v_mfma_f32_16x16x32_bf16 v[168:171], v[188:191], v[212:215], v[168:171]
v_mfma_f32_16x16x32_bf16 v[172:175], v[188:191], v[216:219], v[172:175]
s_waitcnt lgkmcnt(0)
v_mfma_f32_16x16x32_bf16 v[64:67], v[16:19], v[32:35], v[64:67]
v_mfma_f32_16x16x32_bf16 v[68:71], v[16:19], v[36:39], v[68:71]
v_mfma_f32_16x16x32_bf16 v[72:75], v[16:19], v[40:43], v[72:75]
v_mfma_f32_16x16x32_bf16 v[76:79], v[16:19], v[44:47], v[76:79]
v_mfma_f32_16x16x32_bf16 v[80:83], v[16:19], v[48:51], v[80:83]
v_mfma_f32_16x16x32_bf16 v[84:87], v[16:19], v[52:55], v[84:87]
v_mfma_f32_16x16x32_bf16 v[88:91], v[16:19], v[56:59], v[88:91]
v_mfma_f32_16x16x32_bf16 v[92:95], v[20:23], v[32:35], v[92:95]
v_mfma_f32_16x16x32_bf16 v[96:99], v[20:23], v[36:39], v[96:99]
v_mfma_f32_16x16x32_bf16 v[100:103], v[20:23], v[40:43], v[100:103]
v_mfma_f32_16x16x32_bf16 v[104:107], v[20:23], v[44:47], v[104:107]
v_mfma_f32_16x16x32_bf16 v[108:111], v[20:23], v[48:51], v[108:111]
v_mfma_f32_16x16x32_bf16 v[112:115], v[20:23], v[52:55], v[112:115]
v_mfma_f32_16x16x32_bf16 v[116:119], v[20:23], v[56:59], v[116:119]
v_mfma_f32_16x16x32_bf16 v[120:123], v[24:27], v[32:35], v[120:123]
v_mfma_f32_16x16x32_bf16 v[124:127], v[24:27], v[36:39], v[124:127]
v_mfma_f32_16x16x32_bf16 v[128:131], v[24:27], v[40:43], v[128:131]
v_mfma_f32_16x16x32_bf16 v[132:135], v[24:27], v[44:47], v[132:135]
v_mfma_f32_16x16x32_bf16 v[136:139], v[24:27], v[48:51], v[136:139]
v_mfma_f32_16x16x32_bf16 v[140:143], v[24:27], v[52:55], v[140:143]
v_mfma_f32_16x16x32_bf16 v[144:147], v[24:27], v[56:59], v[144:147]
v_mfma_f32_16x16x32_bf16 v[148:151], v[28:31], v[32:35], v[148:151]
v_mfma_f32_16x16x32_bf16 v[152:155], v[28:31], v[36:39], v[152:155]
v_mfma_f32_16x16x32_bf16 v[156:159], v[28:31], v[40:43], v[156:159]
v_mfma_f32_16x16x32_bf16 v[160:163], v[28:31], v[44:47], v[160:163]
v_mfma_f32_16x16x32_bf16 v[164:167], v[28:31], v[48:51], v[164:167]
v_mfma_f32_16x16x32_bf16 v[168:171], v[28:31], v[52:55], v[168:171]
v_mfma_f32_16x16x32_bf16 v[172:175], v[28:31], v[56:59], v[172:175]
s_mov_b32 s74, 1.0
LP_out:
s_nop 9
s_mul_i32 s75, s33, 6422528
s_mul_i32 s76, s34, 28
s_add_u32 s76, s76, s53
s_mul_i32 s76, s76, 14
s_mul_i32 s77, s48, 7
s_add_u32 s76, s76, s77
s_lshl1_add_u32 s76, s32, s76
s_lshl_b32 s76, s76, 10
s_add_u32 s75, s75, s76
s_lshr_b32 s70, s70, 2
v_mul_f32 v64, s74, v64
v_mul_f32 v65, s74, v65
v_mul_f32 v66, s74, v66
v_mul_f32 v67, s74, v67
v_cvt_pk_bf16_f32 v16, v64, v65
v_cvt_pk_bf16_f32 v17, v66, v67
v_mul_f32 v92, s74, v92
v_mul_f32 v93, s74, v93
v_mul_f32 v94, s74, v94
v_mul_f32 v95, s74, v95
v_cvt_pk_bf16_f32 v18, v92, v93
v_cvt_pk_bf16_f32 v19, v94, v95
s_add_u32 s78, s75, 0
buffer_store_dwordx4 v[16:19], v1, s[8:11], s78 offen sc1
v_mul_f32 v120, s74, v120
v_mul_f32 v121, s74, v121
v_mul_f32 v122, s74, v122
v_mul_f32 v123, s74, v123
v_cvt_pk_bf16_f32 v20, v120, v121
v_cvt_pk_bf16_f32 v21, v122, v123
v_mul_f32 v148, s74, v148
v_mul_f32 v149, s74, v149
v_mul_f32 v150, s74, v150
v_mul_f32 v151, s74, v151
v_cvt_pk_bf16_f32 v22, v148, v149
v_cvt_pk_bf16_f32 v23, v150, v151
s_add_u32 s78, s75, 0
s_add_u32 s78, s78, s70
buffer_store_dwordx4 v[20:23], v1, s[8:11], s78 offen sc1
v_mul_f32 v68, s74, v68
v_mul_f32 v69, s74, v69
v_mul_f32 v70, s74, v70
v_mul_f32 v71, s74, v71
v_cvt_pk_bf16_f32 v24, v68, v69
v_cvt_pk_bf16_f32 v25, v70, v71
v_mul_f32 v96, s74, v96
v_mul_f32 v97, s74, v97
v_mul_f32 v98, s74, v98
v_mul_f32 v99, s74, v99
v_cvt_pk_bf16_f32 v26, v96, v97
v_cvt_pk_bf16_f32 v27, v98, v99
s_add_u32 s78, s75, 14336
buffer_store_dwordx4 v[24:27], v1, s[8:11], s78 offen sc1
v_mul_f32 v124, s74, v124
v_mul_f32 v125, s74, v125
v_mul_f32 v126, s74, v126
v_mul_f32 v127, s74, v127
v_cvt_pk_bf16_f32 v28, v124, v125
v_cvt_pk_bf16_f32 v29, v126, v127
v_mul_f32 v152, s74, v152
v_mul_f32 v153, s74, v153
v_mul_f32 v154, s74, v154
v_mul_f32 v155, s74, v155
v_cvt_pk_bf16_f32 v30, v152, v153
v_cvt_pk_bf16_f32 v31, v154, v155
s_add_u32 s78, s75, 14336
s_add_u32 s78, s78, s70
buffer_store_dwordx4 v[28:31], v1, s[8:11], s78 offen sc1
v_mul_f32 v72, s74, v72
v_mul_f32 v73, s74, v73
v_mul_f32 v74, s74, v74
v_mul_f32 v75, s74, v75
v_cvt_pk_bf16_f32 v32, v72, v73
v_cvt_pk_bf16_f32 v33, v74, v75
v_mul_f32 v100, s74, v100
v_mul_f32 v101, s74, v101
v_mul_f32 v102, s74, v102
v_mul_f32 v103, s74, v103
v_cvt_pk_bf16_f32 v34, v100, v101
v_cvt_pk_bf16_f32 v35, v102, v103
s_add_u32 s78, s75, 28672
buffer_store_dwordx4 v[32:35], v1, s[8:11], s78 offen sc1
v_mul_f32 v128, s74, v128
v_mul_f32 v129, s74, v129
v_mul_f32 v130, s74, v130
v_mul_f32 v131, s74, v131
v_cvt_pk_bf16_f32 v36, v128, v129
v_cvt_pk_bf16_f32 v37, v130, v131
v_mul_f32 v156, s74, v156
v_mul_f32 v157, s74, v157
v_mul_f32 v158, s74, v158
v_mul_f32 v159, s74, v159
v_cvt_pk_bf16_f32 v38, v156, v157
v_cvt_pk_bf16_f32 v39, v158, v159
s_add_u32 s78, s75, 28672
s_add_u32 s78, s78, s70
buffer_store_dwordx4 v[36:39], v1, s[8:11], s78 offen sc1
v_mul_f32 v76, s74, v76
v_mul_f32 v77, s74, v77
v_mul_f32 v78, s74, v78
v_mul_f32 v79, s74, v79
v_cvt_pk_bf16_f32 v40, v76, v77
v_cvt_pk_bf16_f32 v41, v78, v79
v_mul_f32 v104, s74, v104
v_mul_f32 v105, s74, v105
v_mul_f32 v106, s74, v106
v_mul_f32 v107, s74, v107
v_cvt_pk_bf16_f32 v42, v104, v105
v_cvt_pk_bf16_f32 v43, v106, v107
s_add_u32 s78, s75, 43008
buffer_store_dwordx4 v[40:43], v1, s[8:11], s78 offen sc1
v_mul_f32 v132, s74, v132
v_mul_f32 v133, s74, v133
v_mul_f32 v134, s74, v134
v_mul_f32 v135, s74, v135
v_cvt_pk_bf16_f32 v44, v132, v133
v_cvt_pk_bf16_f32 v45, v134, v135
v_mul_f32 v160, s74, v160
v_mul_f32 v161, s74, v161
v_mul_f32 v162, s74, v162
v_mul_f32 v163, s74, v163
v_cvt_pk_bf16_f32 v46, v160, v161
v_cvt_pk_bf16_f32 v47, v162, v163
s_add_u32 s78, s75, 43008
s_add_u32 s78, s78, s70
buffer_store_dwordx4 v[44:47], v1, s[8:11], s78 offen sc1
v_mul_f32 v80, s74, v80
v_mul_f32 v81, s74, v81
v_mul_f32 v82, s74, v82
v_mul_f32 v83, s74, v83
v_cvt_pk_bf16_f32 v16, v80, v81
v_cvt_pk_bf16_f32 v17, v82, v83
v_mul_f32 v108, s74, v108
v_mul_f32 v109, s74, v109
v_mul_f32 v110, s74, v110
v_mul_f32 v111, s74, v111
v_cvt_pk_bf16_f32 v18, v108, v109
v_cvt_pk_bf16_f32 v19, v110, v111
s_add_u32 s78, s75, 57344
buffer_store_dwordx4 v[16:19], v1, s[8:11], s78 offen sc1
v_mul_f32 v136, s74, v136
v_mul_f32 v137, s74, v137
v_mul_f32 v138, s74, v138
v_mul_f32 v139, s74, v139
v_cvt_pk_bf16_f32 v20, v136, v137
v_cvt_pk_bf16_f32 v21, v138, v139
v_mul_f32 v164, s74, v164
v_mul_f32 v165, s74, v165
v_mul_f32 v166, s74, v166
v_mul_f32 v167, s74, v167
v_cvt_pk_bf16_f32 v22, v164, v165
v_cvt_pk_bf16_f32 v23, v166, v167
s_add_u32 s78, s75, 57344
s_add_u32 s78, s78, s70
buffer_store_dwordx4 v[20:23], v1, s[8:11], s78 offen sc1
v_mul_f32 v84, s74, v84
v_mul_f32 v85, s74, v85
v_mul_f32 v86, s74, v86
v_mul_f32 v87, s74, v87
v_cvt_pk_bf16_f32 v24, v84, v85
v_cvt_pk_bf16_f32 v25, v86, v87
v_mul_f32 v112, s74, v112
v_mul_f32 v113, s74, v113
v_mul_f32 v114, s74, v114
v_mul_f32 v115, s74, v115
v_cvt_pk_bf16_f32 v26, v112, v113
v_cvt_pk_bf16_f32 v27, v114, v115
s_add_u32 s78, s75, 71680
buffer_store_dwordx4 v[24:27], v1, s[8:11], s78 offen sc1
v_mul_f32 v140, s74, v140
v_mul_f32 v141, s74, v141
v_mul_f32 v142, s74, v142
v_mul_f32 v143, s74, v143
v_cvt_pk_bf16_f32 v28, v140, v141
v_cvt_pk_bf16_f32 v29, v142, v143
v_mul_f32 v168, s74, v168
v_mul_f32 v169, s74, v169
v_mul_f32 v170, s74, v170
v_mul_f32 v171, s74, v171
v_cvt_pk_bf16_f32 v30, v168, v169
v_cvt_pk_bf16_f32 v31, v170, v171
s_add_u32 s78, s75, 71680
s_add_u32 s78, s78, s70
buffer_store_dwordx4 v[28:31], v1, s[8:11], s78 offen sc1
v_mul_f32 v88, s74, v88
v_mul_f32 v89, s74, v89
v_mul_f32 v90, s74, v90
v_mul_f32 v91, s74, v91
v_cvt_pk_bf16_f32 v32, v88, v89
v_cvt_pk_bf16_f32 v33, v90, v91
v_mul_f32 v116, s74, v116
v_mul_f32 v117, s74, v117
v_mul_f32 v118, s74, v118
v_mul_f32 v119, s74, v119
v_cvt_pk_bf16_f32 v34, v116, v117
v_cvt_pk_bf16_f32 v35, v118, v119
s_add_u32 s78, s75, 86016
buffer_store_dwordx4 v[32:35], v1, s[8:11], s78 offen sc1
v_mul_f32 v144, s74, v144
v_mul_f32 v145, s74, v145
v_mul_f32 v146, s74, v146
v_mul_f32 v147, s74, v147
v_cvt_pk_bf16_f32 v36, v144, v145
v_cvt_pk_bf16_f32 v37, v146, v147
v_mul_f32 v172, s74, v172
v_mul_f32 v173, s74, v173
v_mul_f32 v174, s74, v174
v_mul_f32 v175, s74, v175
v_cvt_pk_bf16_f32 v38, v172, v173
v_cvt_pk_bf16_f32 v39, v174, v175
s_add_u32 s78, s75, 86016
s_add_u32 s78, s78, s70
buffer_store_dwordx4 v[36:39], v1, s[8:11], s78 offen sc1
s_mov_b32 s12, s4
s_mov_b32 s13, s5
s_mov_b32 s14, 256
s_mov_b32 s15, 0x20000
s_mov_b32 s33, s89
s_mov_b32 s36, 1048576
s_mov_b32 s37, 0
s_mov_b32 s34, 0
v_and_b32 v4, 7, v0
v_lshlrev_b32 v4, 5, v4
buffer_load_dword v5, v4, s[12:15], 0 offen sc1
v_mov_b32 v3, 0
s_cmp_lg_u32 s32, 0
s_cbranch_scc1 L_tk
v_readfirstlane_b32 s41, v227
s_mov_b64 exec, 1
s_cmp_lt_u32 s41, 32
s_cbranch_scc1 L_tk1
v_mov_b32 v227, 1
buffer_atomic_add v227, off, s[12:15], 0 offset:4 sc0 sc1
s_waitcnt vmcnt(0)
v_add_u32 v227, 32, v227
L_tk1:
ds_write_b32 v3, v227 offset:65532
s_mov_b64 exec, -1
L_tk:
s_waitcnt vmcnt(0) lgkmcnt(0)
s_barrier
v_mov_b32 v2, 1
buffer_store_dword v2, off, s[8:11], s88 sc1
ds_read_b32 v1, v3 offset:65532
s_waitcnt lgkmcnt(0)
v_readfirstlane_b32 s34, v1
s_barrier
s_branch L_cnt1
L_cnt:
s_sub_u32 s36, s36, 1
s_cbranch_scc1 L_timeout_13
buffer_load_dword v5, v4, s[12:15], 0 offen sc1
s_waitcnt vmcnt(0)
L_cnt1:
s_mov_b32 s40, 0
v_readlane_b32 s48, v5, 0
v_readlane_b32 s49, v5, 1
v_readlane_b32 s50, v5, 2
v_readlane_b32 s51, v5, 3
v_readlane_b32 s52, v5, 4
v_readlane_b32 s53, v5, 5
v_readlane_b32 s54, v5, 6
v_readlane_b32 s55, v5, 7
s_add_u32 s40, s40, s48
s_add_u32 s40, s40, s49
s_add_u32 s40, s40, s50
s_add_u32 s40, s40, s51
s_add_u32 s40, s40, s52
s_add_u32 s40, s40, s53
s_add_u32 s40, s40, s54
s_add_u32 s40, s40, s55
s_cmp_lt_u32 s40, 256
s_cbranch_scc1 L_cnt
s_cmp_lt_u32 s34, 32
s_cbranch_scc1 L_role_known
s_sub_u32 s41, s34, 32
s_min_u32 s42, s48, 32
s_sub_u32 s43, 32, s42
s_mov_b32 s33, 0
s_add_u32 s34, s42, s41
s_cmp_lt_u32 s41, s43
s_cbranch_scc1 L_role_known
s_sub_u32 s41, s41, s43
s_min_u32 s42, s49, 32
s_sub_u32 s43, 32, s42
s_mov_b32 s33, 1
s_add_u32 s34, s42, s41
s_cmp_lt_u32 s41, s43
s_cbranch_scc1 L_role_known
s_sub_u32 s41, s41, s43
s_min_u32 s42, s50, 32
s_sub_u32 s43, 32, s42
s_mov_b32 s33, 2
s_add_u32 s34, s42, s41
s_cmp_lt_u32 s41, s43
s_cbranch_scc1 L_role_known
s_sub_u32 s41, s41, s43
s_min_u32 s42, s51, 32
s_sub_u32 s43, 32, s42
s_mov_b32 s33, 3
s_add_u32 s34, s42, s41
s_cmp_lt_u32 s41, s43
s_cbranch_scc1 L_role_known
s_sub_u32 s41, s41, s43
s_min_u32 s42, s52, 32
s_sub_u32 s43, 32, s42
s_mov_b32 s33, 4
s_add_u32 s34, s42, s41
s_cmp_lt_u32 s41, s43
s_cbranch_scc1 L_role_known
s_sub_u32 s41, s41, s43
s_min_u32 s42, s53, 32
s_sub_u32 s43, 32, s42
s_mov_b32 s33, 5
s_add_u32 s34, s42, s41
s_cmp_lt_u32 s41, s43
s_cbranch_scc1 L_role_known
s_sub_u32 s41, s41, s43
s_min_u32 s42, s54, 32
s_sub_u32 s43, 32, s42
s_mov_b32 s33, 6
s_add_u32 s34, s42, s41
s_cmp_lt_u32 s41, s43
s_cbranch_scc1 L_role_known
s_sub_u32 s41, s41, s43
s_min_u32 s42, s55, 32
s_sub_u32 s43, 32, s42
s_mov_b32 s33, 7
s_add_u32 s34, s42, s41
s_cmp_lt_u32 s41, s43
s_cbranch_scc1 L_role_known
s_sub_u32 s41, s41, s43
s_branch L_done
L_role_known:
v_readlane_b32 s41, v5, s33
s_nop 0
s_cmp_ge_u32 s41, 32
s_cselect_b32 s35, 1, 0
s_cmp_ge_u32 s33, 2
s_cbranch_scc1 L_tok
s_mov_b32 s101, s34
s_mov_b32 s38, s33
s_mul_i32 s56, s38, 163840
s_add_u32 s56, s56, 117178368
s_lshl_b32 s58, s38, 13
s_add_u32 s58, s58, 118538240
s_cmp_ge_u32 s34, 30
s_cbranch_scc1 L_roleH
s_cmp_eq_u32 s38, 0
s_cbranch_scc1 L_c1go
s_mov_b32 s40, 118562816
L_c1w:
buffer_load_dword v5, off, s[8:11], s40 sc1
s_sub_u32 s36, s36, 1
s_cbranch_scc1 L_timeout_15
s_sleep 16
s_waitcnt vmcnt(0)
v_cmp_ne_u32 vcc, 1, v5
s_nop 0
s_cbranch_vccnz L_c1w
L_c1go:
s_cmp_ge_u32 s34, 16
s_cbranch_scc1 L_roleB
L_roleA:
s_lshl_b32 s45, s34, 3
v_min_u32 v12, 7, v0
v_lshlrev_b32 v12, 7, v12
s_lshl_b32 s46, s45, 7
s_add_u32 s46, s46, 118571008
s_add_u32 s47, s46, 0
buffer_load_dword v8, v12, s[8:11], s47 offen sc1
s_branch Lwg_5
Lwf_4:
s_sleep 2
s_add_u32 s47, s46, 0
buffer_load_dword v8, v12, s[8:11], s47 offen sc1
s_sub_u32 s36, s36, 1
s_cbranch_scc1 L_timeout_14
Lwg_5:
s_waitcnt vmcnt(0)
v_cmp_ne_u32 vcc, 1, v8
s_nop 0
s_cbranch_vccnz Lwf_4
s_mul_i32 s59, s38, 1835008
s_add_u32 s59, s59, 20185088
s_and_b32 s42, s32, 1
s_mul_i32 s43, s32, 7
s_mul_i32 s44, s34, 28
s_add_u32 s44, s44, s43
s_add_u32 s60, s44, s42
s_mul_i32 s60, s60, 14336
s_mul_i32 s45, s42, 6
s_sub_u32 s45, 6, s45
s_add_u32 s61, s44, s45
s_mul_i32 s61, s61, 14336
s_add_u32 s62, s43, s42
s_lshr_b32 s62, s62, 1
s_add_u32 s63, s43, s45
s_lshr_b32 s63, s63, 1
s_lshl_b32 s46, s42, 3
v_and_b32 v12, 63, v0
v_lshlrev_b32 v1, 4, v12
v_and_b32 v4, 8, v12
v_cmp_eq_u32 vcc, 0, v4
v_mov_b32 v4, 0xeeee
v_mov_b32 v5, 0x4444
v_cndmask_b32 v2, v4, v5, vcc
v_and_b32 v3, 7, v12
v_lshlrev_b32 v3, 2, v3
s_mov_b32 s37, 0
s_lshl_b32 s48, s32, 1
s_add_u32 s48, s48, 0
s_sub_u32 s40, s48, 7
s_cmp_ge_u32 s48, 7
s_cselect_b32 s48, s40, s48
s_lshl_b32 s48, s48, 10
s_lshl_b32 s49, s32, 1
s_add_u32 s49, s49, 1
s_sub_u32 s40, s49, 7
s_cmp_ge_u32 s49, 7
s_cselect_b32 s49, s40, s49
s_lshl_b32 s49, s49, 10
s_lshl_b32 s50, s32, 1
s_add_u32 s50, s50, 2
s_sub_u32 s40, s50, 7
s_cmp_ge_u32 s50, 7
s_cselect_b32 s50, s40, s50
s_lshl_b32 s50, s50, 10
s_lshl_b32 s51, s32, 1
s_add_u32 s51, s51, 3
s_sub_u32 s40, s51, 7
s_cmp_ge_u32 s51, 7
s_cselect_b32 s51, s40, s51
s_lshl_b32 s51, s51, 10
s_lshl_b32 s52, s32, 1
s_add_u32 s52, s52, 4
s_sub_u32 s40, s52, 7
s_cmp_ge_u32 s52, 7
s_cselect_b32 s52, s40, s52
s_lshl_b32 s52, s52, 10
s_lshl_b32 s53, s32, 1
s_add_u32 s53, s53, 5
s_sub_u32 s40, s53, 7
s_cmp_ge_u32 s53, 7
s_cselect_b32 s53, s40, s53
s_lshl_b32 s53, s53, 10
s_lshl_b32 s54, s32, 1
s_add_u32 s54, s54, 6
s_sub_u32 s40, s54, 7
s_cmp_ge_u32 s54, 7
s_cselect_b32 s54, s40, s54
s_lshl_b32 s54, s54, 10
s_mov_b32 s78, s48
s_mov_b32 s79, s49
v_add_u32 v4, s48, v1
v_add_u32 v5, s50, v1
v_add_u32 v6, s51, v1
v_add_u32 v7, s52, v1
v_add_u32 v8, s53, v1
v_add_u32 v9, s54, v1
s_lshl_b32 s40, s48, 1
s_add_u32 s40, s40, s60
s_add_u32 s40, s40, 0
buffer_load_dwordx4 a[0:3], v1, s[8:11], s40 offen sc1
buffer_load_dwordx4 a[4:7], v1, s[8:11], s40 offen offset:1024 sc1
s_lshl_b32 s40, s49, 1
s_add_u32 s40, s40, s60
s_add_u32 s40, s40, 0
buffer_load_dwordx4 a[8:11], v1, s[8:11], s40 offen sc1
buffer_load_dwordx4 a[12:15], v1, s[8:11], s40 offen offset:1024 sc1
s_lshl_b32 s40, s50, 1
s_add_u32 s40, s40, s60
s_add_u32 s40, s40, 0
buffer_load_dwordx4 a[16:19], v1, s[8:11], s40 offen sc1
buffer_load_dwordx4 a[20:23], v1, s[8:11], s40 offen offset:1024 sc1
s_lshl_b32 s40, s51, 1
s_add_u32 s40, s40, s60
s_add_u32 s40, s40, 0
buffer_load_dwordx4 a[24:27], v1, s[8:11], s40 offen sc1
buffer_load_dwordx4 a[28:31], v1, s[8:11], s40 offen offset:1024 sc1
s_lshl_b32 s40, s52, 1
s_add_u32 s40, s40, s60
s_add_u32 s40, s40, 0
buffer_load_dwordx4 a[32:35], v1, s[8:11], s40 offen sc1
buffer_load_dwordx4 a[36:39], v1, s[8:11], s40 offen offset:1024 sc1
s_lshl_b32 s40, s53, 1
s_add_u32 s40, s40, s60
s_add_u32 s40, s40, 0
buffer_load_dwordx4 a[40:43], v1, s[8:11], s40 offen sc1
buffer_load_dwordx4 a[44:47], v1, s[8:11], s40 offen offset:1024 sc1
s_lshl_b32 s40, s54, 1
s_add_u32 s40, s40, s60
s_add_u32 s40, s40, 0
buffer_load_dwordx4 a[48:51], v1, s[8:11], s40 offen sc1
buffer_load_dwordx4 a[52:55], v1, s[8:11], s40 offen offset:1024 sc1
s_lshl_b32 s40, s48, 1
s_add_u32 s40, s40, s60
s_add_u32 s40, s40, 14336
buffer_load_dwordx4 a[56:59], v1, s[8:11], s40 offen sc1
buffer_load_dwordx4 a[60:63], v1, s[8:11], s40 offen offset:1024 sc1
s_lshl_b32 s40, s49, 1
s_add_u32 s40, s40, s60
s_add_u32 s40, s40, 14336
buffer_load_dwordx4 a[64:67], v1, s[8:11], s40 offen sc1
buffer_load_dwordx4 a[68:71], v1, s[8:11], s40 offen offset:1024 sc1
s_lshl_b32 s40, s50, 1
s_add_u32 s40, s40, s60
s_add_u32 s40, s40, 14336
buffer_load_dwordx4 a[72:75], v1, s[8:11], s40 offen sc1
buffer_load_dwordx4 a[76:79], v1, s[8:11], s40 offen offset:1024 sc1
s_lshl_b32 s40, s51, 1
s_add_u32 s40, s40, s60
s_add_u32 s40, s40, 14336
buffer_load_dwordx4 a[80:83], v1, s[8:11], s40 offen sc1
buffer_load_dwordx4 a[84:87], v1, s[8:11], s40 offen offset:1024 sc1
s_lshl_b32 s40, s52, 1
s_add_u32 s40, s40, s60
s_add_u32 s40, s40, 14336
buffer_load_dwordx4 a[88:91], v1, s[8:11], s40 offen sc1
buffer_load_dwordx4 a[92:95], v1, s[8:11], s40 offen offset:1024 sc1
s_lshl_b32 s40, s53, 1
s_add_u32 s40, s40, s60
s_add_u32 s40, s40, 14336
buffer_load_dwordx4 a[96:99], v1, s[8:11], s40 offen sc1
buffer_load_dwordx4 a[100:103], v1, s[8:11], s40 offen offset:1024 sc1
s_lshl_b32 s40, s54, 1
s_add_u32 s40, s40, s60
s_add_u32 s40, s40, 14336
buffer_load_dwordx4 a[104:107], v1, s[8:11], s40 offen sc1
buffer_load_dwordx4 a[108:111], v1, s[8:11], s40 offen offset:1024 sc1
s_lshl_b32 s40, s48, 1
s_add_u32 s40, s40, s60
s_add_u32 s40, s40, 28672
buffer_load_dwordx4 a[112:115], v1, s[8:11], s40 offen sc1
buffer_load_dwordx4 a[116:119], v1, s[8:11], s40 offen offset:1024 sc1
s_lshl_b32 s40, s49, 1
s_add_u32 s40, s40, s60
s_add_u32 s40, s40, 28672
buffer_load_dwordx4 a[120:123], v1, s[8:11], s40 offen sc1
buffer_load_dwordx4 a[124:127], v1, s[8:11], s40 offen offset:1024 sc1
s_lshl_b32 s40, s50, 1
s_add_u32 s40, s40, s60
s_add_u32 s40, s40, 28672
buffer_load_dwordx4 a[128:131], v1, s[8:11], s40 offen sc1
buffer_load_dwordx4 a[132:135], v1, s[8:11], s40 offen offset:1024 sc1
s_lshl_b32 s40, s51, 1
s_add_u32 s40, s40, s60
s_add_u32 s40, s40, 28672
buffer_load_dwordx4 a[136:139], v1, s[8:11], s40 offen sc1
buffer_load_dwordx4 a[140:143], v1, s[8:11], s40 offen offset:1024 sc1
s_lshl_b32 s40, s52, 1
s_add_u32 s40, s40, s60
s_add_u32 s40, s40, 28672
buffer_load_dwordx4 a[144:147], v1, s[8:11], s40 offen sc1
buffer_load_dwordx4 a[148:151], v1, s[8:11], s40 offen offset:1024 sc1
s_lshl_b32 s40, s53, 1
s_add_u32 s40, s40, s60
s_add_u32 s40, s40, 28672
buffer_load_dwordx4 a[152:155], v1, s[8:11], s40 offen sc1
buffer_load_dwordx4 a[156:159], v1, s[8:11], s40 offen offset:1024 sc1
s_lshl_b32 s40, s54, 1
s_add_u32 s40, s40, s60
s_add_u32 s40, s40, 28672
buffer_load_dwordx4 a[160:163], v1, s[8:11], s40 offen sc1
buffer_load_dwordx4 a[164:167], v1, s[8:11], s40 offen offset:1024 sc1
s_lshl_b32 s40, s48, 1
s_add_u32 s40, s40, s60
s_add_u32 s40, s40, 43008
buffer_load_dwordx4 a[168:171], v1, s[8:11], s40 offen sc1
buffer_load_dwordx4 a[172:175], v1, s[8:11], s40 offen offset:1024 sc1
s_lshl_b32 s40, s49, 1
s_add_u32 s40, s40, s60
s_add_u32 s40, s40, 43008
buffer_load_dwordx4 a[176:179], v1, s[8:11], s40 offen sc1
buffer_load_dwordx4 a[180:183], v1, s[8:11], s40 offen offset:1024 sc1
s_lshl_b32 s40, s50, 1
s_add_u32 s40, s40, s60
s_add_u32 s40, s40, 43008
buffer_load_dwordx4 a[184:187], v1, s[8:11], s40 offen sc1
buffer_load_dwordx4 a[188:191], v1, s[8:11], s40 offen offset:1024 sc1
s_lshl_b32 s40, s51, 1
s_add_u32 s40, s40, s60
s_add_u32 s40, s40, 43008
buffer_load_dwordx4 a[192:195], v1, s[8:11], s40 offen sc1
buffer_load_dwordx4 a[196:199], v1, s[8:11], s40 offen offset:1024 sc1
s_lshl_b32 s40, s52, 1
s_add_u32 s40, s40, s60
s_add_u32 s40, s40, 43008
buffer_load_dwordx4 a[200:203], v1, s[8:11], s40 offen sc1
buffer_load_dwordx4 a[204:207], v1, s[8:11], s40 offen offset:1024 sc1
s_lshl_b32 s40, s53, 1
s_add_u32 s40, s40, s60
s_add_u32 s40, s40, 43008
buffer_load_dwordx4 a[208:211], v1, s[8:11], s40 offen sc1
buffer_load_dwordx4 a[212:215], v1, s[8:11], s40 offen offset:1024 sc1
s_lshl_b32 s40, s54, 1
s_add_u32 s40, s40, s60
s_add_u32 s40, s40, 43008
buffer_load_dwordx4 a[216:219], v1, s[8:11], s40 offen sc1
buffer_load_dwordx4 a[220:223], v1, s[8:11], s40 offen offset:1024 sc1
s_waitcnt vmcnt(42)
s_lshl_b32 s40, s48, 1
s_add_u32 s40, s40, s60
s_add_u32 s40, s40, 57344
buffer_load_dwordx4 a[224:227], v1, s[8:11], s40 offen sc1
buffer_load_dwordx4 a[228:231], v1, s[8:11], s40 offen offset:1024 sc1
s_lshl_b32 s40, s49, 1
s_add_u32 s40, s40, s60
s_add_u32 s40, s40, 57344
buffer_load_dwordx4 a[232:235], v1, s[8:11], s40 offen sc1
buffer_load_dwordx4 a[236:239], v1, s[8:11], s40 offen offset:1024 sc1
s_lshl_b32 s40, s50, 1
s_add_u32 s40, s40, s60
s_add_u32 s40, s40, 57344
buffer_load_dwordx4 a[240:243], v1, s[8:11], s40 offen sc1
buffer_load_dwordx4 a[244:247], v1, s[8:11], s40 offen offset:1024 sc1
s_lshl_b32 s40, s51, 1
s_add_u32 s40, s40, s60
s_add_u32 s40, s40, 57344
buffer_load_dwordx4 a[248:251], v1, s[8:11], s40 offen sc1
buffer_load_dwordx4 a[252:255], v1, s[8:11], s40 offen offset:1024 sc1
s_lshl_b32 s40, s52, 1
s_add_u32 s40, s40, s60
s_add_u32 s40, s40, 57344
buffer_load_dwordx4 v[120:123], v1, s[8:11], s40 offen sc1
buffer_load_dwordx4 v[124:127], v1, s[8:11], s40 offen offset:1024 sc1
s_lshl_b32 s40, s53, 1
s_add_u32 s40, s40, s60
s_add_u32 s40, s40, 57344
buffer_load_dwordx4 v[128:131], v1, s[8:11], s40 offen sc1
buffer_load_dwordx4 v[132:135], v1, s[8:11], s40 offen offset:1024 sc1
s_lshl_b32 s40, s54, 1
s_add_u32 s40, s40, s60
s_add_u32 s40, s40, 57344
buffer_load_dwordx4 v[136:139], v1, s[8:11], s40 offen sc1
buffer_load_dwordx4 v[140:143], v1, s[8:11], s40 offen offset:1024 sc1
s_waitcnt vmcnt(42)
s_lshl_b32 s40, s48, 1
s_add_u32 s40, s40, s60
s_add_u32 s40, s40, 71680
buffer_load_dwordx4 v[144:147], v1, s[8:11], s40 offen sc1
buffer_load_dwordx4 v[148:151], v1, s[8:11], s40 offen offset:1024 sc1
s_lshl_b32 s40, s49, 1
s_add_u32 s40, s40, s60
s_add_u32 s40, s40, 71680
buffer_load_dwordx4 v[152:155], v1, s[8:11], s40 offen sc1
buffer_load_dwordx4 v[156:159], v1, s[8:11], s40 offen offset:1024 sc1
s_lshl_b32 s40, s50, 1
s_add_u32 s40, s40, s60
s_add_u32 s40, s40, 71680
buffer_load_dwordx4 v[160:163], v1, s[8:11], s40 offen sc1
buffer_load_dwordx4 v[164:167], v1, s[8:11], s40 offen offset:1024 sc1
s_lshl_b32 s40, s51, 1
s_add_u32 s40, s40, s60
s_add_u32 s40, s40, 71680
buffer_load_dwordx4 v[168:171], v1, s[8:11], s40 offen sc1
buffer_load_dwordx4 v[172:175], v1, s[8:11], s40 offen offset:1024 sc1
s_lshl_b32 s40, s52, 1
s_add_u32 s40, s40, s60
s_add_u32 s40, s40, 71680
buffer_load_dwordx4 v[176:179], v1, s[8:11], s40 offen sc1
buffer_load_dwordx4 v[180:183], v1, s[8:11], s40 offen offset:1024 sc1
s_lshl_b32 s40, s53, 1
s_add_u32 s40, s40, s60
s_add_u32 s40, s40, 71680
buffer_load_dwordx4 v[184:187], v1, s[8:11], s40 offen sc1
buffer_load_dwordx4 v[188:191], v1, s[8:11], s40 offen offset:1024 sc1
s_lshl_b32 s40, s54, 1
s_add_u32 s40, s40, s60
s_add_u32 s40, s40, 71680
buffer_load_dwordx4 v[192:195], v1, s[8:11], s40 offen sc1
buffer_load_dwordx4 v[196:199], v1, s[8:11], s40 offen offset:1024 sc1
s_waitcnt vmcnt(42)
s_lshl_b32 s40, s48, 1
s_add_u32 s40, s40, s61
s_add_u32 s40, s40, 0
buffer_load_dwordx4 v[200:203], v1, s[8:11], s40 offen sc1
buffer_load_dwordx4 v[204:207], v1, s[8:11], s40 offen offset:1024 sc1
s_lshl_b32 s40, s49, 1
s_add_u32 s40, s40, s61
s_add_u32 s40, s40, 0
buffer_load_dwordx4 v[208:211], v1, s[8:11], s40 offen sc1
buffer_load_dwordx4 v[212:215], v1, s[8:11], s40 offen offset:1024 sc1
s_lshl_b32 s40, s50, 1
s_add_u32 s40, s40, s61
s_add_u32 s40, s40, 0
buffer_load_dwordx4 v[216:219], v1, s[8:11], s40 offen sc1
buffer_load_dwordx4 v[220:223], v1, s[8:11], s40 offen offset:1024 sc1
s_lshl_b32 s40, s51, 1
s_add_u32 s40, s40, s61
s_add_u32 s40, s40, 0
buffer_load_dwordx4 v[224:227], v1, s[8:11], s40 offen sc1
buffer_load_dwordx4 v[228:231], v1, s[8:11], s40 offen offset:1024 sc1
s_lshl_b32 s40, s52, 1
s_add_u32 s40, s40, s61
s_add_u32 s40, s40, 0
buffer_load_dwordx4 v[232:235], v1, s[8:11], s40 offen sc1
buffer_load_dwordx4 v[236:239], v1, s[8:11], s40 offen offset:1024 sc1
s_lshl_b32 s40, s53, 1
s_add_u32 s40, s40, s61
s_add_u32 s40, s40, 0
buffer_load_dwordx4 v[240:243], v1, s[8:11], s40 offen sc1
buffer_load_dwordx4 v[244:247], v1, s[8:11], s40 offen offset:1024 sc1
s_lshl_b32 s40, s54, 1
s_add_u32 s40, s40, s61
s_add_u32 s40, s40, 0
buffer_load_dwordx4 v[248:251], v1, s[8:11], s40 offen sc1
buffer_load_dwordx4 v[252:255], v1, s[8:11], s40 offen offset:1024 sc1
s_waitcnt vmcnt(42)
s_lshl_b32 s65, s62, 10
s_add_u32 s65, s65, s59
s_lshl_b32 s66, s63, 10
s_add_u32 s66, s66, s46
s_add_u32 s66, s66, s59
v_and_b32 v12, 63, v0
v_lshrrev_b32 v13, 4, v12
v_and_b32 v24, 15, v12
v_and_b32 v15, 7, v12
v_lshrrev_b32 v16, 5, v12
v_lshlrev_b32 v16, 8, v16
v_and_b32 v17, 1, v13
v_lshl_add_u32 v16, v17, 3, v16
v_lshl_add_u32 v16, v15, 4, v16
s_lshl_b32 s40, s62, 9
v_add_u32 v107, s40, v16
v_add_u32 v108, 1024, v107
s_lshl_b32 s40, s63, 9
s_lshr_b32 s41, s46, 1
s_add_u32 s40, s40, s41
v_add_u32 v109, s40, v16
s_mul_i32 s40, s32, 5376
s_add_u32 s40, s40, 8192
v_mul_u32_u24 v10, 192, v13
v_lshl_add_u32 v10, v24, 3, v10
v_add_u32 v10, s40, v10
v_and_b32 v16, 3, v12
v_mul_u32_u24 v11, 192, v16
v_lshrrev_b32 v16, 2, v12
v_lshl_add_u32 v11, v16, 3, v11
v_add_u32 v11, s40, v11
s_mul_i32 s40, s32, 3744
s_add_u32 s40, s40, 29696
v_mul_u32_u24 v110, 288, v13
v_lshl_add_u32 v110, v24, 4, v110
v_add_u32 v110, s40, v110
v_mov_b32 v16, 0xf149f2ca
v_mov_b32 v17, v16
v_mov_b32 v18, v16
v_mov_b32 v19, v16
ds_write_b128 v110, v[16:19] offset:2592
v_cmp_gt_u32 vcc, 10, v24
s_nop 1
v_cndmask_b32 v111, 0, 1.0, vcc
v_min_u32 v16, 12, v24
v_mul_u32_u24 v112, 288, v16
v_and_b32 v16, 1, v13
s_lshl_b32 s40, s32, 1
v_add_u32 v16, s40, v16
v_lshrrev_b32 v17, 5, v12
v_lshl_add_u32 v18, v17, 3, v16
v_lshl_add_u32 v112, v18, 4, v112
v_add_u32 v112, 29696, v112
s_lshr_b32 s40, s34, 2
s_mul_i32 s40, s40, 3072
s_and_b32 s41, s34, 3
s_lshl_b32 s42, s41, 9
s_add_u32 s42, s42, s40
s_lshr_b32 s43, s41, 1
s_lshl_b32 s43, s43, 9
s_add_u32 s43, s43, s40
s_add_u32 s43, s43, 2048
s_and_b32 s41, s41, 1
s_lshl2_add_u32 s43, s41, s43
v_bfe_u32 v19, v24, 1, 1
v_lshlrev_b32 v19, 8, v19
v_and_b32 v20, 1, v24
v_lshl_add_u32 v19, v20, 3, v19
v_add_u32 v21, s43, v19
v_bfe_u32 v20, v24, 2, 1
v_lshl_add_u32 v19, v20, 2, v19
v_add_u32 v19, s42, v19
v_cmp_gt_u32 vcc, 8, v24
s_nop 1
v_cndmask_b32 v19, v21, v19, vcc
v_lshl_add_u32 v113, v18, 4, v19
s_mul_i32 s40, s32, 1408
s_add_u32 s40, s40, s58
s_add_u32 s40, s40, 1024
s_lshl2_add_u32 s67, s34, s40
s_and_b32 s40, s34, 1
s_mul_i32 s40, s40, 1408
s_add_u32 s68, s58, s40
s_add_u32 s68, s68, 1152
s_mov_b32 s76, 0x0fff0fff
s_mov_b32 s77, 0x0fff0fff
s_mov_b32 s70, 0x1f800000
s_mov_b32 s71, 1073741824
v_min_u32 v3, 20, v3
v_and_b32 v16, 15, v0
v_cmp_gt_u32 vcc, 14, v16
v_lshlrev_b32 v16, 2, v16
s_nop 0
v_cndmask_b32 v106, 0, v16, vcc
s_add_u32 s68, s68, 128
v_lshrrev_b32 v16, 2, v1
v_min_u32 v106, 220, v16
s_waitcnt vmcnt(0) lgkmcnt(0)
s_barrier
LA_loop:
s_add_u32 s45, s37, 0
s_and_b32 s45, s45, 7
s_mul_i32 s57, s45, 20480
s_add_u32 s57, s57, s56
s_add_u32 s64, s57, 8192
s_add_u32 s40, s57, s78
s_add_u32 s41, s57, s79
s_add_u32 s51, s65, 14336
s_add_u32 s52, s66, 14336
s_add_u32 s69, s37, 1
v_mov_b32 v14, s69
v_mov_b64 v[44:45], 0
v_mov_b64 v[46:47], 0
v_mov_b64 v[48:49], 0
v_mov_b64 v[50:51], 0
v_mov_b64 v[52:53], 0
v_mov_b64 v[54:55], 0
v_mov_b64 v[56:57], 0
v_mov_b64 v[58:59], 0
v_mov_b64 v[60:61], 0
v_mov_b64 v[62:63], 0
v_mov_b64 v[64:65], 0
v_mov_b64 v[66:67], 0
v_mov_b64 v[68:69], 0
v_mov_b64 v[70:71], 0
s_cmp_lg_u32 s32, 0
s_cbranch_scc1 LA_go
Lrd_6:
buffer_load_dword v15, v3, s[8:11], s58 offen sc1
s_sub_u32 s36, s36, 1
s_cbranch_scc1 L_timeout_1
s_waitcnt vmcnt(0)
Lrd_7:
v_cmp_ge_u32 vcc, s37, v15
s_nop 0
s_cbranch_vccnz Lrd_6
buffer_load_dword v32, v106, s[8:11], s68 offen sc1
s_nop 11
buffer_load_dword v33, v106, s[8:11], s68 offen sc1
s_nop 11
buffer_load_dword v34, v106, s[8:11], s68 offen sc1
s_nop 11
buffer_load_dword v35, v106, s[8:11], s68 offen sc1
s_waitcnt vmcnt(3)
v_cmp_gt_u32 vcc, s37, v32
s_nop 0
s_cbranch_vccnz Lcm_11
Lcp_8:
s_nop 9
LA_go:
s_barrier
buffer_load_dwordx4 v[16:19], v1, s[8:11], s40 offen sc1
s_nop 11
buffer_load_dwordx4 v[20:23], v1, s[8:11], s41 offen sc1
s_waitcnt vmcnt(1)
Lpoll_12:
v_smfmac_f32_16x16x64_bf16 v[44:47], v[16:19], a[0:7], v2
ds_write_b128 v4, v[16:19] offset:0
v_smfmac_f32_16x16x64_bf16 v[48:51], v[16:19], a[56:63], v2
v_max3_u32 v12, v16, v17, v18
v_smfmac_f32_16x16x64_bf16 v[52:55], v[16:19], a[112:119], v2
v_smfmac_f32_16x16x64_bf16 v[56:59], v[16:19], a[168:175], v2
v_smfmac_f32_16x16x64_bf16 v[60:63], v[16:19], a[224:231], v2
s_waitcnt vmcnt(0)
ds_write_b128 v4, v[20:23] offset:1024
v_smfmac_f32_16x16x64_bf16 v[64:67], v[16:19], v[144:151], v2
v_max3_u32 v12, v12, v19, v20
v_smfmac_f32_16x16x64_bf16 v[68:71], v[16:19], v[200:207], v2
buffer_load_dwordx4 v[72:75], v1, s[8:11], s65 offen offset:0 sc1
v_max3_u32 v12, v12, v21, v22
v_smfmac_f32_16x16x64_bf16 v[44:47], v[20:23], a[8:15], v2
v_max_u32 v12, v12, v23
v_smfmac_f32_16x16x64_bf16 v[48:51], v[20:23], a[64:71], v2
v_cmp_eq_u32 vcc, -1, v12
v_smfmac_f32_16x16x64_bf16 v[52:55], v[20:23], a[120:127], v2
s_cbranch_vccnz Lre_13
s_waitcnt lgkmcnt(0)
s_barrier
ds_read_b128 v[24:27], v5 offset:0
ds_read_b128 v[28:31], v6 offset:0
v_smfmac_f32_16x16x64_bf16 v[56:59], v[20:23], a[176:183], v2
buffer_load_dwordx4 v[76:79], v1, s[8:11], s51 offen offset:0 sc1
ds_read_b128 v[32:35], v7 offset:0
v_smfmac_f32_16x16x64_bf16 v[60:63], v[20:23], a[232:239], v2
ds_read_b128 v[36:39], v8 offset:0
v_smfmac_f32_16x16x64_bf16 v[64:67], v[20:23], v[152:159], v2
ds_read_b128 v[40:43], v9 offset:0
v_smfmac_f32_16x16x64_bf16 v[68:71], v[20:23], v[208:215], v2
ds_read2_b32 v[100:101], v107 offset0:0 offset1:32
s_waitcnt lgkmcnt(5)
v_smfmac_f32_16x16x64_bf16 v[44:47], v[24:27], a[16:23], v2
buffer_load_dwordx4 v[80:83], v1, s[8:11], s65 offen offset:1024 sc1
ds_read2_b32 v[102:103], v107 offset0:1 offset1:33
v_smfmac_f32_16x16x64_bf16 v[48:51], v[24:27], a[72:79], v2
ds_read2_b32 v[104:105], v109 offset0:0 offset1:32
v_smfmac_f32_16x16x64_bf16 v[52:55], v[24:27], a[128:135], v2
v_smfmac_f32_16x16x64_bf16 v[56:59], v[24:27], a[184:191], v2
v_smfmac_f32_16x16x64_bf16 v[60:63], v[24:27], a[240:247], v2
buffer_load_dwordx4 v[84:87], v1, s[8:11], s51 offen offset:1024 sc1
v_smfmac_f32_16x16x64_bf16 v[64:67], v[24:27], v[160:167], v2
v_smfmac_f32_16x16x64_bf16 v[68:71], v[24:27], v[216:223], v2
s_waitcnt lgkmcnt(3)
v_smfmac_f32_16x16x64_bf16 v[44:47], v[28:31], a[24:31], v2
v_smfmac_f32_16x16x64_bf16 v[44:47], v[32:35], a[32:39], v2
buffer_load_dwordx4 v[88:91], v1, s[8:11], s65 offen offset:2048 sc1
v_smfmac_f32_16x16x64_bf16 v[44:47], v[36:39], a[40:47], v2
v_smfmac_f32_16x16x64_bf16 v[44:47], v[40:43], a[48:55], v2
v_smfmac_f32_16x16x64_bf16 v[48:51], v[28:31], a[80:87], v2
v_smfmac_f32_16x16x64_bf16 v[48:51], v[32:35], a[88:95], v2
v_cvt_pk_bf16_f32 v114, v44, v45
v_smfmac_f32_16x16x64_bf16 v[48:51], v[36:39], a[96:103], v2
v_cvt_pk_bf16_f32 v115, v46, v47
v_smfmac_f32_16x16x64_bf16 v[48:51], v[40:43], a[104:111], v2
ds_write_b64 v10, v[114:115] offset:0
v_smfmac_f32_16x16x64_bf16 v[52:55], v[28:31], a[136:143], v2
buffer_load_dwordx4 v[92:95], v1, s[8:11], s51 offen offset:2048 sc1
ds_read_b64_tr_b16 v[16:17], v11 offset:0
v_smfmac_f32_16x16x64_bf16 v[52:55], v[32:35], a[144:151], v2
v_cvt_pk_bf16_f32 v12, v48, v49
v_smfmac_f32_16x16x64_bf16 v[52:55], v[36:39], a[152:159], v2
v_cvt_pk_bf16_f32 v13, v50, v51
v_smfmac_f32_16x16x64_bf16 v[52:55], v[40:43], a[160:167], v2
ds_write_b64 v10, v[12:13] offset:768
v_smfmac_f32_16x16x64_bf16 v[56:59], v[28:31], a[192:199], v2
buffer_load_dwordx2 v[96:97], v1, s[8:11], s66 offen sc1
ds_read_b64_tr_b16 v[18:19], v11 offset:768
v_smfmac_f32_16x16x64_bf16 v[56:59], v[32:35], a[200:207], v2
v_cvt_pk_bf16_f32 v114, v52, v53
v_smfmac_f32_16x16x64_bf16 v[56:59], v[36:39], a[208:215], v2
v_cvt_pk_bf16_f32 v115, v54, v55
v_smfmac_f32_16x16x64_bf16 v[56:59], v[40:43], a[216:223], v2
ds_write_b64 v10, v[114:115] offset:1536
v_smfmac_f32_16x16x64_bf16 v[60:63], v[28:31], a[248:255], v2
buffer_load_dwordx2 v[98:99], v1, s[8:11], s52 offen sc1
ds_read_b64_tr_b16 v[20:21], v11 offset:1536
v_smfmac_f32_16x16x64_bf16 v[60:63], v[32:35], v[120:127], v2
v_cvt_pk_bf16_f32 v12, v56, v57
v_smfmac_f32_16x16x64_bf16 v[60:63], v[36:39], v[128:135], v2
v_cvt_pk_bf16_f32 v13, v58, v59
v_smfmac_f32_16x16x64_bf16 v[60:63], v[40:43], v[136:143], v2
ds_write_b64 v10, v[12:13] offset:2304
v_smfmac_f32_16x16x64_bf16 v[64:67], v[28:31], v[168:175], v2
ds_read_b64_tr_b16 v[22:23], v11 offset:2304
v_smfmac_f32_16x16x64_bf16 v[64:67], v[32:35], v[176:183], v2
v_cvt_pk_bf16_f32 v114, v60, v61
v_smfmac_f32_16x16x64_bf16 v[64:67], v[36:39], v[184:191], v2
v_cvt_pk_bf16_f32 v115, v62, v63
v_smfmac_f32_16x16x64_bf16 v[64:67], v[40:43], v[192:199], v2
ds_write_b64 v10, v[114:115] offset:3072
v_smfmac_f32_16x16x64_bf16 v[68:71], v[28:31], v[224:231], v2
ds_read_b64_tr_b16 v[24:25], v11 offset:3072
v_smfmac_f32_16x16x64_bf16 v[68:71], v[32:35], v[232:239], v2
v_cvt_pk_bf16_f32 v12, v64, v65
v_smfmac_f32_16x16x64_bf16 v[68:71], v[36:39], v[240:247], v2
v_cvt_pk_bf16_f32 v13, v66, v67
v_smfmac_f32_16x16x64_bf16 v[68:71], v[40:43], v[248:255], v2
ds_write_b64 v10, v[12:13] offset:3840
ds_read_b64_tr_b16 v[26:27], v11 offset:3840
ds_read2_b32 v[56:57], v107 offset0:128 offset1:160
s_waitcnt vmcnt(0) lgkmcnt(5)
v_mfma_f32_16x16x32_bf16 v[44:47], v[72:75], v[16:19], 0
ds_read2_b32 v[58:59], v107 offset0:129 offset1:161
s_nop 2
v_cvt_pk_bf16_f32 v114, v68, v69
v_cvt_pk_bf16_f32 v115, v70, v71
v_mfma_f32_16x16x32_bf16 v[48:51], v[76:79], v[16:19], 0
ds_write_b64 v10, v[114:115] offset:4608
ds_read_b64_tr_b16 v[116:117], v11 offset:4608
v_mfma_f32_16x16x32_bf16 v[52:55], v[100:103], v[16:19], 0
ds_read2_b32 v[60:61], v108 offset0:0 offset1:32
v_mfma_f32_16x16x32_bf16 v[44:47], v[80:83], v[20:23], v[44:47]
ds_read2_b32 v[62:63], v108 offset0:1 offset1:33
v_mfma_f32_16x16x32_bf16 v[48:51], v[84:87], v[20:23], v[48:51]
s_waitcnt lgkmcnt(4)
v_mfma_f32_16x16x32_bf16 v[52:55], v[56:59], v[20:23], v[52:55]
v_mfma_f32_16x16x32_bf16 v[44:47], v[88:91], v[24:27], v[44:47]
v_mfma_f32_16x16x32_bf16 v[48:51], v[92:95], v[24:27], v[48:51]
s_waitcnt lgkmcnt(0)
v_mfma_f32_16x16x32_bf16 v[52:55], v[60:63], v[24:27], v[52:55]
v_mfma_f32_16x16x16_bf16 v[44:47], v[96:97], v[116:117], v[44:47]
v_mfma_f32_16x16x16_bf16 v[48:51], v[98:99], v[116:117], v[48:51]
v_mfma_f32_16x16x16_bf16 v[52:55], v[104:105], v[116:117], v[52:55]
s_nop 0
ds_write_b128 v110, v[44:47]
s_nop 2
ds_write_b128 v110, v[48:51] offset:1152
s_nop 2
ds_write_b128 v110, v[52:55] offset:2304
s_waitcnt lgkmcnt(0)
s_barrier
ds_read_b128 v[16:19], v112 offset:0
ds_read_b128 v[20:23], v112 offset:3744
ds_read_b128 v[24:27], v112 offset:7488
ds_read_b128 v[28:31], v112 offset:11232
s_waitcnt lgkmcnt(2)
v_pk_add_f32 v[16:17], v[16:17], v[20:21]
v_pk_add_f32 v[18:19], v[18:19], v[22:23]
s_waitcnt lgkmcnt(0)
v_pk_add_f32 v[24:25], v[24:25], v[28:29]
v_pk_add_f32 v[26:27], v[26:27], v[30:31]
v_pk_add_f32 v[16:17], v[16:17], v[24:25]
v_pk_add_f32 v[18:19], v[18:19], v[26:27]
s_cmp_eq_u32 s35, 0
s_cbranch_scc1 Lsi_14
buffer_store_dword v14, off, s[8:11], s67
Lsj_15:
v_permlane32_swap_b32 v16, v18
v_permlane32_swap_b32 v17, v19
v_pk_add_f32 v[16:17], v[16:17], v[18:19]
v_exp_f32 v22, v16
v_exp_f32 v23, v17
s_nop 0
v_add_f32 v24, v22, v23
v_mul_f32 v20, v24, v111
v_mul_f32 v21, v24, v111
s_nop 1
v_permlane32_swap_b32 v20, v21
v_add_f32 v20, v20, v21
s_nop 1
v_add_f32_dpp v20, v20, v20 row_ror:8 row_mask:0xf bank_mask:0xf
s_nop 1
v_add_f32_dpp v20, v20, v20 row_ror:4 row_mask:0xf bank_mask:0xf
s_nop 1
v_add_f32_dpp v20, v20, v20 row_ror:2 row_mask:0xf bank_mask:0xf
s_nop 1
v_add_f32_dpp v20, v20, v20 row_ror:1 row_mask:0xf bank_mask:0xf
v_subrev_u32 v24, s70, v20
v_cmp_le_u32 vcc, s71, v24
v_rcp_f32 v21, v20
s_mov_b64 exec, s[76:77]
s_cmp_eq_u32 s35, 0
v_mul_f32 v22, v22, v21
v_mul_f32 v23, v23, v21
v_cvt_pk_bf16_f32 v22, v22, v23
v_min_u32 v114, -2, v22
s_cbranch_vccnz Lmx_16
Lsm_17:
s_cbranch_scc1 Lsi_18
buffer_store_dword v114, v113, s[8:11], s64 offen
Lsj_19:
s_mov_b64 exec, -1
s_add_u32 s65, s65, 28672
s_add_u32 s66, s66, 28672
s_add_u32 s37, s37, 1
s_cmp_lt_u32 s37, 63
s_cbranch_scc1 LA_loop
s_branch L_done
Lco_9:
s_branch Lcp_8
Lcm_11:
buffer_load_dword v32, v106, s[8:11], s68 offen sc1
s_waitcnt vmcnt(3)
v_cmp_gt_u32 vcc, s37, v33
s_nop 0
s_cbranch_vccz Lco_9
buffer_load_dword v33, v106, s[8:11], s68 offen sc1
s_waitcnt vmcnt(3)
v_cmp_gt_u32 vcc, s37, v34
s_nop 0
s_cbranch_vccz Lco_9
buffer_load_dword v34, v106, s[8:11], s68 offen sc1
s_waitcnt vmcnt(3)
v_cmp_gt_u32 vcc, s37, v35
s_nop 0
s_cbranch_vccz Lco_9
buffer_load_dword v35, v106, s[8:11], s68 offen sc1
Lcl_10:
s_sub_u32 s36, s36, 1
s_cbranch_scc1 L_timeout_6
s_waitcnt vmcnt(3)
v_cmp_gt_u32 vcc, s37, v32
s_nop 0
s_cbranch_vccz Lco_9
buffer_load_dword v32, v106, s[8:11], s68 offen sc1
s_waitcnt vmcnt(3)
v_cmp_gt_u32 vcc, s37, v33
s_nop 0
s_cbranch_vccz Lco_9
buffer_load_dword v33, v106, s[8:11], s68 offen sc1
s_waitcnt vmcnt(3)
v_cmp_gt_u32 vcc, s37, v34
s_nop 0
s_cbranch_vccz Lco_9
buffer_load_dword v34, v106, s[8:11], s68 offen sc1
s_waitcnt vmcnt(3)
v_cmp_gt_u32 vcc, s37, v35
s_nop 0
s_cbranch_vccz Lco_9
buffer_load_dword v35, v106, s[8:11], s68 offen sc1
s_branch Lcl_10
Lre_13:
buffer_load_dwordx4 v[16:19], v1, s[8:11], s40 offen sc1
s_nop 11
buffer_load_dwordx4 v[20:23], v1, s[8:11], s41 offen sc1
s_sub_u32 s36, s36, 1
s_cbranch_scc1 L_timeout_2
s_nop 7
v_mov_b64 v[44:45], 0
v_mov_b64 v[46:47], 0
v_mov_b64 v[48:49], 0
v_mov_b64 v[50:51], 0
v_mov_b64 v[52:53], 0
v_mov_b64 v[54:55], 0
v_mov_b64 v[56:57], 0
v_mov_b64 v[58:59], 0
v_mov_b64 v[60:61], 0
v_mov_b64 v[62:63], 0
v_mov_b64 v[64:65], 0
v_mov_b64 v[66:67], 0
v_mov_b64 v[68:69], 0
v_mov_b64 v[70:71], 0
s_waitcnt vmcnt(0)
s_branch Lpoll_12
Lsi_14:
buffer_store_dword v14, off, s[8:11], s67 sc1
s_branch Lsj_15
Lmx_16:
s_mov_b64 exec, -1
v_max_f32 v20, v16, v17
v_max_f32 v21, v16, v17
s_nop 1
v_permlane32_swap_b32 v20, v21
v_max_f32 v20, v20, v21
s_nop 1
v_max_f32_dpp v20, v20, v20 row_ror:8 row_mask:0xf bank_mask:0xf
s_nop 1
v_max_f32_dpp v20, v20, v20 row_ror:4 row_mask:0xf bank_mask:0xf
s_nop 1
v_max_f32_dpp v20, v20, v20 row_ror:2 row_mask:0xf bank_mask:0xf
s_nop 1
v_max_f32_dpp v20, v20, v20 row_ror:1 row_mask:0xf bank_mask:0xf
v_sub_f32 v16, v16, v20
v_sub_f32 v17, v17, v20
v_exp_f32 v22, v16
v_exp_f32 v23, v17
s_nop 0
v_add_f32 v24, v22, v23
v_mul_f32 v20, v24, v111
v_mul_f32 v21, v24, v111
s_nop 1
v_permlane32_swap_b32 v20, v21
v_add_f32 v20, v20, v21
s_nop 1
v_add_f32_dpp v20, v20, v20 row_ror:8 row_mask:0xf bank_mask:0xf
s_nop 1
v_add_f32_dpp v20, v20, v20 row_ror:4 row_mask:0xf bank_mask:0xf
s_nop 1
v_add_f32_dpp v20, v20, v20 row_ror:2 row_mask:0xf bank_mask:0xf
s_nop 1
v_add_f32_dpp v20, v20, v20 row_ror:1 row_mask:0xf bank_mask:0xf
v_rcp_f32 v21, v20
s_mov_b64 exec, s[76:77]
s_cmp_eq_u32 s35, 0
v_mul_f32 v22, v22, v21
v_mul_f32 v23, v23, v21
v_cvt_pk_bf16_f32 v22, v22, v23
v_min_u32 v114, -2, v22
s_branch Lsm_17
Lsi_18:
buffer_store_dword v114, v113, s[8:11], s64 offen sc1
s_branch Lsj_19
L_roleB:
s_lshl_b32 s45, s32, 5
s_add_u32 s45, s45, 128
v_min_u32 v12, 31, v0
v_lshlrev_b32 v12, 7, v12
s_lshl_b32 s46, s45, 7
s_add_u32 s46, s46, 118571008
s_add_u32 s47, s46, 0
buffer_load_dword v8, v12, s[8:11], s47 offen sc1
s_branch Lwg_21
Lwf_20:
s_sleep 2
s_add_u32 s47, s46, 0
buffer_load_dword v8, v12, s[8:11], s47 offen sc1
s_sub_u32 s36, s36, 1
s_cbranch_scc1 L_timeout_14
Lwg_21:
s_waitcnt vmcnt(0)
v_cmp_ne_u32 vcc, 1, v8
s_nop 0
s_cbranch_vccnz Lwf_20
s_sub_u32 s34, s34, 16
s_mul_i32 s59, s32, 112
s_lshl1_add_u32 s59, s34, s59
s_mul_i32 s59, s59, 14336
v_and_b32 v12, 63, v0
v_lshlrev_b32 v1, 4, v12
v_and_b32 v4, 8, v12
v_cmp_eq_u32 vcc, 0, v4
v_mov_b32 v4, 0xeeee
v_mov_b32 v5, 0x4444
v_cndmask_b32 v2, v4, v5, vcc
v_and_b32 v3, 7, v12
v_lshlrev_b32 v3, 2, v3
s_mov_b32 s37, 0
s_lshl_b32 s48, s32, 1
s_add_u32 s48, s48, 0
s_sub_u32 s40, s48, 7
s_cmp_ge_u32 s48, 7
s_cselect_b32 s48, s40, s48
s_lshl_b32 s48, s48, 10
s_lshl_b32 s49, s32, 1
s_add_u32 s49, s49, 1
s_sub_u32 s40, s49, 7
s_cmp_ge_u32 s49, 7
s_cselect_b32 s49, s40, s49
s_lshl_b32 s49, s49, 10
s_lshl_b32 s50, s32, 1
s_add_u32 s50, s50, 2
s_sub_u32 s40, s50, 7
s_cmp_ge_u32 s50, 7
s_cselect_b32 s50, s40, s50
s_lshl_b32 s50, s50, 10
s_lshl_b32 s51, s32, 1
s_add_u32 s51, s51, 3
s_sub_u32 s40, s51, 7
s_cmp_ge_u32 s51, 7
s_cselect_b32 s51, s40, s51
s_lshl_b32 s51, s51, 10
s_lshl_b32 s52, s32, 1
s_add_u32 s52, s52, 4
s_sub_u32 s40, s52, 7
s_cmp_ge_u32 s52, 7
s_cselect_b32 s52, s40, s52
s_lshl_b32 s52, s52, 10
s_lshl_b32 s53, s32, 1
s_add_u32 s53, s53, 5
s_sub_u32 s40, s53, 7
s_cmp_ge_u32 s53, 7
s_cselect_b32 s53, s40, s53
s_lshl_b32 s53, s53, 10
s_lshl_b32 s54, s32, 1
s_add_u32 s54, s54, 6
s_sub_u32 s40, s54, 7
s_cmp_ge_u32 s54, 7
s_cselect_b32 s54, s40, s54
s_lshl_b32 s54, s54, 10
s_mov_b32 s78, s48
s_mov_b32 s79, s49
v_add_u32 v4, s48, v1
v_add_u32 v5, s50, v1
v_add_u32 v6, s51, v1
v_add_u32 v7, s52, v1
v_add_u32 v8, s53, v1
v_add_u32 v9, s54, v1
s_lshl_b32 s40, s48, 1
s_add_u32 s40, s40, s59
s_add_u32 s40, s40, 6422528
buffer_load_dwordx4 a[0:3], v1, s[8:11], s40 offen sc1
buffer_load_dwordx4 a[4:7], v1, s[8:11], s40 offen offset:1024 sc1
s_lshl_b32 s40, s49, 1
s_add_u32 s40, s40, s59
s_add_u32 s40, s40, 6422528
buffer_load_dwordx4 a[8:11], v1, s[8:11], s40 offen sc1
buffer_load_dwordx4 a[12:15], v1, s[8:11], s40 offen offset:1024 sc1
s_lshl_b32 s40, s50, 1
s_add_u32 s40, s40, s59
s_add_u32 s40, s40, 6422528
buffer_load_dwordx4 a[16:19], v1, s[8:11], s40 offen sc1
buffer_load_dwordx4 a[20:23], v1, s[8:11], s40 offen offset:1024 sc1
s_lshl_b32 s40, s51, 1
s_add_u32 s40, s40, s59
s_add_u32 s40, s40, 6422528
buffer_load_dwordx4 a[24:27], v1, s[8:11], s40 offen sc1
buffer_load_dwordx4 a[28:31], v1, s[8:11], s40 offen offset:1024 sc1
s_lshl_b32 s40, s52, 1
s_add_u32 s40, s40, s59
s_add_u32 s40, s40, 6422528
buffer_load_dwordx4 a[32:35], v1, s[8:11], s40 offen sc1
buffer_load_dwordx4 a[36:39], v1, s[8:11], s40 offen offset:1024 sc1
s_lshl_b32 s40, s53, 1
s_add_u32 s40, s40, s59
s_add_u32 s40, s40, 6422528
buffer_load_dwordx4 a[40:43], v1, s[8:11], s40 offen sc1
buffer_load_dwordx4 a[44:47], v1, s[8:11], s40 offen offset:1024 sc1
s_lshl_b32 s40, s54, 1
s_add_u32 s40, s40, s59
s_add_u32 s40, s40, 6422528
buffer_load_dwordx4 a[48:51], v1, s[8:11], s40 offen sc1
buffer_load_dwordx4 a[52:55], v1, s[8:11], s40 offen offset:1024 sc1
s_lshl_b32 s40, s48, 1
s_add_u32 s40, s40, s59
s_add_u32 s40, s40, 6823936
buffer_load_dwordx4 a[56:59], v1, s[8:11], s40 offen sc1
buffer_load_dwordx4 a[60:63], v1, s[8:11], s40 offen offset:1024 sc1
s_lshl_b32 s40, s49, 1
s_add_u32 s40, s40, s59
s_add_u32 s40, s40, 6823936
buffer_load_dwordx4 a[64:67], v1, s[8:11], s40 offen sc1
buffer_load_dwordx4 a[68:71], v1, s[8:11], s40 offen offset:1024 sc1
s_lshl_b32 s40, s50, 1
s_add_u32 s40, s40, s59
s_add_u32 s40, s40, 6823936
buffer_load_dwordx4 a[72:75], v1, s[8:11], s40 offen sc1
buffer_load_dwordx4 a[76:79], v1, s[8:11], s40 offen offset:1024 sc1
s_lshl_b32 s40, s51, 1
s_add_u32 s40, s40, s59
s_add_u32 s40, s40, 6823936
buffer_load_dwordx4 a[80:83], v1, s[8:11], s40 offen sc1
buffer_load_dwordx4 a[84:87], v1, s[8:11], s40 offen offset:1024 sc1
s_lshl_b32 s40, s52, 1
s_add_u32 s40, s40, s59
s_add_u32 s40, s40, 6823936
buffer_load_dwordx4 a[88:91], v1, s[8:11], s40 offen sc1
buffer_load_dwordx4 a[92:95], v1, s[8:11], s40 offen offset:1024 sc1
s_lshl_b32 s40, s53, 1
s_add_u32 s40, s40, s59
s_add_u32 s40, s40, 6823936
buffer_load_dwordx4 a[96:99], v1, s[8:11], s40 offen sc1
buffer_load_dwordx4 a[100:103], v1, s[8:11], s40 offen offset:1024 sc1
s_lshl_b32 s40, s54, 1
s_add_u32 s40, s40, s59
s_add_u32 s40, s40, 6823936
buffer_load_dwordx4 a[104:107], v1, s[8:11], s40 offen sc1
buffer_load_dwordx4 a[108:111], v1, s[8:11], s40 offen offset:1024 sc1
s_lshl_b32 s40, s48, 1
s_add_u32 s40, s40, s59
s_add_u32 s40, s40, 7225344
buffer_load_dwordx4 a[112:115], v1, s[8:11], s40 offen sc1
buffer_load_dwordx4 a[116:119], v1, s[8:11], s40 offen offset:1024 sc1
s_lshl_b32 s40, s49, 1
s_add_u32 s40, s40, s59
s_add_u32 s40, s40, 7225344
buffer_load_dwordx4 a[120:123], v1, s[8:11], s40 offen sc1
buffer_load_dwordx4 a[124:127], v1, s[8:11], s40 offen offset:1024 sc1
s_lshl_b32 s40, s50, 1
s_add_u32 s40, s40, s59
s_add_u32 s40, s40, 7225344
buffer_load_dwordx4 a[128:131], v1, s[8:11], s40 offen sc1
buffer_load_dwordx4 a[132:135], v1, s[8:11], s40 offen offset:1024 sc1
s_lshl_b32 s40, s51, 1
s_add_u32 s40, s40, s59
s_add_u32 s40, s40, 7225344
buffer_load_dwordx4 a[136:139], v1, s[8:11], s40 offen sc1
buffer_load_dwordx4 a[140:143], v1, s[8:11], s40 offen offset:1024 sc1
s_lshl_b32 s40, s52, 1
s_add_u32 s40, s40, s59
s_add_u32 s40, s40, 7225344
buffer_load_dwordx4 a[144:147], v1, s[8:11], s40 offen sc1
buffer_load_dwordx4 a[148:151], v1, s[8:11], s40 offen offset:1024 sc1
s_lshl_b32 s40, s53, 1
s_add_u32 s40, s40, s59
s_add_u32 s40, s40, 7225344
buffer_load_dwordx4 a[152:155], v1, s[8:11], s40 offen sc1
buffer_load_dwordx4 a[156:159], v1, s[8:11], s40 offen offset:1024 sc1
s_lshl_b32 s40, s54, 1
s_add_u32 s40, s40, s59
s_add_u32 s40, s40, 7225344
buffer_load_dwordx4 a[160:163], v1, s[8:11], s40 offen sc1
buffer_load_dwordx4 a[164:167], v1, s[8:11], s40 offen offset:1024 sc1
s_lshl_b32 s40, s48, 1
s_add_u32 s40, s40, s59
s_add_u32 s40, s40, 7626752
buffer_load_dwordx4 a[168:171], v1, s[8:11], s40 offen sc1
buffer_load_dwordx4 a[172:175], v1, s[8:11], s40 offen offset:1024 sc1
s_lshl_b32 s40, s49, 1
s_add_u32 s40, s40, s59
s_add_u32 s40, s40, 7626752
buffer_load_dwordx4 a[176:179], v1, s[8:11], s40 offen sc1
buffer_load_dwordx4 a[180:183], v1, s[8:11], s40 offen offset:1024 sc1
s_lshl_b32 s40, s50, 1
s_add_u32 s40, s40, s59
s_add_u32 s40, s40, 7626752
buffer_load_dwordx4 a[184:187], v1, s[8:11], s40 offen sc1
buffer_load_dwordx4 a[188:191], v1, s[8:11], s40 offen offset:1024 sc1
s_lshl_b32 s40, s51, 1
s_add_u32 s40, s40, s59
s_add_u32 s40, s40, 7626752
buffer_load_dwordx4 a[192:195], v1, s[8:11], s40 offen sc1
buffer_load_dwordx4 a[196:199], v1, s[8:11], s40 offen offset:1024 sc1
s_lshl_b32 s40, s52, 1
s_add_u32 s40, s40, s59
s_add_u32 s40, s40, 7626752
buffer_load_dwordx4 a[200:203], v1, s[8:11], s40 offen sc1
buffer_load_dwordx4 a[204:207], v1, s[8:11], s40 offen offset:1024 sc1
s_lshl_b32 s40, s53, 1
s_add_u32 s40, s40, s59
s_add_u32 s40, s40, 7626752
buffer_load_dwordx4 a[208:211], v1, s[8:11], s40 offen sc1
buffer_load_dwordx4 a[212:215], v1, s[8:11], s40 offen offset:1024 sc1
s_lshl_b32 s40, s54, 1
s_add_u32 s40, s40, s59
s_add_u32 s40, s40, 7626752
buffer_load_dwordx4 a[216:219], v1, s[8:11], s40 offen sc1
buffer_load_dwordx4 a[220:223], v1, s[8:11], s40 offen offset:1024 sc1
s_waitcnt vmcnt(42)
s_lshl_b32 s40, s48, 1
s_add_u32 s40, s40, s59
s_add_u32 s40, s40, 6436864
buffer_load_dwordx4 a[224:227], v1, s[8:11], s40 offen sc1
buffer_load_dwordx4 a[228:231], v1, s[8:11], s40 offen offset:1024 sc1
s_lshl_b32 s40, s49, 1
s_add_u32 s40, s40, s59
s_add_u32 s40, s40, 6436864
buffer_load_dwordx4 a[232:235], v1, s[8:11], s40 offen sc1
buffer_load_dwordx4 a[236:239], v1, s[8:11], s40 offen offset:1024 sc1
s_lshl_b32 s40, s50, 1
s_add_u32 s40, s40, s59
s_add_u32 s40, s40, 6436864
buffer_load_dwordx4 a[240:243], v1, s[8:11], s40 offen sc1
buffer_load_dwordx4 a[244:247], v1, s[8:11], s40 offen offset:1024 sc1
s_lshl_b32 s40, s51, 1
s_add_u32 s40, s40, s59
s_add_u32 s40, s40, 6436864
buffer_load_dwordx4 a[248:251], v1, s[8:11], s40 offen sc1
buffer_load_dwordx4 a[252:255], v1, s[8:11], s40 offen offset:1024 sc1
s_lshl_b32 s40, s52, 1
s_add_u32 s40, s40, s59
s_add_u32 s40, s40, 6436864
buffer_load_dwordx4 v[120:123], v1, s[8:11], s40 offen sc1
buffer_load_dwordx4 v[124:127], v1, s[8:11], s40 offen offset:1024 sc1
s_lshl_b32 s40, s53, 1
s_add_u32 s40, s40, s59
s_add_u32 s40, s40, 6436864
buffer_load_dwordx4 v[128:131], v1, s[8:11], s40 offen sc1
buffer_load_dwordx4 v[132:135], v1, s[8:11], s40 offen offset:1024 sc1
s_lshl_b32 s40, s54, 1
s_add_u32 s40, s40, s59
s_add_u32 s40, s40, 6436864
buffer_load_dwordx4 v[136:139], v1, s[8:11], s40 offen sc1
buffer_load_dwordx4 v[140:143], v1, s[8:11], s40 offen offset:1024 sc1
s_waitcnt vmcnt(42)
s_lshl_b32 s40, s48, 1
s_add_u32 s40, s40, s59
s_add_u32 s40, s40, 6838272
buffer_load_dwordx4 v[144:147], v1, s[8:11], s40 offen sc1
buffer_load_dwordx4 v[148:151], v1, s[8:11], s40 offen offset:1024 sc1
s_lshl_b32 s40, s49, 1
s_add_u32 s40, s40, s59
s_add_u32 s40, s40, 6838272
buffer_load_dwordx4 v[152:155], v1, s[8:11], s40 offen sc1
buffer_load_dwordx4 v[156:159], v1, s[8:11], s40 offen offset:1024 sc1
s_lshl_b32 s40, s50, 1
s_add_u32 s40, s40, s59
s_add_u32 s40, s40, 6838272
buffer_load_dwordx4 v[160:163], v1, s[8:11], s40 offen sc1
buffer_load_dwordx4 v[164:167], v1, s[8:11], s40 offen offset:1024 sc1
s_lshl_b32 s40, s51, 1
s_add_u32 s40, s40, s59
s_add_u32 s40, s40, 6838272
buffer_load_dwordx4 v[168:171], v1, s[8:11], s40 offen sc1
buffer_load_dwordx4 v[172:175], v1, s[8:11], s40 offen offset:1024 sc1
s_lshl_b32 s40, s52, 1
s_add_u32 s40, s40, s59
s_add_u32 s40, s40, 6838272
buffer_load_dwordx4 v[176:179], v1, s[8:11], s40 offen sc1
buffer_load_dwordx4 v[180:183], v1, s[8:11], s40 offen offset:1024 sc1
s_lshl_b32 s40, s53, 1
s_add_u32 s40, s40, s59
s_add_u32 s40, s40, 6838272
buffer_load_dwordx4 v[184:187], v1, s[8:11], s40 offen sc1
buffer_load_dwordx4 v[188:191], v1, s[8:11], s40 offen offset:1024 sc1
s_lshl_b32 s40, s54, 1
s_add_u32 s40, s40, s59
s_add_u32 s40, s40, 6838272
buffer_load_dwordx4 v[192:195], v1, s[8:11], s40 offen sc1
buffer_load_dwordx4 v[196:199], v1, s[8:11], s40 offen offset:1024 sc1
s_waitcnt vmcnt(42)
s_lshl_b32 s40, s48, 1
s_add_u32 s40, s40, s59
s_add_u32 s40, s40, 7239680
buffer_load_dwordx4 v[200:203], v1, s[8:11], s40 offen sc1
buffer_load_dwordx4 v[204:207], v1, s[8:11], s40 offen offset:1024 sc1
s_lshl_b32 s40, s49, 1
s_add_u32 s40, s40, s59
s_add_u32 s40, s40, 7239680
buffer_load_dwordx4 v[208:211], v1, s[8:11], s40 offen sc1
buffer_load_dwordx4 v[212:215], v1, s[8:11], s40 offen offset:1024 sc1
s_lshl_b32 s40, s50, 1
s_add_u32 s40, s40, s59
s_add_u32 s40, s40, 7239680
buffer_load_dwordx4 v[216:219], v1, s[8:11], s40 offen sc1
buffer_load_dwordx4 v[220:223], v1, s[8:11], s40 offen offset:1024 sc1
s_lshl_b32 s40, s51, 1
s_add_u32 s40, s40, s59
s_add_u32 s40, s40, 7239680
buffer_load_dwordx4 v[224:227], v1, s[8:11], s40 offen sc1
buffer_load_dwordx4 v[228:231], v1, s[8:11], s40 offen offset:1024 sc1
s_lshl_b32 s40, s52, 1
s_add_u32 s40, s40, s59
s_add_u32 s40, s40, 7239680
buffer_load_dwordx4 v[232:235], v1, s[8:11], s40 offen sc1
buffer_load_dwordx4 v[236:239], v1, s[8:11], s40 offen offset:1024 sc1
s_lshl_b32 s40, s53, 1
s_add_u32 s40, s40, s59
s_add_u32 s40, s40, 7239680
buffer_load_dwordx4 v[240:243], v1, s[8:11], s40 offen sc1
buffer_load_dwordx4 v[244:247], v1, s[8:11], s40 offen offset:1024 sc1
s_lshl_b32 s40, s54, 1
s_add_u32 s40, s40, s59
s_add_u32 s40, s40, 7239680
buffer_load_dwordx4 v[248:251], v1, s[8:11], s40 offen sc1
buffer_load_dwordx4 v[252:255], v1, s[8:11], s40 offen offset:1024 sc1
s_waitcnt vmcnt(42)
s_or_b32 s40, s34, s32
s_or_b32 s40, s40, s38
s_cselect_b32 s40, 0x7ff00000, 0
s_or_b32 s40, s40, 118562816
v_mov_b32 v16, 1
buffer_store_dword v16, off, s[8:11], s40 sc1
s_mul_i32 s44, s32, 14336
s_add_u32 s44, s44, 16448
s_lshl_b32 s40, s48, 1
s_add_u32 s40, s40, s59
s_add_u32 s40, s40, 7641088
s_add_u32 m0, s44, 0
s_nop 0
buffer_load_dwordx4 v1, s[8:11], s40 offen sc1 lds
buffer_load_dwordx4 v1, s[8:11], s40 offen offset:1024 sc1 lds
s_lshl_b32 s40, s49, 1
s_add_u32 s40, s40, s59
s_add_u32 s40, s40, 7641088
s_add_u32 m0, s44, 2048
s_nop 0
buffer_load_dwordx4 v1, s[8:11], s40 offen sc1 lds
buffer_load_dwordx4 v1, s[8:11], s40 offen offset:1024 sc1 lds
s_lshl_b32 s40, s50, 1
s_add_u32 s40, s40, s59
s_add_u32 s40, s40, 7641088
s_add_u32 m0, s44, 4096
s_nop 0
buffer_load_dwordx4 v1, s[8:11], s40 offen sc1 lds
buffer_load_dwordx4 v1, s[8:11], s40 offen offset:1024 sc1 lds
s_lshl_b32 s40, s51, 1
s_add_u32 s40, s40, s59
s_add_u32 s40, s40, 7641088
s_add_u32 m0, s44, 6144
s_nop 0
buffer_load_dwordx4 v1, s[8:11], s40 offen sc1 lds
buffer_load_dwordx4 v1, s[8:11], s40 offen offset:1024 sc1 lds
s_lshl_b32 s40, s52, 1
s_add_u32 s40, s40, s59
s_add_u32 s40, s40, 7641088
s_add_u32 m0, s44, 8192
s_nop 0
buffer_load_dwordx4 v1, s[8:11], s40 offen sc1 lds
buffer_load_dwordx4 v1, s[8:11], s40 offen offset:1024 sc1 lds
s_lshl_b32 s40, s53, 1
s_add_u32 s40, s40, s59
s_add_u32 s40, s40, 7641088
s_add_u32 m0, s44, 10240
s_nop 0
buffer_load_dwordx4 v1, s[8:11], s40 offen sc1 lds
buffer_load_dwordx4 v1, s[8:11], s40 offen offset:1024 sc1 lds
s_lshl_b32 s40, s54, 1
s_add_u32 s40, s40, s59
s_add_u32 s40, s40, 7641088
s_add_u32 m0, s44, 12288
s_nop 0
buffer_load_dwordx4 v1, s[8:11], s40 offen sc1 lds
buffer_load_dwordx4 v1, s[8:11], s40 offen offset:1024 sc1 lds
v_and_b32 v16, 15, v0
v_cmp_gt_u32 vcc, 14, v16
v_lshlrev_b32 v16, 2, v16
s_nop 0
v_cndmask_b32 v117, 0, v16, vcc
v_add_u32 v119, s44, v1
s_and_b32 s45, s32, 1
s_mul_i32 s40, s38, 29360128
s_add_u32 s40, s40, 23855104
s_lshl_b32 s41, s32, 12
s_add_u32 s40, s40, s41
s_lshl_b32 s42, s34, 15
s_add_u32 s60, s40, s42
s_add_u32 s61, s60, 16384
s_mul_i32 s40, s38, 7340032
s_add_u32 s40, s40, 82575360
s_lshl_b32 s41, s32, 10
s_add_u32 s40, s40, s41
s_lshl_b32 s42, s34, 13
s_add_u32 s62, s40, s42
s_add_u32 s63, s62, 4096
s_mul_i32 s70, s32, 3072
s_add_u32 s70, s70, 8192
s_and_b32 s40, s34, 3
s_mul_i32 s68, s40, 1408
s_add_u32 s68, s68, s58
s_add_u32 s68, s68, 1024
s_add_u32 s67, s58, 4096
v_lshrrev_b32 v16, 2, v1
v_min_u32 v117, 220, v16
s_mul_i32 s40, s45, 1408
s_add_u32 s66, s58, s40
s_add_u32 s66, s66, 1152
s_lshl2_add_u32 s66, s34, s66
s_lshl2_add_u32 s74, s34, s32
s_lshl2_add_u32 s74, s74, s58
s_add_u32 s74, s74, 1280
s_add_u32 s75, s74, 4224
v_and_b32 v12, 63, v0
v_lshrrev_b32 v13, 4, v12
v_and_b32 v24, 15, v12
v_lshlrev_b32 v118, 2, v24
v_lshrrev_b32 v16, 5, v12
v_and_b32 v15, 1, v13
v_lshlrev_b32 v15, 2, v15
v_lshl_add_u32 v15, v16, 1, v15
v_and_b32 v17, 1, v24
v_add_u32 v15, v15, v17
s_lshl_b32 s40, s34, 4
s_lshl_b32 s41, s45, 1
s_add_u32 s40, s40, s41
v_lshrrev_b32 v17, 2, v24
v_lshlrev_b32 v17, 2, v17
v_bfe_u32 v18, v24, 1, 1
v_add3_u32 v17, v17, v18, s40
v_lshrrev_b32 v18, 3, v17
v_lshlrev_b32 v10, 8, v18
v_and_b32 v18, 1, v17
v_lshl_add_u32 v10, v18, 7, v10
v_lshl_add_u32 v10, v15, 4, v10
v_bfe_u32 v18, v17, 1, 2
v_lshl_add_u32 v10, v18, 2, v10
s_lshl_b32 s41, s32, 10
s_add_u32 s41, s41, 8192
v_add_u32 v11, s41, v1
s_lshl_b32 s40, s45, 12
s_add_u32 s40, s40, 8192
v_add_u32 v116, s40, v1
s_lshl_b32 s65, s32, 13
s_add_u32 s65, s65, 73792
v_add_u32 v0, s65, v1
s_mov_b32 s72, s62
s_mov_b32 s73, s63
s_waitcnt vmcnt(0)
LB_w0:
buffer_load_dword v15, off, s[8:11], s58 sc1
s_sub_u32 s36, s36, 1
s_cbranch_scc1 L_timeout_5
s_waitcnt vmcnt(0)
v_cmp_eq_u32 vcc, 0, v15
s_nop 0
s_cbranch_vccnz LB_w0
v_mov_b32 v12, 0
ds_write_b32 v12, v12 offset:16444
s_waitcnt lgkmcnt(0)
s_barrier
s_mov_b32 s64, s56
s_mov_b32 s57, s64
s_add_u32 s40, s57, s78
s_add_u32 s41, s57, s79
s_mov_b32 m0, s65
LB_loop:
v_mov_b32 v12, 0
ds_read_b32 v15, v12 offset:16444
buffer_load_dwordx4 v[16:19], v1, s[8:11], s40 offen sc1
buffer_load_dwordx4 v[20:23], v1, s[8:11], s41 offen sc1
s_waitcnt lgkmcnt(0)
v_readfirstlane_b32 s71, v15
s_nop 0
s_cmp_gt_u32 s71, s37
s_cselect_b32 s76, s60, 0x7ff00000
s_cselect_b32 s77, s61, 0x7ff00000
s_barrier
buffer_load_dwordx4 v1, s[8:11], s76 offen offset:0 sc1 lds
buffer_load_dwordx4 v1, s[8:11], s76 offen offset:1024 sc1 lds
buffer_load_dwordx4 v1, s[8:11], s76 offen offset:2048 sc1 lds
ds_read_b128 v[76:79], v119 offset:0
ds_read_b128 v[80:83], v119 offset:1024
ds_read_b128 v[84:87], v119 offset:2048
ds_read_b128 v[88:91], v119 offset:3072
ds_read_b128 v[92:95], v119 offset:4096
ds_read_b128 v[96:99], v119 offset:5120
s_add_u32 s45, s37, 1
s_and_b32 s45, s45, 7
s_mul_i32 s64, s45, 20480
s_add_u32 s64, s64, s56
s_add_u32 s47, s57, s70
s_add_u32 s69, s37, 1
v_mov_b32 v14, s69
v_pk_add_f32 v[44:45], v[44:45], v[52:53]
v_pk_add_f32 v[46:47], v[46:47], v[54:55]
v_cvt_pk_bf16_f32 v100, v44, v45
v_cvt_pk_bf16_f32 v101, v46, v47
v_pk_add_f32 v[48:49], v[48:49], v[56:57]
v_pk_add_f32 v[50:51], v[50:51], v[58:59]
v_cvt_pk_bf16_f32 v102, v48, v49
v_cvt_pk_bf16_f32 v103, v50, v51
v_pk_add_f32 v[60:61], v[60:61], v[68:69]
v_pk_add_f32 v[62:63], v[62:63], v[70:71]
v_cvt_pk_bf16_f32 v104, v60, v61
v_cvt_pk_bf16_f32 v105, v62, v63
v_pk_add_f32 v[64:65], v[64:65], v[72:73]
v_pk_add_f32 v[66:67], v[66:67], v[74:75]
v_cvt_pk_bf16_f32 v106, v64, v65
v_cvt_pk_bf16_f32 v107, v66, v67
v_permlane16_swap_b32 v100, v102
v_permlane16_swap_b32 v101, v103
v_permlane16_swap_b32 v104, v106
v_permlane16_swap_b32 v105, v107
v_mov_b64 v[44:45], 0
v_mov_b64 v[46:47], 0
v_mov_b64 v[48:49], 0
v_mov_b64 v[50:51], 0
v_mov_b64 v[52:53], 0
v_mov_b64 v[54:55], 0
v_mov_b64 v[56:57], 0
v_mov_b64 v[58:59], 0
v_mov_b64 v[60:61], 0
v_mov_b64 v[62:63], 0
v_mov_b64 v[64:65], 0
v_mov_b64 v[66:67], 0
v_mov_b64 v[68:69], 0
v_mov_b64 v[70:71], 0
v_mov_b64 v[72:73], 0
v_mov_b64 v[74:75], 0
s_waitcnt vmcnt(3)
Lpoll_22:
v_smfmac_f32_16x16x64_bf16 v[44:47], v[16:19], a[0:7], v2
ds_write_b128 v4, v[16:19] offset:0
v_smfmac_f32_16x16x64_bf16 v[48:51], v[16:19], a[56:63], v2
ds_write_b128 v4, v[20:23] offset:1024
v_smfmac_f32_16x16x64_bf16 v[52:55], v[16:19], a[112:119], v2
buffer_load_dwordx4 v1, s[8:11], s76 offen offset:3072 sc1 lds
s_add_u32 m0, s65, 4096
v_max3_u32 v12, v16, v17, v18
v_smfmac_f32_16x16x64_bf16 v[56:59], v[16:19], a[168:175], v2
v_max3_u32 v12, v12, v19, v20
v_smfmac_f32_16x16x64_bf16 v[60:63], v[16:19], a[224:231], v2
v_max3_u32 v12, v12, v21, v22
v_smfmac_f32_16x16x64_bf16 v[64:67], v[16:19], v[144:151], v2
buffer_load_dwordx4 v1, s[8:11], s77 offen offset:0 sc1 lds
v_max_u32 v12, v12, v23
v_smfmac_f32_16x16x64_bf16 v[68:71], v[16:19], v[200:207], v2
v_cmp_eq_u32 vcc, -1, v12
v_smfmac_f32_16x16x64_bf16 v[44:47], v[20:23], a[8:15], v2
v_smfmac_f32_16x16x64_bf16 v[48:51], v[20:23], a[64:71], v2
buffer_load_dwordx4 v1, s[8:11], s77 offen offset:1024 sc1 lds
s_cbranch_vccnz Lre_23
s_waitcnt lgkmcnt(0)
s_barrier
ds_read_b128 v[24:27], v5 offset:0
ds_read_b128 v[28:31], v6 offset:0
v_smfmac_f32_16x16x64_bf16 v[52:55], v[20:23], a[120:127], v2
ds_read_b128 v[32:35], v7 offset:0
v_smfmac_f32_16x16x64_bf16 v[56:59], v[20:23], a[176:183], v2
ds_read_b128 v[36:39], v8 offset:0
v_smfmac_f32_16x16x64_bf16 v[60:63], v[20:23], a[232:239], v2
buffer_load_dwordx4 v1, s[8:11], s77 offen offset:2048 sc1 lds
ds_read_b128 v[40:43], v9 offset:0
v_smfmac_f32_16x16x64_bf16 v[64:67], v[20:23], v[152:159], v2
v_smfmac_f32_16x16x64_bf16 v[68:71], v[20:23], v[208:215], v2
s_waitcnt lgkmcnt(4)
v_smfmac_f32_16x16x64_bf16 v[44:47], v[24:27], a[16:23], v2
buffer_load_dwordx4 v1, s[8:11], s77 offen offset:3072 sc1 lds
v_smfmac_f32_16x16x64_bf16 v[48:51], v[24:27], a[72:79], v2
v_smfmac_f32_16x16x64_bf16 v[52:55], v[24:27], a[128:135], v2
v_smfmac_f32_16x16x64_bf16 v[56:59], v[24:27], a[184:191], v2
buffer_store_dwordx4 v[100:103], v1, s[8:11], s72 offen sc1
v_smfmac_f32_16x16x64_bf16 v[60:63], v[24:27], a[240:247], v2
v_smfmac_f32_16x16x64_bf16 v[64:67], v[24:27], v[160:167], v2
v_smfmac_f32_16x16x64_bf16 v[68:71], v[24:27], v[216:223], v2
buffer_store_dwordx4 v[104:107], v1, s[8:11], s73 offen sc1
s_waitcnt lgkmcnt(0)
v_smfmac_f32_16x16x64_bf16 v[44:47], v[28:31], a[24:31], v2
v_smfmac_f32_16x16x64_bf16 v[72:75], v[16:19], v[76:83], v2
ds_read_b128 v[76:79], v119 offset:6144
v_smfmac_f32_16x16x64_bf16 v[44:47], v[32:35], a[32:39], v2
v_smfmac_f32_16x16x64_bf16 v[44:47], v[36:39], a[40:47], v2
v_smfmac_f32_16x16x64_bf16 v[44:47], v[40:43], a[48:55], v2
ds_read_b128 v[80:83], v119 offset:7168
v_smfmac_f32_16x16x64_bf16 v[48:51], v[28:31], a[80:87], v2
v_smfmac_f32_16x16x64_bf16 v[72:75], v[20:23], v[84:91], v2
ds_read_b128 v[84:87], v119 offset:8192
v_smfmac_f32_16x16x64_bf16 v[48:51], v[32:35], a[88:95], v2
v_cvt_pk_bf16_f32 v100, v44, v45
v_smfmac_f32_16x16x64_bf16 v[48:51], v[36:39], a[96:103], v2
v_cvt_pk_bf16_f32 v101, v46, v47
v_smfmac_f32_16x16x64_bf16 v[48:51], v[40:43], a[104:111], v2
ds_read_b128 v[88:91], v119 offset:9216
v_smfmac_f32_16x16x64_bf16 v[52:55], v[28:31], a[136:143], v2
v_smfmac_f32_16x16x64_bf16 v[72:75], v[24:27], v[92:99], v2
ds_read_b128 v[92:95], v119 offset:10240
v_smfmac_f32_16x16x64_bf16 v[52:55], v[32:35], a[144:151], v2
v_cvt_pk_bf16_f32 v102, v48, v49
v_smfmac_f32_16x16x64_bf16 v[52:55], v[36:39], a[152:159], v2
v_cvt_pk_bf16_f32 v103, v50, v51
v_smfmac_f32_16x16x64_bf16 v[52:55], v[40:43], a[160:167], v2
ds_read_b128 v[96:99], v119 offset:11264
v_smfmac_f32_16x16x64_bf16 v[56:59], v[28:31], a[192:199], v2
s_waitcnt lgkmcnt(4)
v_smfmac_f32_16x16x64_bf16 v[72:75], v[28:31], v[76:83], v2
ds_read_b128 v[76:79], v119 offset:12288
v_smfmac_f32_16x16x64_bf16 v[56:59], v[32:35], a[200:207], v2
v_cvt_pk_bf16_f32 v104, v52, v53
v_smfmac_f32_16x16x64_bf16 v[56:59], v[36:39], a[208:215], v2
v_cvt_pk_bf16_f32 v105, v54, v55
v_smfmac_f32_16x16x64_bf16 v[56:59], v[40:43], a[216:223], v2
ds_read_b128 v[80:83], v119 offset:13312
v_smfmac_f32_16x16x64_bf16 v[60:63], v[28:31], a[248:255], v2
s_waitcnt lgkmcnt(4)
v_smfmac_f32_16x16x64_bf16 v[72:75], v[32:35], v[84:91], v2
v_smfmac_f32_16x16x64_bf16 v[60:63], v[32:35], v[120:127], v2
v_cvt_pk_bf16_f32 v106, v56, v57
v_smfmac_f32_16x16x64_bf16 v[60:63], v[36:39], v[128:135], v2
v_cvt_pk_bf16_f32 v107, v58, v59
v_smfmac_f32_16x16x64_bf16 v[60:63], v[40:43], v[136:143], v2
v_smfmac_f32_16x16x64_bf16 v[64:67], v[28:31], v[168:175], v2
s_waitcnt lgkmcnt(2)
v_smfmac_f32_16x16x64_bf16 v[72:75], v[36:39], v[92:99], v2
v_smfmac_f32_16x16x64_bf16 v[64:67], v[32:35], v[176:183], v2
v_cvt_pk_bf16_f32 v108, v60, v61
v_smfmac_f32_16x16x64_bf16 v[64:67], v[36:39], v[184:191], v2
v_cvt_pk_bf16_f32 v109, v62, v63
v_smfmac_f32_16x16x64_bf16 v[64:67], v[40:43], v[192:199], v2
v_smfmac_f32_16x16x64_bf16 v[68:71], v[28:31], v[224:231], v2
s_waitcnt lgkmcnt(0)
v_smfmac_f32_16x16x64_bf16 v[72:75], v[40:43], v[76:83], v2
v_smfmac_f32_16x16x64_bf16 v[68:71], v[32:35], v[232:239], v2
v_cvt_pk_bf16_f32 v110, v64, v65
v_smfmac_f32_16x16x64_bf16 v[68:71], v[36:39], v[240:247], v2
v_cvt_pk_bf16_f32 v111, v66, v67
v_smfmac_f32_16x16x64_bf16 v[68:71], v[40:43], v[248:255], v2
s_nop 6
v_cvt_pk_bf16_f32 v112, v68, v69
v_cvt_pk_bf16_f32 v113, v70, v71
v_cvt_pk_bf16_f32 v114, v72, v73
v_cvt_pk_bf16_f32 v115, v74, v75
s_mov_b32 s72, s62
s_mov_b32 s73, s63
s_add_u32 s62, s62, 114688
s_add_u32 s63, s63, 114688
s_add_u32 s60, s60, 458752
s_add_u32 s61, s61, 458752
s_cmp_ge_u32 s37, 63
s_cbranch_scc1 LB_last
v_mov_b64 v[28:29], 0
v_mov_b64 v[30:31], 0
v_mov_b64 v[32:33], 0
v_mov_b64 v[34:35], 0
v_and_b32 v13, 12, v3
v_mul_u32_u24 v13, 352, v13
s_cmp_le_u32 s71, s37
s_cbranch_scc1 LB_late
s_waitcnt vmcnt(2)
LB_have:
ds_read_b128 v[76:79], v0 offset:0
ds_read_b128 v[80:83], v0 offset:1024
ds_read_b128 v[84:87], v0 offset:2048
ds_read_b128 v[88:91], v0 offset:3072
ds_read_b128 v[92:95], v0 offset:4096
ds_read_b128 v[96:99], v0 offset:5120
ds_read_b128 v[36:39], v0 offset:6144
ds_read_b128 v[40:43], v0 offset:7168
s_cmp_lg_u32 s32, 0
s_cbranch_scc1 LB_zh
buffer_load_dword v16, v118, s[8:11], s68 offen sc1
s_nop 11
buffer_load_dword v17, v118, s[8:11], s68 offen sc1
s_nop 11
buffer_load_dword v18, v118, s[8:11], s68 offen sc1
s_nop 11
buffer_load_dword v19, v118, s[8:11], s68 offen sc1
s_waitcnt vmcnt(3)
v_cmp_gt_u32 vcc, s69, v16
s_nop 0
s_cbranch_vccnz Lcm_27
Lcp_24:
s_sleep 1
s_nop 3
LB_go:
s_barrier
buffer_load_dwordx4 v[16:19], v1, s[8:11], s47 offen offset:0 sc1
buffer_load_dwordx4 v[20:23], v1, s[8:11], s47 offen offset:1024 sc1
buffer_load_dwordx4 v[24:27], v1, s[8:11], s47 offen offset:2048 sc1
LB_round:
s_waitcnt vmcnt(2) lgkmcnt(0)
v_smfmac_f32_16x16x64_bf16 v[28:31], v[16:19], v[76:83], v2
v_max3_u32 v12, v16, v17, v18
v_smfmac_f32_16x16x64_bf16 v[32:35], v[16:19], v[92:99], v2
s_waitcnt vmcnt(1)
v_max3_u32 v12, v12, v19, v20
v_smfmac_f32_16x16x64_bf16 v[28:31], v[20:23], v[84:91], v2
v_max3_u32 v12, v12, v21, v22
v_smfmac_f32_16x16x64_bf16 v[32:35], v[20:23], v[36:43], v2
s_waitcnt vmcnt(0)
v_max3_u32 v12, v12, v23, v24
v_smfmac_f32_16x16x64_bf16 v[28:31], v[24:27], v[100:107], v2
v_max3_u32 v12, v12, v25, v26
v_smfmac_f32_16x16x64_bf16 v[32:35], v[24:27], v[108:115], v2
v_max_u32 v12, v12, v27
v_cmp_eq_u32 vcc, -1, v12
s_cmp_eq_u32 s35, 0
ds_write_b128 v11, v[28:31]
s_cbranch_vccnz Lrr_28
s_nop 1
ds_write_b128 v11, v[32:35] offset:4096
s_cbranch_scc1 Lsi_29
buffer_store_dword v14, v13, s[8:11], s74 offen
Lsj_30:
s_cmp_ge_u32 s32, 2
s_waitcnt lgkmcnt(0)
s_barrier
s_cbranch_scc1 LB_next
ds_read_b128 v[76:79], v116 offset:0
ds_read_b128 v[80:83], v116 offset:1024
ds_read_b128 v[84:87], v116 offset:2048
ds_read_b128 v[88:91], v116 offset:3072
s_mov_b32 vcc_lo, 0x55555555
s_mov_b32 vcc_hi, 0x55555555
s_waitcnt lgkmcnt(2)
v_pk_add_f32 v[76:77], v[76:77], v[80:81]
v_pk_add_f32 v[78:79], v[78:79], v[82:83]
s_waitcnt lgkmcnt(0)
v_pk_add_f32 v[84:85], v[84:85], v[88:89]
v_pk_add_f32 v[86:87], v[86:87], v[90:91]
v_pk_add_f32 v[76:77], v[76:77], v[84:85]
v_pk_add_f32 v[78:79], v[78:79], v[86:87]
s_nop 1
v_permlane32_swap_b32 v76, v78
v_permlane32_swap_b32 v77, v79
v_pk_add_f32 v[76:77], v[76:77], v[78:79]
s_nop 1
v_cndmask_b32_dpp v80, v77, v76, vcc quad_perm:[1,0,3,2] row_mask:0xf bank_mask:0xf
s_not_b64 vcc, vcc
v_cndmask_b32_dpp v81, v76, v77, vcc quad_perm:[1,0,3,2] row_mask:0xf bank_mask:0xf
s_cmp_eq_u32 s35, 0
v_cvt_pk_bf16_f32 v80, v80, v81
v_min_u32 v13, -2, v80
s_cbranch_scc1 Lsi_31
buffer_store_dword v13, v10, s[8:11], s64 offen
Lsj_32:
s_add_u32 s37, s37, 1
s_mov_b32 s57, s64
s_add_u32 s40, s57, s78
s_add_u32 s41, s57, s79
s_mov_b32 m0, s65
v_permlane32_swap_b32 v44, v52
v_permlane32_swap_b32 v45, v53
v_permlane32_swap_b32 v46, v54
v_permlane32_swap_b32 v47, v55
v_permlane32_swap_b32 v48, v56
v_permlane32_swap_b32 v49, v57
v_permlane32_swap_b32 v50, v58
v_permlane32_swap_b32 v51, v59
v_permlane32_swap_b32 v60, v68
v_permlane32_swap_b32 v61, v69
v_permlane32_swap_b32 v62, v70
v_permlane32_swap_b32 v63, v71
v_permlane32_swap_b32 v64, v72
v_permlane32_swap_b32 v65, v73
v_permlane32_swap_b32 v66, v74
v_permlane32_swap_b32 v67, v75
LB_next2:
s_barrier
s_branch LB_loop
LB_zh:
s_branch LB_go
LB_next:
s_add_u32 s37, s37, 1
s_cmp_lg_u32 s32, 2
s_cbranch_scc1 LB_w3
buffer_load_dword v36, v117, s[8:11], s67 offen sc1
s_mov_b32 s57, s64
s_add_u32 s40, s57, s78
s_add_u32 s41, s57, s79
s_mov_b32 m0, s65
s_nop 9
buffer_load_dword v37, v117, s[8:11], s67 offen sc1
s_nop 13
buffer_load_dword v38, v117, s[8:11], s67 offen sc1
s_nop 13
buffer_load_dword v39, v117, s[8:11], s67 offen sc1
v_permlane32_swap_b32 v44, v52
v_permlane32_swap_b32 v45, v53
v_permlane32_swap_b32 v46, v54
v_permlane32_swap_b32 v47, v55
v_permlane32_swap_b32 v48, v56
v_permlane32_swap_b32 v49, v57
v_permlane32_swap_b32 v50, v58
v_permlane32_swap_b32 v51, v59
v_permlane32_swap_b32 v60, v68
v_permlane32_swap_b32 v61, v69
v_permlane32_swap_b32 v62, v70
v_permlane32_swap_b32 v63, v71
v_permlane32_swap_b32 v64, v72
v_permlane32_swap_b32 v65, v73
v_permlane32_swap_b32 v66, v74
v_permlane32_swap_b32 v67, v75
s_waitcnt vmcnt(2)
v_cmp_gt_u32 vcc, s37, v37
s_nop 0
s_cbranch_vccnz Lcm_36
Lcp_33:
s_nop 4
s_branch LB_next2
LB_w3:
s_cmp_eq_u32 s35, 0
s_cbranch_scc1 Lsi_37
buffer_store_dword v14, off, s[8:11], s66 offset:2816
Lsj_38:
s_mov_b32 s57, s64
s_add_u32 s40, s57, s78
s_add_u32 s41, s57, s79
s_mov_b32 m0, s65
buffer_load_dword v15, off, s[8:11], s58 offset:24 sc1
s_nop 15
s_nop 15
s_nop 3
v_permlane32_swap_b32 v44, v52
v_permlane32_swap_b32 v45, v53
v_permlane32_swap_b32 v46, v54
v_permlane32_swap_b32 v47, v55
v_permlane32_swap_b32 v48, v56
v_permlane32_swap_b32 v49, v57
v_permlane32_swap_b32 v50, v58
v_permlane32_swap_b32 v51, v59
v_permlane32_swap_b32 v60, v68
v_permlane32_swap_b32 v61, v69
v_permlane32_swap_b32 v62, v70
v_permlane32_swap_b32 v63, v71
v_permlane32_swap_b32 v64, v72
v_permlane32_swap_b32 v65, v73
v_permlane32_swap_b32 v66, v74
v_permlane32_swap_b32 v67, v75
v_mov_b32 v12, 0
s_waitcnt vmcnt(0)
ds_write_b32 v12, v15 offset:16444
s_waitcnt lgkmcnt(0)
s_branch LB_next2
LB_late:
buffer_load_dword v15, off, s[8:11], s58 offset:24 sc1
s_sub_u32 s36, s36, 1
s_cbranch_scc1 L_timeout_5
s_waitcnt vmcnt(0)
v_cmp_ge_u32 vcc, s37, v15
s_nop 0
s_cbranch_vccnz LB_late
s_sub_u32 s76, s60, 458752
s_sub_u32 s77, s61, 458752
s_mov_b32 m0, s65
s_nop 0
buffer_load_dwordx4 v1, s[8:11], s76 offen offset:0 sc1 lds
buffer_load_dwordx4 v1, s[8:11], s76 offen offset:1024 sc1 lds
buffer_load_dwordx4 v1, s[8:11], s76 offen offset:2048 sc1 lds
buffer_load_dwordx4 v1, s[8:11], s76 offen offset:3072 sc1 lds
s_add_u32 m0, s65, 4096
s_nop 0
buffer_load_dwordx4 v1, s[8:11], s77 offen offset:0 sc1 lds
buffer_load_dwordx4 v1, s[8:11], s77 offen offset:1024 sc1 lds
buffer_load_dwordx4 v1, s[8:11], s77 offen offset:2048 sc1 lds
buffer_load_dwordx4 v1, s[8:11], s77 offen offset:3072 sc1 lds
s_waitcnt vmcnt(0)
s_branch LB_have
LB_last:
v_permlane32_swap_b32 v44, v52
v_permlane32_swap_b32 v45, v53
v_permlane32_swap_b32 v46, v54
v_permlane32_swap_b32 v47, v55
v_permlane32_swap_b32 v48, v56
v_permlane32_swap_b32 v49, v57
v_permlane32_swap_b32 v50, v58
v_permlane32_swap_b32 v51, v59
v_permlane32_swap_b32 v60, v68
v_permlane32_swap_b32 v61, v69
v_permlane32_swap_b32 v62, v70
v_permlane32_swap_b32 v63, v71
v_permlane32_swap_b32 v64, v72
v_permlane32_swap_b32 v65, v73
v_permlane32_swap_b32 v66, v74
v_permlane32_swap_b32 v67, v75
v_pk_add_f32 v[44:45], v[44:45], v[52:53]
v_pk_add_f32 v[46:47], v[46:47], v[54:55]
v_cvt_pk_bf16_f32 v100, v44, v45
v_cvt_pk_bf16_f32 v101, v46, v47
v_pk_add_f32 v[48:49], v[48:49], v[56:57]
v_pk_add_f32 v[50:51], v[50:51], v[58:59]
v_cvt_pk_bf16_f32 v102, v48, v49
v_cvt_pk_bf16_f32 v103, v50, v51
v_pk_add_f32 v[60:61], v[60:61], v[68:69]
v_pk_add_f32 v[62:63], v[62:63], v[70:71]
v_cvt_pk_bf16_f32 v104, v60, v61
v_cvt_pk_bf16_f32 v105, v62, v63
v_pk_add_f32 v[64:65], v[64:65], v[72:73]
v_pk_add_f32 v[66:67], v[66:67], v[74:75]
v_cvt_pk_bf16_f32 v106, v64, v65
v_cvt_pk_bf16_f32 v107, v66, v67
v_permlane16_swap_b32 v100, v102
v_permlane16_swap_b32 v101, v103
v_permlane16_swap_b32 v104, v106
v_permlane16_swap_b32 v105, v107
buffer_store_dwordx4 v[100:103], v1, s[8:11], s72 offen sc1
buffer_store_dwordx4 v[104:107], v1, s[8:11], s73 offen sc1
v_mov_b32 v14, 0x7f
s_waitcnt vmcnt(0)
s_cmp_eq_u32 s35, 0
s_cbranch_scc1 Lsi_39
buffer_store_dword v14, off, s[8:11], s75
Lsj_40:
s_branch L_done
Lre_23:
buffer_load_dwordx4 v[16:19], v1, s[8:11], s40 offen sc1
buffer_load_dwordx4 v[20:23], v1, s[8:11], s41 offen sc1
s_sub_u32 s36, s36, 1
s_cbranch_scc1 L_timeout_7
s_nop 7
v_mov_b64 v[44:45], 0
v_mov_b64 v[46:47], 0
v_mov_b64 v[48:49], 0
v_mov_b64 v[50:51], 0
v_mov_b64 v[52:53], 0
v_mov_b64 v[54:55], 0
v_mov_b64 v[56:57], 0
v_mov_b64 v[58:59], 0
v_mov_b64 v[60:61], 0
v_mov_b64 v[62:63], 0
v_mov_b64 v[64:65], 0
v_mov_b64 v[66:67], 0
v_mov_b64 v[68:69], 0
v_mov_b64 v[70:71], 0
s_waitcnt vmcnt(0)
s_branch Lpoll_22
Lco_25:
s_branch Lcp_24
Lcm_27:
buffer_load_dword v16, v118, s[8:11], s68 offen sc1
s_waitcnt vmcnt(3)
v_cmp_gt_u32 vcc, s69, v17
s_nop 0
s_cbranch_vccz Lco_25
buffer_load_dword v17, v118, s[8:11], s68 offen sc1
s_waitcnt vmcnt(3)
v_cmp_gt_u32 vcc, s69, v18
s_nop 0
s_cbranch_vccz Lco_25
buffer_load_dword v18, v118, s[8:11], s68 offen sc1
s_waitcnt vmcnt(3)
v_cmp_gt_u32 vcc, s69, v19
s_nop 0
s_cbranch_vccz Lco_25
buffer_load_dword v19, v118, s[8:11], s68 offen sc1
Lcl_26:
s_sub_u32 s36, s36, 1
s_cbranch_scc1 L_timeout_4
s_waitcnt vmcnt(3)
v_cmp_gt_u32 vcc, s69, v16
s_nop 0
s_cbranch_vccz Lco_25
buffer_load_dword v16, v118, s[8:11], s68 offen sc1
s_waitcnt vmcnt(3)
v_cmp_gt_u32 vcc, s69, v17
s_nop 0
s_cbranch_vccz Lco_25
buffer_load_dword v17, v118, s[8:11], s68 offen sc1
s_waitcnt vmcnt(3)
v_cmp_gt_u32 vcc, s69, v18
s_nop 0
s_cbranch_vccz Lco_25
buffer_load_dword v18, v118, s[8:11], s68 offen sc1
s_waitcnt vmcnt(3)
v_cmp_gt_u32 vcc, s69, v19
s_nop 0
s_cbranch_vccz Lco_25
buffer_load_dword v19, v118, s[8:11], s68 offen sc1
s_branch Lcl_26
Lrr_28:
buffer_load_dwordx4 v[16:19], v1, s[8:11], s47 offen offset:0 sc1
buffer_load_dwordx4 v[20:23], v1, s[8:11], s47 offen offset:1024 sc1
buffer_load_dwordx4 v[24:27], v1, s[8:11], s47 offen offset:2048 sc1
s_sub_u32 s36, s36, 1
s_cbranch_scc1 L_timeout_3
s_nop 7
v_mov_b64 v[28:29], 0
v_mov_b64 v[30:31], 0
v_mov_b64 v[32:33], 0
v_mov_b64 v[34:35], 0
s_branch LB_round
Lsi_29:
buffer_store_dword v14, v13, s[8:11], s74 offen sc1
s_branch Lsj_30
Lsi_31:
buffer_store_dword v13, v10, s[8:11], s64 offen sc1
s_branch Lsj_32
Lco_34:
s_branch Lcp_33
Lcm_36:
buffer_load_dword v37, v117, s[8:11], s67 offen sc1
s_waitcnt vmcnt(2)
v_cmp_gt_u32 vcc, s37, v38
s_nop 0
s_cbranch_vccz Lco_34
buffer_load_dword v38, v117, s[8:11], s67 offen sc1
s_waitcnt vmcnt(2)
v_cmp_gt_u32 vcc, s37, v39
s_nop 0
s_cbranch_vccz Lco_34
buffer_load_dword v39, v117, s[8:11], s67 offen sc1
Lcl_35:
s_sub_u32 s36, s36, 1
s_cbranch_scc1 L_timeout_9
s_waitcnt vmcnt(2)
v_cmp_gt_u32 vcc, s37, v37
s_nop 0
s_cbranch_vccz Lco_34
buffer_load_dword v37, v117, s[8:11], s67 offen sc1
s_waitcnt vmcnt(2)
v_cmp_gt_u32 vcc, s37, v38
s_nop 0
s_cbranch_vccz Lco_34
buffer_load_dword v38, v117, s[8:11], s67 offen sc1
s_waitcnt vmcnt(2)
v_cmp_gt_u32 vcc, s37, v39
s_nop 0
s_cbranch_vccz Lco_34
buffer_load_dword v39, v117, s[8:11], s67 offen sc1
s_branch Lcl_35
Lsi_37:
buffer_store_dword v14, off, s[8:11], s66 offset:2816 sc1
s_branch Lsj_38
Lsi_39:
buffer_store_dword v14, off, s[8:11], s75 sc1
s_branch Lsj_40
L_roleH:
v_min_u32 v12, 63, v0
v_lshlrev_b32 v12, 7, v12
s_mov_b32 s46, 118571008
s_add_u32 s47, s46, 0
buffer_load_dword v8, v12, s[8:11], s47 offen sc1
s_add_u32 s47, s46, 8192
buffer_load_dword v9, v12, s[8:11], s47 offen sc1
s_add_u32 s47, s46, 16384
buffer_load_dword v10, v12, s[8:11], s47 offen sc1
s_add_u32 s47, s46, 24576
buffer_load_dword v11, v12, s[8:11], s47 offen sc1
s_branch Lwg_42
Lwf_41:
s_sleep 12
s_add_u32 s47, s46, 0
buffer_load_dword v8, v12, s[8:11], s47 offen sc1
s_add_u32 s47, s46, 8192
buffer_load_dword v9, v12, s[8:11], s47 offen sc1
s_add_u32 s47, s46, 16384
buffer_load_dword v10, v12, s[8:11], s47 offen sc1
s_add_u32 s47, s46, 24576
buffer_load_dword v11, v12, s[8:11], s47 offen sc1
s_sub_u32 s36, s36, 1
s_cbranch_scc1 L_timeout_14
Lwg_42:
s_waitcnt vmcnt(0)
v_and_b32 v8, v8, v9
v_and_b32 v8, v8, v10
v_and_b32 v8, v8, v11
v_cmp_ne_u32 vcc, 1, v8
s_nop 0
s_cbranch_vccnz Lwf_41
v_and_b32 v12, 63, v0
v_lshlrev_b32 v1, 4, v12
s_mov_b32 s37, 0
s_cmp_eq_u32 s34, 31
s_cbranch_scc1 LH_1
s_lshl_b32 s60, s32, 11
s_add_u32 s61, s60, 1024
s_min_u32 s61, s61, 6144
s_mul_i32 s62, s38, 458752
s_add_u32 s62, s62, 117506048
s_mul_i32 s63, s32, 3072
s_add_u32 s63, s63, 8192
s_lshl2_add_u32 s58, s32, s58
v_add_u32 v4, s60, v1
v_lshrrev_b32 v13, 4, v12
v_lshlrev_b32 v5, 8, v13
v_bfe_u32 v15, v12, 3, 1
v_lshl_add_u32 v5, v15, 3, v5
v_and_b32 v15, 7, v12
v_lshl_add_u32 v5, v15, 4, v5
v_add_u32 v5, s60, v5
v_add_u32 v6, 1024, v5
v_mov_b32 v32, -1
v_mov_b32 v33, -1
v_mov_b32 v34, -1
v_mov_b32 v35, -1
LH0_loop:
s_add_u32 s46, s37, 5
v_mov_b32 v7, s46
s_cmp_eq_u32 s35, 0
s_cbranch_scc1 Lsi_43
buffer_store_dword v7, off, s[8:11], s58
Lsj_44:
s_add_u32 s45, s37, 0
s_and_b32 s45, s45, 7
s_mul_i32 s57, s45, 20480
s_add_u32 s57, s57, s56
s_add_u32 s45, s37, 6
s_and_b32 s45, s45, 7
s_mul_i32 s64, s45, 20480
s_add_u32 s64, s64, s56
s_add_u32 s40, s57, s60
s_add_u32 s41, s57, s61
LH0_poll:
buffer_load_dwordx4 v[16:19], v1, s[8:11], s40 offen sc1
buffer_load_dwordx4 v[20:23], v1, s[8:11], s41 offen sc1
s_sub_u32 s36, s36, 1
s_cbranch_scc1 L_timeout_10
s_waitcnt vmcnt(0)
ds_write_b128 v4, v[16:19]
ds_write_b128 v4, v[20:23] offset:1024
ds_read2_b32 v[24:25], v5 offset0:0 offset1:32
ds_read2_b32 v[26:27], v5 offset0:1 offset1:33
ds_read2_b32 v[28:29], v6 offset0:0 offset1:32
ds_read2_b32 v[30:31], v6 offset0:1 offset1:33
v_max3_u32 v12, v16, v17, v18
v_max3_u32 v12, v12, v19, v20
v_max3_u32 v12, v12, v21, v22
v_max_u32 v12, v12, v23
v_cmp_eq_u32 vcc, -1, v12
s_add_u32 s42, s62, s60
s_add_u32 s43, s62, s61
s_waitcnt lgkmcnt(0)
s_cbranch_vccnz LH0_poll
buffer_store_dwordx4 v[24:27], v1, s[8:11], s42 offen sc1
buffer_store_dwordx4 v[28:31], v1, s[8:11], s43 offen sc1
s_add_u32 s62, s62, 7168
s_add_u32 s42, s64, s60
s_add_u32 s43, s64, s63
s_cmp_eq_u32 s35, 0
s_cbranch_scc1 Lsi_45
buffer_store_dwordx4 v[32:35], v1, s[8:11], s42 offen offset:0
buffer_store_dwordx4 v[32:35], v1, s[8:11], s42 offen offset:1024
buffer_store_dwordx4 v[32:35], v1, s[8:11], s43 offen offset:0
buffer_store_dwordx4 v[32:35], v1, s[8:11], s43 offen offset:1024
buffer_store_dwordx4 v[32:35], v1, s[8:11], s43 offen offset:2048
Lsj_46:
s_waitcnt vmcnt(0)
s_add_u32 s37, s37, 1
s_cmp_lt_u32 s37, 64
s_cbranch_scc1 LH0_loop
s_branch L_done
LH_1:
v_and_b32 v15, 15, v0
v_cmp_gt_u32 vcc, 14, v15
v_lshlrev_b32 v15, 2, v15
s_nop 0
v_cndmask_b32 v4, 0, v15, vcc
s_add_u32 s60, s58, 5376
v_and_b32 v15, 15, v12
v_lshlrev_b32 v5, 7, v15
v_lshlrev_b32 v6, 7, v12
s_cmp_eq_u32 s32, 1
s_cbranch_scc1 LH_z
s_cmp_eq_u32 s32, 2
s_cbranch_scc1 LHy_loop
s_cmp_lg_u32 s32, 0
s_cbranch_scc1 LH_t
v_min_u32 v5, 768, v5
s_mul_i32 s62, s38, 1835008
s_add_u32 s62, s62, 20185088
v_and_b32 v8, 1, v12
v_lshlrev_b32 v8, 2, v8
LH1_loop:
s_lshr_b32 s54, s37, 5
s_lshl_b32 s54, s54, 12
s_and_b32 s55, s37, 31
s_lshl2_add_u32 s54, s55, s54
s_lshl_b32 s55, s38, 13
s_add_u32 s54, s54, s55
s_add_u32 s61, s54, 118439936
s_sub_u32 s46, s37, 3
s_max_i32 s46, s46, 0
LH1_poll:
buffer_load_dword v16, v5, s[8:11], s61 offen sc1
buffer_load_dword v17, v4, s[8:11], s60 offen sc1
s_sub_u32 s36, s36, 1
s_cbranch_scc1 L_timeout_11
s_waitcnt vmcnt(0)
v_cmp_ne_u32 vcc, 1, v16
v_cmp_gt_u32 s[42:43], s46, v17
s_nop 0
s_or_b64 vcc, vcc, s[42:43]
s_cbranch_vccnz LH1_poll
s_add_u32 s40, s62, 0
buffer_load_dword v18, v6, s[8:11], s40 offen sc1
s_add_u32 s40, s62, 8192
buffer_load_dword v18, v6, s[8:11], s40 offen sc1
s_add_u32 s40, s62, 16384
buffer_load_dword v18, v6, s[8:11], s40 offen sc1
s_add_u32 s40, s62, 20480
buffer_load_dword v18, v6, s[8:11], s40 offen sc1
s_add_u32 s62, s62, 28672
s_add_u32 s37, s37, 1
v_mov_b32 v7, s37
s_waitcnt vmcnt(0)
s_cmp_eq_u32 s35, 0
s_cbranch_scc1 Lsi_47
buffer_store_dword v7, v8, s[8:11], s58 offen offset:16
Lsj_48:
s_cmp_lt_u32 s37, 63
s_cbranch_scc1 LH1_loop
s_branch L_done
LH_t:
s_add_u32 s40, s56, 0
buffer_load_dword v18, v6, s[8:11], s40 offen sc1
s_add_u32 s40, s56, 8192
buffer_load_dword v18, v6, s[8:11], s40 offen sc1
s_add_u32 s40, s56, 16384
buffer_load_dword v18, v6, s[8:11], s40 offen sc1
s_add_u32 s40, s56, 24576
buffer_load_dword v18, v6, s[8:11], s40 offen sc1
s_waitcnt vmcnt(0)
s_add_u32 s40, s56, 32768
buffer_load_dword v18, v6, s[8:11], s40 offen sc1
s_add_u32 s40, s56, 40960
buffer_load_dword v18, v6, s[8:11], s40 offen sc1
s_add_u32 s40, s56, 49152
buffer_load_dword v18, v6, s[8:11], s40 offen sc1
s_add_u32 s40, s56, 57344
buffer_load_dword v18, v6, s[8:11], s40 offen sc1
s_waitcnt vmcnt(0)
s_add_u32 s40, s56, 65536
buffer_load_dword v18, v6, s[8:11], s40 offen sc1
s_add_u32 s40, s56, 73728
buffer_load_dword v18, v6, s[8:11], s40 offen sc1
s_add_u32 s40, s56, 81920
buffer_load_dword v18, v6, s[8:11], s40 offen sc1
s_add_u32 s40, s56, 90112
buffer_load_dword v18, v6, s[8:11], s40 offen sc1
s_waitcnt vmcnt(0)
s_add_u32 s40, s56, 98304
buffer_load_dword v18, v6, s[8:11], s40 offen sc1
s_add_u32 s40, s56, 106496
buffer_load_dword v18, v6, s[8:11], s40 offen sc1
s_add_u32 s40, s56, 114688
buffer_load_dword v18, v6, s[8:11], s40 offen sc1
s_add_u32 s40, s56, 122880
buffer_load_dword v18, v6, s[8:11], s40 offen sc1
s_waitcnt vmcnt(0)
s_add_u32 s40, s56, 131072
buffer_load_dword v18, v6, s[8:11], s40 offen sc1
s_add_u32 s40, s56, 139264
buffer_load_dword v18, v6, s[8:11], s40 offen sc1
s_add_u32 s40, s56, 147456
buffer_load_dword v18, v6, s[8:11], s40 offen sc1
s_add_u32 s40, s56, 155648
buffer_load_dword v18, v6, s[8:11], s40 offen sc1
s_waitcnt vmcnt(0)
s_branch L_done
LHy_loop:
s_lshr_b32 s54, s37, 5
s_lshl_b32 s54, s54, 12
s_and_b32 s55, s37, 31
s_lshl2_add_u32 s54, s55, s54
s_lshl_b32 s55, s38, 13
s_add_u32 s54, s54, s55
s_add_u32 s61, s54, 118423552
LHy_poll:
buffer_load_dword v16, v5, s[8:11], s61 offen sc1
s_sub_u32 s36, s36, 1
s_cbranch_scc1 L_timeout_11
s_waitcnt vmcnt(0)
v_cmp_ne_u32 vcc, 1, v16
s_nop 0
s_cbranch_vccnz LHy_poll
s_add_u32 s37, s37, 1
v_mov_b32 v7, s37
s_cmp_eq_u32 s35, 0
s_cbranch_scc1 Lsi_49
buffer_store_dword v7, off, s[8:11], s58 offset:24
Lsj_50:
s_cmp_lt_u32 s37, 63
s_cbranch_scc1 LHy_loop
s_branch L_done
LH_z:
v_mov_b32 v7, 1
s_add_u32 s60, s58, 5504
v_lshrrev_b32 v4, 2, v1
v_min_u32 v4, 220, v4
LHz_loop:
s_lshr_b32 s54, s37, 5
s_lshl_b32 s54, s54, 12
s_and_b32 s55, s37, 31
s_lshl2_add_u32 s54, s55, s54
s_lshl_b32 s55, s38, 13
s_add_u32 s54, s54, s55
s_add_u32 s61, s54, 118456320
s_add_u32 s46, s37, 2
LHz_poll:
buffer_load_dword v17, v4, s[8:11], s60 offen sc1
s_sub_u32 s36, s36, 1
s_cbranch_scc1 L_timeout_12
s_waitcnt vmcnt(0)
v_cmp_gt_u32 vcc, s46, v17
s_nop 0
s_cbranch_vccnz LHz_poll
buffer_store_dword v7, off, s[8:11], s61 sc1
s_add_u32 s37, s37, 1
s_cmp_lt_u32 s37, 64
s_cbranch_scc1 LHz_loop
s_branch L_done
Lsi_43:
buffer_store_dword v7, off, s[8:11], s58 sc1
s_branch Lsj_44
Lsi_45:
buffer_store_dwordx4 v[32:35], v1, s[8:11], s42 offen offset:0 sc1
buffer_store_dwordx4 v[32:35], v1, s[8:11], s42 offen offset:1024 sc1
buffer_store_dwordx4 v[32:35], v1, s[8:11], s43 offen offset:0 sc1
buffer_store_dwordx4 v[32:35], v1, s[8:11], s43 offen offset:1024 sc1
buffer_store_dwordx4 v[32:35], v1, s[8:11], s43 offen offset:2048 sc1
s_branch Lsj_46
Lsi_47:
buffer_store_dword v7, v8, s[8:11], s58 offen offset:16 sc1
s_branch Lsj_48
Lsi_49:
buffer_store_dword v7, off, s[8:11], s58 offset:24 sc1
s_branch Lsj_50
L_tok:
s_sub_u32 s42, s33, 2
s_cmp_ge_u32 s33, 6
s_cselect_b32 s43, 28, 28
s_cmp_ge_u32 s34, s43
s_cbranch_scc1 L_isO
s_mov_b32 s101, s34
s_cmp_ge_u32 s33, 6
s_cbranch_scc1 L_roleF
s_and_b32 s43, s34, 3
s_lshl2_add_u32 s43, s42, s43
s_lshr_b32 s42, s34, 2
s_cmp_ge_u32 s42, 4
s_cbranch_scc1 L_isY
s_and_b32 s44, s42, 1
s_lshl_b32 s44, s44, 4
s_add_u32 s34, s43, s44
s_and_b32 s33, s42, 2
s_add_u32 s33, s33, 2
s_mov_b32 s101, s34
s_cmp_lt_u32 s42, 2
s_cbranch_scc1 L_roleT
s_add_u32 s40, s42, 1
s_mov_b32 s41, 0
s_mov_b32 s42, 0
s_mov_b32 s43, 0
s_branch L_roleY
L_isO:
s_lshl2_add_u32 s42, s42, s34
s_sub_u32 s42, s42, 28
s_mul_i32 s40, s42, 43
s_lshr_b32 s40, s40, 8
s_mul_i32 s41, s40, 6
s_sub_u32 s41, s42, s41
s_cmp_eq_u32 s41, 5
s_cbranch_scc1 L_done
s_mov_b32 s33, 3
s_add_u32 s101, s41, 16
s_branch L_roleO
L_isY:
s_add_u32 s44, s43, 16
s_cmp_eq_u32 s42, 6
s_cselect_b32 s34, s44, s43
s_cmp_eq_u32 s42, 4
s_cselect_b32 s33, 3, 5
s_mov_b32 s101, s34
s_sub_u32 s40, s42, 4
s_sub_u32 s44, s42, 5
s_cmp_eq_u32 s42, 4
s_cselect_b32 s41, 25, s44
s_cselect_b32 s42, 0, 1
s_cselect_b32 s43, 1, 2
L_roleY:
v_mbcnt_lo_u32_b32 v0, -1, 0
v_mbcnt_hi_u32_b32 v0, -1, v0
v_lshlrev_b32 v1, 4, v0
s_mov_b32 s92, 0x1000000
s_mov_b32 s97, 0
s_mov_b32 s98, 0
s_mov_b32 s95, 0
v_min_u32 v2, 27, v0
v_lshlrev_b32 v2, 7, v2
v_min_u32 v118, 13, v0
v_lshlrev_b32 v118, 7, v118
s_and_b32 s59, s34, 15
s_mov_b32 s100, 118554624
s_mov_b32 s71, 0
s_mov_b32 s73, 0
s_mov_b32 s65, 25
s_mov_b32 s66, 5
s_mov_b32 s72, s40
s_mov_b32 s68, s41
s_mov_b32 s69, s42
s_mov_b32 s70, s43
s_cmp_eq_u32 s43, 0
s_cselect_b32 s67, 1, 0
s_mov_b32 s22, s43
s_mov_b32 s23, 1
s_mul_i32 s60, s59, 28
s_mul_i32 s41, s32, 7
s_add_u32 s60, s60, s41
s_mul_i32 s60, s60, 14336
s_lshl_b32 s40, s32, 8
s_add_u32 s40, s40, 65536
v_and_b32 v7, 15, v0
v_lshl_add_u32 v5, v7, 2, s40
v_lshrrev_b32 v7, 5, v0
v_lshl_add_u32 v5, v7, 7, v5
v_lshrrev_b32 v7, 4, v0
v_lshl_add_u32 v6, v7, 4, s40
s_lshl2_add_u32 s40, s59, s32
s_min_u32 s40, s40, 27
s_lshl_b32 s76, s40, 10
s_cmp_ge_u32 s40, 14
s_cselect_b64 s[78:79], -1, 0
s_add_u32 s20, s76, 20185088
s_mul_i32 s21, s32, 114688
s_lshl_b32 s40, s59, 10
s_add_u32 s21, s21, s40
s_add_u32 s21, s21, 23855104
s_mov_b32 s58, 126476
s_mul_i32 s61, s73, 3670016
s_mul_i32 s40, s72, 28672
s_add_u32 s61, s61, s40
s_add_u32 s61, s61, 12845056
s_mul_i32 s62, s73, 524288
s_lshl_b32 s40, s72, 12
s_add_u32 s62, s62, s40
s_add_u32 s62, s62, 118603776
s_add_u32 s74, s73, 1
s_lshl_b32 s45, s59, 3
s_add_u32 s45, s45, 128
v_min_u32 v12, 7, v0
v_lshlrev_b32 v12, 7, v12
s_lshl_b32 s46, s45, 7
s_add_u32 s46, s46, 118571008
s_add_u32 s47, s46, 0
buffer_load_dword v8, v12, s[8:11], s47 offen sc1
s_branch Lwg_52
Lwf_51:
s_sleep 2
s_add_u32 s47, s46, 0
buffer_load_dword v8, v12, s[8:11], s47 offen sc1
s_sub_u32 s36, s36, 1
s_cbranch_scc1 L_timeout_14
Lwg_52:
s_waitcnt vmcnt(0)
v_cmp_ne_u32 vcc, 1, v8
s_nop 0
s_cbranch_vccnz Lwf_51
v_mov_b32 v72, 0x3f803f80
v_mov_b32 v73, 0x3f803f80
v_mov_b32 v74, 0x3f803f80
v_mov_b32 v75, 0x3f803f80
s_add_u32 s40, s60, 6422528
buffer_load_dwordx4 a[0:3], v1, s[8:11], s40 offen offset:0 sc1
buffer_load_dwordx4 a[4:7], v1, s[8:11], s40 offen offset:1024 sc1
buffer_load_dwordx4 a[8:11], v1, s[8:11], s40 offen offset:2048 sc1
buffer_load_dwordx4 a[12:15], v1, s[8:11], s40 offen offset:3072 sc1
s_add_u32 s40, s60, 6426624
buffer_load_dwordx4 a[16:19], v1, s[8:11], s40 offen offset:0 sc1
buffer_load_dwordx4 a[20:23], v1, s[8:11], s40 offen offset:1024 sc1
buffer_load_dwordx4 a[24:27], v1, s[8:11], s40 offen offset:2048 sc1
buffer_load_dwordx4 a[28:31], v1, s[8:11], s40 offen offset:3072 sc1
s_add_u32 s40, s60, 6430720
buffer_load_dwordx4 a[32:35], v1, s[8:11], s40 offen offset:0 sc1
buffer_load_dwordx4 a[36:39], v1, s[8:11], s40 offen offset:1024 sc1
buffer_load_dwordx4 a[40:43], v1, s[8:11], s40 offen offset:2048 sc1
buffer_load_dwordx4 a[44:47], v1, s[8:11], s40 offen offset:3072 sc1
s_add_u32 s40, s60, 6434816
buffer_load_dwordx4 a[48:51], v1, s[8:11], s40 offen offset:0 sc1
buffer_load_dwordx4 a[52:55], v1, s[8:11], s40 offen offset:1024 sc1
s_add_u32 s40, s60, 6436864
buffer_load_dwordx4 a[56:59], v1, s[8:11], s40 offen offset:0 sc1
buffer_load_dwordx4 a[60:63], v1, s[8:11], s40 offen offset:1024 sc1
buffer_load_dwordx4 a[64:67], v1, s[8:11], s40 offen offset:2048 sc1
buffer_load_dwordx4 a[68:71], v1, s[8:11], s40 offen offset:3072 sc1
s_add_u32 s40, s60, 6440960
buffer_load_dwordx4 a[72:75], v1, s[8:11], s40 offen offset:0 sc1
buffer_load_dwordx4 a[76:79], v1, s[8:11], s40 offen offset:1024 sc1
buffer_load_dwordx4 a[80:83], v1, s[8:11], s40 offen offset:2048 sc1
buffer_load_dwordx4 a[84:87], v1, s[8:11], s40 offen offset:3072 sc1
s_add_u32 s40, s60, 6445056
buffer_load_dwordx4 a[88:91], v1, s[8:11], s40 offen offset:0 sc1
buffer_load_dwordx4 a[92:95], v1, s[8:11], s40 offen offset:1024 sc1
buffer_load_dwordx4 a[96:99], v1, s[8:11], s40 offen offset:2048 sc1
buffer_load_dwordx4 a[100:103], v1, s[8:11], s40 offen offset:3072 sc1
s_add_u32 s40, s60, 6449152
buffer_load_dwordx4 a[104:107], v1, s[8:11], s40 offen offset:0 sc1
buffer_load_dwordx4 a[108:111], v1, s[8:11], s40 offen offset:1024 sc1
s_add_u32 s40, s60, 6451200
buffer_load_dwordx4 a[112:115], v1, s[8:11], s40 offen offset:0 sc1
buffer_load_dwordx4 a[116:119], v1, s[8:11], s40 offen offset:1024 sc1
buffer_load_dwordx4 a[120:123], v1, s[8:11], s40 offen offset:2048 sc1
buffer_load_dwordx4 a[124:127], v1, s[8:11], s40 offen offset:3072 sc1
s_add_u32 s40, s60, 6455296
buffer_load_dwordx4 a[128:131], v1, s[8:11], s40 offen offset:0 sc1
buffer_load_dwordx4 a[132:135], v1, s[8:11], s40 offen offset:1024 sc1
buffer_load_dwordx4 a[136:139], v1, s[8:11], s40 offen offset:2048 sc1
buffer_load_dwordx4 a[140:143], v1, s[8:11], s40 offen offset:3072 sc1
s_add_u32 s40, s60, 6459392
buffer_load_dwordx4 a[144:147], v1, s[8:11], s40 offen offset:0 sc1
buffer_load_dwordx4 a[148:151], v1, s[8:11], s40 offen offset:1024 sc1
buffer_load_dwordx4 a[152:155], v1, s[8:11], s40 offen offset:2048 sc1
buffer_load_dwordx4 a[156:159], v1, s[8:11], s40 offen offset:3072 sc1
s_add_u32 s40, s60, 6463488
buffer_load_dwordx4 a[160:163], v1, s[8:11], s40 offen offset:0 sc1
buffer_load_dwordx4 a[164:167], v1, s[8:11], s40 offen offset:1024 sc1
s_add_u32 s40, s60, 6465536
buffer_load_dwordx4 a[168:171], v1, s[8:11], s40 offen offset:0 sc1
buffer_load_dwordx4 a[172:175], v1, s[8:11], s40 offen offset:1024 sc1
buffer_load_dwordx4 a[176:179], v1, s[8:11], s40 offen offset:2048 sc1
buffer_load_dwordx4 a[180:183], v1, s[8:11], s40 offen offset:3072 sc1
s_add_u32 s40, s60, 6469632
buffer_load_dwordx4 a[184:187], v1, s[8:11], s40 offen offset:0 sc1
buffer_load_dwordx4 a[188:191], v1, s[8:11], s40 offen offset:1024 sc1
buffer_load_dwordx4 a[192:195], v1, s[8:11], s40 offen offset:2048 sc1
buffer_load_dwordx4 a[196:199], v1, s[8:11], s40 offen offset:3072 sc1
s_add_u32 s40, s60, 6473728
buffer_load_dwordx4 a[200:203], v1, s[8:11], s40 offen offset:0 sc1
buffer_load_dwordx4 a[204:207], v1, s[8:11], s40 offen offset:1024 sc1
buffer_load_dwordx4 a[208:211], v1, s[8:11], s40 offen offset:2048 sc1
buffer_load_dwordx4 a[212:215], v1, s[8:11], s40 offen offset:3072 sc1
s_add_u32 s40, s60, 6477824
buffer_load_dwordx4 a[216:219], v1, s[8:11], s40 offen offset:0 sc1
buffer_load_dwordx4 a[220:223], v1, s[8:11], s40 offen offset:1024 sc1
s_waitcnt vmcnt(42)
v_mfma_f32_16x16x32_bf16 v[16:19], v[72:75], a[0:3], 0
v_mfma_f32_16x16x32_bf16 v[16:19], v[72:75], a[4:7], v[16:19]
v_mfma_f32_16x16x32_bf16 v[16:19], v[72:75], a[8:11], v[16:19]
v_mfma_f32_16x16x32_bf16 v[16:19], v[72:75], a[12:15], v[16:19]
v_mfma_f32_16x16x32_bf16 v[16:19], v[72:75], a[16:19], v[16:19]
v_mfma_f32_16x16x32_bf16 v[16:19], v[72:75], a[20:23], v[16:19]
v_mfma_f32_16x16x32_bf16 v[16:19], v[72:75], a[24:27], v[16:19]
v_mfma_f32_16x16x32_bf16 v[16:19], v[72:75], a[28:31], v[16:19]
v_mfma_f32_16x16x32_bf16 v[16:19], v[72:75], a[32:35], v[16:19]
v_mfma_f32_16x16x32_bf16 v[16:19], v[72:75], a[36:39], v[16:19]
v_mfma_f32_16x16x32_bf16 v[16:19], v[72:75], a[40:43], v[16:19]
v_mfma_f32_16x16x32_bf16 v[16:19], v[72:75], a[44:47], v[16:19]
v_mfma_f32_16x16x32_bf16 v[16:19], v[72:75], a[48:51], v[16:19]
v_mfma_f32_16x16x32_bf16 v[16:19], v[72:75], a[52:55], v[16:19]
s_add_u32 s40, s60, 6479872
buffer_load_dwordx4 a[224:227], v1, s[8:11], s40 offen offset:0 sc1
buffer_load_dwordx4 a[228:231], v1, s[8:11], s40 offen offset:1024 sc1
buffer_load_dwordx4 a[232:235], v1, s[8:11], s40 offen offset:2048 sc1
buffer_load_dwordx4 a[236:239], v1, s[8:11], s40 offen offset:3072 sc1
s_add_u32 s40, s60, 6483968
buffer_load_dwordx4 a[240:243], v1, s[8:11], s40 offen offset:0 sc1
buffer_load_dwordx4 a[244:247], v1, s[8:11], s40 offen offset:1024 sc1
buffer_load_dwordx4 a[248:251], v1, s[8:11], s40 offen offset:2048 sc1
buffer_load_dwordx4 a[252:255], v1, s[8:11], s40 offen offset:3072 sc1
s_add_u32 s40, s60, 6488064
buffer_load_dwordx4 v[120:123], v1, s[8:11], s40 offen offset:0 sc1
buffer_load_dwordx4 v[124:127], v1, s[8:11], s40 offen offset:1024 sc1
buffer_load_dwordx4 v[128:131], v1, s[8:11], s40 offen offset:2048 sc1
buffer_load_dwordx4 v[132:135], v1, s[8:11], s40 offen offset:3072 sc1
s_add_u32 s40, s60, 6492160
buffer_load_dwordx4 v[136:139], v1, s[8:11], s40 offen offset:0 sc1
buffer_load_dwordx4 v[140:143], v1, s[8:11], s40 offen offset:1024 sc1
s_waitcnt vmcnt(42)
v_mfma_f32_16x16x32_bf16 v[20:23], v[72:75], a[56:59], 0
v_mfma_f32_16x16x32_bf16 v[20:23], v[72:75], a[60:63], v[20:23]
v_mfma_f32_16x16x32_bf16 v[20:23], v[72:75], a[64:67], v[20:23]
v_mfma_f32_16x16x32_bf16 v[20:23], v[72:75], a[68:71], v[20:23]
v_mfma_f32_16x16x32_bf16 v[20:23], v[72:75], a[72:75], v[20:23]
v_mfma_f32_16x16x32_bf16 v[20:23], v[72:75], a[76:79], v[20:23]
v_mfma_f32_16x16x32_bf16 v[20:23], v[72:75], a[80:83], v[20:23]
v_mfma_f32_16x16x32_bf16 v[20:23], v[72:75], a[84:87], v[20:23]
v_mfma_f32_16x16x32_bf16 v[20:23], v[72:75], a[88:91], v[20:23]
v_mfma_f32_16x16x32_bf16 v[20:23], v[72:75], a[92:95], v[20:23]
v_mfma_f32_16x16x32_bf16 v[20:23], v[72:75], a[96:99], v[20:23]
v_mfma_f32_16x16x32_bf16 v[20:23], v[72:75], a[100:103], v[20:23]
v_mfma_f32_16x16x32_bf16 v[20:23], v[72:75], a[104:107], v[20:23]
v_mfma_f32_16x16x32_bf16 v[20:23], v[72:75], a[108:111], v[20:23]
s_add_u32 s40, s60, 6494208
buffer_load_dwordx4 v[144:147], v1, s[8:11], s40 offen offset:0 sc1
buffer_load_dwordx4 v[148:151], v1, s[8:11], s40 offen offset:1024 sc1
buffer_load_dwordx4 v[152:155], v1, s[8:11], s40 offen offset:2048 sc1
buffer_load_dwordx4 v[156:159], v1, s[8:11], s40 offen offset:3072 sc1
s_add_u32 s40, s60, 6498304
buffer_load_dwordx4 v[160:163], v1, s[8:11], s40 offen offset:0 sc1
buffer_load_dwordx4 v[164:167], v1, s[8:11], s40 offen offset:1024 sc1
buffer_load_dwordx4 v[168:171], v1, s[8:11], s40 offen offset:2048 sc1
buffer_load_dwordx4 v[172:175], v1, s[8:11], s40 offen offset:3072 sc1
s_add_u32 s40, s60, 6502400
buffer_load_dwordx4 v[176:179], v1, s[8:11], s40 offen offset:0 sc1
buffer_load_dwordx4 v[180:183], v1, s[8:11], s40 offen offset:1024 sc1
buffer_load_dwordx4 v[184:187], v1, s[8:11], s40 offen offset:2048 sc1
buffer_load_dwordx4 v[188:191], v1, s[8:11], s40 offen offset:3072 sc1
s_add_u32 s40, s60, 6506496
buffer_load_dwordx4 v[192:195], v1, s[8:11], s40 offen offset:0 sc1
buffer_load_dwordx4 v[196:199], v1, s[8:11], s40 offen offset:1024 sc1
s_waitcnt vmcnt(42)
v_mfma_f32_16x16x32_bf16 v[24:27], v[72:75], a[112:115], 0
v_mfma_f32_16x16x32_bf16 v[24:27], v[72:75], a[116:119], v[24:27]
v_mfma_f32_16x16x32_bf16 v[24:27], v[72:75], a[120:123], v[24:27]
v_mfma_f32_16x16x32_bf16 v[24:27], v[72:75], a[124:127], v[24:27]
v_mfma_f32_16x16x32_bf16 v[24:27], v[72:75], a[128:131], v[24:27]
v_mfma_f32_16x16x32_bf16 v[24:27], v[72:75], a[132:135], v[24:27]
v_mfma_f32_16x16x32_bf16 v[24:27], v[72:75], a[136:139], v[24:27]
v_mfma_f32_16x16x32_bf16 v[24:27], v[72:75], a[140:143], v[24:27]
v_mfma_f32_16x16x32_bf16 v[24:27], v[72:75], a[144:147], v[24:27]
v_mfma_f32_16x16x32_bf16 v[24:27], v[72:75], a[148:151], v[24:27]
v_mfma_f32_16x16x32_bf16 v[24:27], v[72:75], a[152:155], v[24:27]
v_mfma_f32_16x16x32_bf16 v[24:27], v[72:75], a[156:159], v[24:27]
v_mfma_f32_16x16x32_bf16 v[24:27], v[72:75], a[160:163], v[24:27]
v_mfma_f32_16x16x32_bf16 v[24:27], v[72:75], a[164:167], v[24:27]
s_add_u32 s40, s60, 6508544
buffer_load_dwordx4 v[200:203], v1, s[8:11], s40 offen offset:0 sc1
buffer_load_dwordx4 v[204:207], v1, s[8:11], s40 offen offset:1024 sc1
buffer_load_dwordx4 v[208:211], v1, s[8:11], s40 offen offset:2048 sc1
buffer_load_dwordx4 v[212:215], v1, s[8:11], s40 offen offset:3072 sc1
s_add_u32 s40, s60, 6512640
buffer_load_dwordx4 v[216:219], v1, s[8:11], s40 offen offset:0 sc1
buffer_load_dwordx4 v[220:223], v1, s[8:11], s40 offen offset:1024 sc1
buffer_load_dwordx4 v[224:227], v1, s[8:11], s40 offen offset:2048 sc1
buffer_load_dwordx4 v[228:231], v1, s[8:11], s40 offen offset:3072 sc1
s_add_u32 s40, s60, 6516736
buffer_load_dwordx4 v[232:235], v1, s[8:11], s40 offen offset:0 sc1
buffer_load_dwordx4 v[236:239], v1, s[8:11], s40 offen offset:1024 sc1
buffer_load_dwordx4 v[240:243], v1, s[8:11], s40 offen offset:2048 sc1
buffer_load_dwordx4 v[244:247], v1, s[8:11], s40 offen offset:3072 sc1
s_add_u32 s40, s60, 6520832
buffer_load_dwordx4 v[248:251], v1, s[8:11], s40 offen offset:0 sc1
buffer_load_dwordx4 v[252:255], v1, s[8:11], s40 offen offset:1024 sc1
s_waitcnt vmcnt(42)
v_mfma_f32_16x16x32_bf16 v[28:31], v[72:75], a[168:171], 0
v_mfma_f32_16x16x32_bf16 v[28:31], v[72:75], a[172:175], v[28:31]
v_mfma_f32_16x16x32_bf16 v[28:31], v[72:75], a[176:179], v[28:31]
v_mfma_f32_16x16x32_bf16 v[28:31], v[72:75], a[180:183], v[28:31]
v_mfma_f32_16x16x32_bf16 v[28:31], v[72:75], a[184:187], v[28:31]
v_mfma_f32_16x16x32_bf16 v[28:31], v[72:75], a[188:191], v[28:31]
v_mfma_f32_16x16x32_bf16 v[28:31], v[72:75], a[192:195], v[28:31]
v_mfma_f32_16x16x32_bf16 v[28:31], v[72:75], a[196:199], v[28:31]
v_mfma_f32_16x16x32_bf16 v[28:31], v[72:75], a[200:203], v[28:31]
v_mfma_f32_16x16x32_bf16 v[28:31], v[72:75], a[204:207], v[28:31]
v_mfma_f32_16x16x32_bf16 v[28:31], v[72:75], a[208:211], v[28:31]
v_mfma_f32_16x16x32_bf16 v[28:31], v[72:75], a[212:215], v[28:31]
v_mfma_f32_16x16x32_bf16 v[28:31], v[72:75], a[216:219], v[28:31]
v_mfma_f32_16x16x32_bf16 v[28:31], v[72:75], a[220:223], v[28:31]
s_lshl_b32 s45, s59, 7
s_add_u32 s45, s45, 118562944
s_or_b32 s44, s72, s32
s_cselect_b32 s45, 2146435072, s45
v_mov_b32 v13, 1
buffer_store_dword v13, off, s[8:11], s45 sc1
v_min_u32 v12, 63, v0
v_lshlrev_b32 v12, 7, v12
s_mov_b32 s46, 118571008
s_add_u32 s47, s46, 0
buffer_load_dword v8, v12, s[8:11], s47 offen sc1
s_add_u32 s47, s46, 8192
buffer_load_dword v9, v12, s[8:11], s47 offen sc1
s_add_u32 s47, s46, 16384
buffer_load_dword v10, v12, s[8:11], s47 offen sc1
s_add_u32 s47, s46, 24576
buffer_load_dword v11, v12, s[8:11], s47 offen sc1
s_waitcnt vmcnt(33)
v_mfma_f32_16x16x32_bf16 v[32:35], v[72:75], a[224:227], 0
v_mfma_f32_16x16x32_bf16 v[32:35], v[72:75], a[228:231], v[32:35]
v_mfma_f32_16x16x32_bf16 v[32:35], v[72:75], a[232:235], v[32:35]
v_mfma_f32_16x16x32_bf16 v[32:35], v[72:75], a[236:239], v[32:35]
v_mfma_f32_16x16x32_bf16 v[32:35], v[72:75], a[240:243], v[32:35]
v_mfma_f32_16x16x32_bf16 v[32:35], v[72:75], a[244:247], v[32:35]
v_mfma_f32_16x16x32_bf16 v[32:35], v[72:75], a[248:251], v[32:35]
v_mfma_f32_16x16x32_bf16 v[32:35], v[72:75], a[252:255], v[32:35]
v_mfma_f32_16x16x32_bf16 v[32:35], v[72:75], v[120:123], v[32:35]
v_mfma_f32_16x16x32_bf16 v[32:35], v[72:75], v[124:127], v[32:35]
v_mfma_f32_16x16x32_bf16 v[32:35], v[72:75], v[128:131], v[32:35]
v_mfma_f32_16x16x32_bf16 v[32:35], v[72:75], v[132:135], v[32:35]
v_mfma_f32_16x16x32_bf16 v[32:35], v[72:75], v[136:139], v[32:35]
v_mfma_f32_16x16x32_bf16 v[32:35], v[72:75], v[140:143], v[32:35]
s_waitcnt vmcnt(19)
v_mfma_f32_16x16x32_bf16 v[36:39], v[72:75], v[144:147], 0
v_mfma_f32_16x16x32_bf16 v[36:39], v[72:75], v[148:151], v[36:39]
v_mfma_f32_16x16x32_bf16 v[36:39], v[72:75], v[152:155], v[36:39]
v_mfma_f32_16x16x32_bf16 v[36:39], v[72:75], v[156:159], v[36:39]
v_mfma_f32_16x16x32_bf16 v[36:39], v[72:75], v[160:163], v[36:39]
v_mfma_f32_16x16x32_bf16 v[36:39], v[72:75], v[164:167], v[36:39]
v_mfma_f32_16x16x32_bf16 v[36:39], v[72:75], v[168:171], v[36:39]
v_mfma_f32_16x16x32_bf16 v[36:39], v[72:75], v[172:175], v[36:39]
v_mfma_f32_16x16x32_bf16 v[36:39], v[72:75], v[176:179], v[36:39]
v_mfma_f32_16x16x32_bf16 v[36:39], v[72:75], v[180:183], v[36:39]
v_mfma_f32_16x16x32_bf16 v[36:39], v[72:75], v[184:187], v[36:39]
v_mfma_f32_16x16x32_bf16 v[36:39], v[72:75], v[188:191], v[36:39]
v_mfma_f32_16x16x32_bf16 v[36:39], v[72:75], v[192:195], v[36:39]
v_mfma_f32_16x16x32_bf16 v[36:39], v[72:75], v[196:199], v[36:39]
s_waitcnt vmcnt(5)
v_mfma_f32_16x16x32_bf16 v[40:43], v[72:75], v[200:203], 0
v_mfma_f32_16x16x32_bf16 v[40:43], v[72:75], v[204:207], v[40:43]
v_mfma_f32_16x16x32_bf16 v[40:43], v[72:75], v[208:211], v[40:43]
v_mfma_f32_16x16x32_bf16 v[40:43], v[72:75], v[212:215], v[40:43]
v_mfma_f32_16x16x32_bf16 v[40:43], v[72:75], v[216:219], v[40:43]
v_mfma_f32_16x16x32_bf16 v[40:43], v[72:75], v[220:223], v[40:43]
v_mfma_f32_16x16x32_bf16 v[40:43], v[72:75], v[224:227], v[40:43]
v_mfma_f32_16x16x32_bf16 v[40:43], v[72:75], v[228:231], v[40:43]
v_mfma_f32_16x16x32_bf16 v[40:43], v[72:75], v[232:235], v[40:43]
v_mfma_f32_16x16x32_bf16 v[40:43], v[72:75], v[236:239], v[40:43]
v_mfma_f32_16x16x32_bf16 v[40:43], v[72:75], v[240:243], v[40:43]
v_mfma_f32_16x16x32_bf16 v[40:43], v[72:75], v[244:247], v[40:43]
v_mfma_f32_16x16x32_bf16 v[40:43], v[72:75], v[248:251], v[40:43]
v_mfma_f32_16x16x32_bf16 v[40:43], v[72:75], v[252:255], v[40:43]
s_branch Lwg_56
Lwf_55:
s_sleep 12
s_add_u32 s47, s46, 0
buffer_load_dword v8, v12, s[8:11], s47 offen sc1
s_add_u32 s47, s46, 8192
buffer_load_dword v9, v12, s[8:11], s47 offen sc1
s_add_u32 s47, s46, 16384
buffer_load_dword v10, v12, s[8:11], s47 offen sc1
s_add_u32 s47, s46, 24576
buffer_load_dword v11, v12, s[8:11], s47 offen sc1
s_sub_u32 s36, s36, 1
s_cbranch_scc1 L_timeout_14
Lwg_56:
s_waitcnt vmcnt(0)
v_and_b32 v8, v8, v9
v_and_b32 v8, v8, v10
v_and_b32 v8, v8, v11
v_cmp_ne_u32 vcc, 1, v8
s_nop 0
s_cbranch_vccnz Lwf_55
s_xor_b32 s44, s95, 32768
s_mul_i32 s42, s32, 7168
s_add_u32 s43, s61, s42
s_add_u32 s42, s42, s44
s_mov_b32 m0, s42
s_nop 0
buffer_load_dwordx4 v1, s[8:11], s43 offen offset:0 sc1 lds
buffer_load_dwordx4 v1, s[8:11], s43 offen offset:1024 sc1 lds
buffer_load_dwordx4 v1, s[8:11], s43 offen offset:2048 sc1 lds
buffer_load_dwordx4 v1, s[8:11], s43 offen offset:3072 sc1 lds
s_add_u32 s43, s43, 4096
s_add_u32 m0, s42, 4096
s_nop 0
buffer_load_dwordx4 v1, s[8:11], s43 offen offset:0 sc1 lds
buffer_load_dwordx4 v1, s[8:11], s43 offen offset:1024 sc1 lds
buffer_load_dwordx4 v1, s[8:11], s43 offen offset:2048 sc1 lds
s_lshl_b32 s42, s32, 10
s_add_u32 s43, s62, s42
s_add_u32 s42, s42, s44
s_add_u32 m0, s42, 28672
s_nop 0
buffer_load_dwordx4 v1, s[8:11], s43 offen sc1 lds
s_mov_b32 s97, 1
v_mov_b32 v110, v16
v_mov_b32 v111, v20
v_mov_b32 v112, v24
v_mov_b32 v113, v28
v_mov_b32 v114, v32
v_mov_b32 v115, v36
v_mov_b32 v116, v40
v_mov_b32 v0, 126464
v_mov_b32 v8, 0
v_mov_b32 v9, 0
v_mov_b32 v10, 0
v_mov_b32 v11, 0
ds_write_b128 v0, v[8:11]
ds_write_b128 v0, v[8:11] offset:16
s_mov_b32 s96, 126464
s_mov_b32 s94, 1
s_mov_b32 s93, 3
v_mov_b32 v15, 1
s_waitcnt lgkmcnt(0)
s_barrier
s_mov_b32 s19, 0
v_lshrrev_b32 v8, 8, v1
v_mul_u32_u24 v4, 896, v8
v_bfe_u32 v8, v1, 4, 4
v_lshl_add_u32 v4, v8, 3, v4
v_add_u32 v4, 28672, v4
s_waitcnt vmcnt(0)
LY_loop:
s_xor_b32 s44, s95, 32768
s_mul_i32 s45, s32, 7168
s_add_u32 s45, s45, s44
v_add_u32 v8, s45, v1
s_lshl_b32 s45, s32, 10
v_add_u32 v9, s45, v1
v_min_u32 v9, 3568, v9
v_add_u32 v9, s44, v9
s_cmp_eq_u32 s97, 0
s_cbranch_scc1 Lxb_58
s_waitcnt vmcnt(7)
Lxt_57:
s_cmp_eq_u32 s74, 1
s_cbranch_scc1 Lxv_60
ds_read_b128 v[72:75], v8 offset:0
ds_read_b128 v[76:79], v8 offset:1024
ds_read_b128 v[80:83], v8 offset:2048
ds_read_b128 v[84:87], v8 offset:3072
ds_read_b128 v[88:91], v8 offset:4096
ds_read_b128 v[92:95], v8 offset:5120
ds_read_b128 v[96:99], v8 offset:6144
ds_read_b128 v[100:103], v9 offset:28672
s_waitcnt lgkmcnt(6)
v_max3_u32 v10, v72, v73, v74
v_max3_u32 v11, v75, v76, v77
v_max3_u32 v10, v10, v78, v79
s_waitcnt lgkmcnt(4)
v_max3_u32 v10, v10, v80, v81
v_max3_u32 v11, v11, v82, v83
v_max3_u32 v10, v10, v84, v85
v_max3_u32 v11, v11, v86, v87
s_waitcnt lgkmcnt(2)
v_max3_u32 v10, v10, v88, v89
v_max3_u32 v11, v11, v90, v91
v_max3_u32 v10, v10, v92, v93
v_max3_u32 v11, v11, v94, v95
s_waitcnt lgkmcnt(0)
v_max3_u32 v10, v10, v96, v97
v_max3_u32 v11, v11, v98, v99
v_max3_u32 v10, v10, v100, v101
v_max3_u32 v11, v11, v102, v103
v_max_u32 v10, v10, v11
v_cmp_eq_u32 vcc, -1, v10
s_nop 0
s_cbranch_vccnz Lxe_61
Lxv_60:
s_xor_b32 s95, s95, 32768
v_add_u32 v3, s95, v1
v_xor_b32 v4, 32768, v4
s_barrier
v_add_u32 v7, s76, v3
ds_read_b128 v[72:75], v3 offset:0
ds_read_b128 v[76:79], v3 offset:1024
ds_read2_b64 v[88:91], v4 offset0:0 offset1:16
ds_read2_b64 v[92:95], v4 offset0:32 offset1:48
ds_read2_b64 v[96:99], v4 offset0:64 offset1:80
ds_read2_b64 v[100:103], v4 offset0:96 offset1:112
ds_read_b128 v[84:87], v7
s_waitcnt lgkmcnt(6)
v_mfma_f32_16x16x32_bf16 v[16:19], v[72:75], a[0:3], 0
ds_read_b128 v[80:83], v3 offset:2048
v_mfma_f32_16x16x32_bf16 v[24:27], v[72:75], a[56:59], 0
s_add_u32 s94, s94, 1
s_mov_b32 s37, s72
s_mov_b32 s38, s73
v_mfma_f32_16x16x32_bf16 v[32:35], v[72:75], a[112:115], 0
s_cmp_lg_u32 s98, 0
s_cselect_b32 s53, s96, 126484
s_cselect_b32 s99, s99, 2146435072
v_mfma_f32_16x16x32_bf16 v[40:43], v[72:75], a[168:171], 0
s_mov_b32 s98, 0
s_lshl_b32 s43, s38, 6
s_add_u32 s43, s43, s37
v_mfma_f32_16x16x32_bf16 v[48:51], v[72:75], a[224:227], 0
s_xor_b32 s49, s95, 32768
s_mul_i32 s50, s32, 7168
s_add_u32 s48, s49, s50
v_mfma_f32_16x16x32_bf16 v[56:59], v[72:75], v[144:147], 0
s_lshl_b32 s51, s32, 10
s_add_u32 s49, s49, s51
s_add_u32 s49, s49, 28672
v_mfma_f32_16x16x32_bf16 v[64:67], v[72:75], v[200:203], 0
buffer_load_dword v14, v118, s[8:11], s100 offen sc1
s_waitcnt lgkmcnt(1)
s_waitcnt lgkmcnt(6)
v_mfma_f32_16x16x32_bf16 v[16:19], v[76:79], a[4:7], v[16:19]
ds_read_b128 v[72:75], v3 offset:3072
v_mfma_f32_16x16x32_bf16 v[24:27], v[76:79], a[60:63], v[24:27]
s_mul_i32 s64, s43, 28672
v_add_f32 v88, v88, v90
v_add_f32 v92, v92, v94
v_mfma_f32_16x16x32_bf16 v[32:35], v[76:79], a[116:119], v[32:35]
s_add_u32 s64, s64, s20
v_add_f32 v96, v96, v98
v_add_f32 v89, v89, v91
v_mfma_f32_16x16x32_bf16 v[40:43], v[76:79], a[172:175], v[40:43]
s_cmp_lt_u32 s59, 7
s_cselect_b32 s64, s64, 2146435072
v_add_f32 v93, v93, v95
v_mfma_f32_16x16x32_bf16 v[48:51], v[76:79], a[228:231], v[48:51]
s_mul_i32 s63, s43, 458752
v_add_f32 v97, v97, v99
v_add_f32 v88, v88, v92
v_mfma_f32_16x16x32_bf16 v[56:59], v[76:79], v[148:151], v[56:59]
s_add_u32 s63, s63, s21
v_add_f32 v96, v96, v100
v_add_f32 v89, v89, v93
v_mfma_f32_16x16x32_bf16 v[64:67], v[76:79], v[204:207], v[64:67]
v_add_f32 v97, v97, v101
v_add_f32 v90, v88, v96
s_waitcnt lgkmcnt(1)
v_mfma_f32_16x16x32_bf16 v[16:19], v[80:83], a[8:11], v[16:19]
ds_read_b128 v[76:79], v3 offset:4096
v_mfma_f32_16x16x32_bf16 v[24:27], v[80:83], a[64:67], v[24:27]
s_lshr_b32 s54, s37, 5
v_add_f32 v88, v88, v96
v_add_f32 v91, v89, v97
v_mfma_f32_16x16x32_bf16 v[32:35], v[80:83], a[120:123], v[32:35]
s_lshl_b32 s54, s54, 12
v_add_f32 v89, v89, v97
v_mfma_f32_16x16x32_bf16 v[40:43], v[80:83], a[176:179], v[40:43]
s_and_b32 s55, s37, 31
v_permlane16_swap_b32 v88, v90
v_mfma_f32_16x16x32_bf16 v[48:51], v[80:83], a[232:235], v[48:51]
s_lshl2_add_u32 s54, s55, s54
v_permlane16_swap_b32 v89, v91
v_mfma_f32_16x16x32_bf16 v[56:59], v[80:83], v[152:155], v[56:59]
s_lshl_b32 s55, s38, 13
v_add_f32 v88, v88, v90
v_add_f32 v89, v89, v91
v_mfma_f32_16x16x32_bf16 v[64:67], v[80:83], v[208:211], v[64:67]
v_mul_f32 v88, 0x3b124925, v88
v_mul_f32 v89, 0x3b124925, v89
s_waitcnt lgkmcnt(1)
v_mfma_f32_16x16x32_bf16 v[16:19], v[72:75], a[12:15], v[16:19]
ds_read_b128 v[80:83], v3 offset:5120
v_mfma_f32_16x16x32_bf16 v[24:27], v[72:75], a[68:71], v[24:27]
s_add_u32 s54, s54, s55
v_fma_f32 v89, -v88, v88, v89
v_max_f32 v89, 0, v89
v_mfma_f32_16x16x32_bf16 v[32:35], v[72:75], a[124:127], v[32:35]
s_add_u32 s77, s54, 118423552
v_cvt_pk_bf16_f32 v88, v89, v88
v_lshlrev_b32 v89, 16, v88
v_mfma_f32_16x16x32_bf16 v[40:43], v[72:75], a[180:183], v[40:43]
s_lshl_b32 s41, s59, 7
v_and_b32 v106, 0xffff0000, v88
v_add_f32 v89, 0x3727c5ac, v89
v_mfma_f32_16x16x32_bf16 v[48:51], v[72:75], a[236:239], v[48:51]
s_add_u32 s77, s77, s41
v_cvt_pk_bf16_f32 v89, v89, v89
v_lshlrev_b32 v89, 16, v89
v_mfma_f32_16x16x32_bf16 v[56:59], v[72:75], v[156:159], v[56:59]
s_add_u32 s75, s77, 16384
v_sqrt_f32 v89, v89
v_mfma_f32_16x16x32_bf16 v[64:67], v[72:75], v[212:215], v[64:67]
v_cvt_pk_bf16_f32 v89, v89, v89
v_lshlrev_b32 v89, 16, v89
s_waitcnt lgkmcnt(1)
v_mfma_f32_16x16x32_bf16 v[16:19], v[76:79], a[16:19], v[16:19]
ds_read_b128 v[72:75], v3 offset:6144
v_mfma_f32_16x16x32_bf16 v[24:27], v[76:79], a[72:75], v[24:27]
s_cmp_lt_u32 s59, 7
s_cselect_b32 s75, s75, 2146435072
v_mfma_f32_16x16x32_bf16 v[32:35], v[76:79], a[128:131], v[32:35]
s_add_u32 s72, s72, s66
v_rcp_f32 v104, v89
v_mfma_f32_16x16x32_bf16 v[40:43], v[76:79], a[184:187], v[40:43]
s_cmp_ge_u32 s72, s65
s_cselect_b32 s42, 1, 0
s_cselect_b32 s72, s68, s72
v_mfma_f32_16x16x32_bf16 v[48:51], v[76:79], a[240:243], v[48:51]
s_cmp_lg_u32 s42, 0
s_cselect_b32 s73, s69, s73
s_cselect_b32 s66, s70, s66
v_mfma_f32_16x16x32_bf16 v[56:59], v[76:79], v[160:163], v[56:59]
s_cmp_lg_u32 s42, 0
s_cselect_b32 s65, 64, s65
v_mul_f32 v108, v104, v106
v_mfma_f32_16x16x32_bf16 v[64:67], v[76:79], v[216:219], v[64:67]
ds_write_b32 v5, v104
s_waitcnt lgkmcnt(2)
v_mfma_f32_16x16x32_bf16 v[16:19], v[80:83], a[20:23], v[16:19]
ds_read_b128 v[76:79], v3 offset:7168
v_mfma_f32_16x16x32_bf16 v[24:27], v[80:83], a[76:79], v[24:27]
ds_write_b32 v5, v108 offset:64
v_mov_b32 v119, s53
v_mfma_f32_16x16x32_bf16 v[32:35], v[80:83], a[132:135], v[32:35]
s_waitcnt vmcnt(1)
s_mov_b64 exec, 1
ds_add_rtn_u32 v119, v119, v15
s_mov_b64 exec, -1
v_mfma_f32_16x16x32_bf16 v[40:43], v[80:83], a[188:191], v[40:43]
ds_read_b128 v[88:91], v6 offset:0
v_mfma_f32_16x16x32_bf16 v[48:51], v[80:83], a[244:247], v[48:51]
ds_read_b128 v[92:95], v6 offset:64
v_mfma_f32_16x16x32_bf16 v[56:59], v[80:83], v[164:167], v[56:59]
ds_read_b128 v[96:99], v6 offset:128
v_mfma_f32_16x16x32_bf16 v[64:67], v[80:83], v[220:223], v[64:67]
ds_read_b128 v[100:103], v6 offset:192
s_waitcnt lgkmcnt(8)
v_mfma_f32_16x16x32_bf16 v[16:19], v[72:75], a[24:27], v[16:19]
ds_read_b128 v[80:83], v3 offset:8192
v_mfma_f32_16x16x32_bf16 v[24:27], v[72:75], a[80:83], v[24:27]
s_waitcnt lgkmcnt(5)
v_readfirstlane_b32 s52, v119
v_mov_b32 v105, v104
v_mfma_f32_16x16x32_bf16 v[32:35], v[72:75], a[136:139], v[32:35]
s_and_b32 s52, s52, s93
s_cmp_eq_u32 s52, s93
s_cselect_b32 s52, s99, 2146435072
v_mfma_f32_16x16x32_bf16 v[40:43], v[72:75], a[192:195], v[40:43]
buffer_store_dword v15, off, s[8:11], s52 sc1
v_mov_b32 v107, v106
v_mfma_f32_16x16x32_bf16 v[48:51], v[72:75], a[248:251], v[48:51]
s_add_u32 s67, s67, s42
v_permlane32_swap_b32 v104, v105
v_mfma_f32_16x16x32_bf16 v[56:59], v[72:75], v[168:171], v[56:59]
s_mul_i32 s61, s73, 3670016
v_permlane32_swap_b32 v106, v107
v_mfma_f32_16x16x32_bf16 v[64:67], v[72:75], v[224:227], v[64:67]
v_cndmask_b32 v8, v104, v105, s[78:79]
v_cndmask_b32 v9, v106, v107, s[78:79]
s_waitcnt lgkmcnt(7)
v_mfma_f32_16x16x32_bf16 v[16:19], v[76:79], a[28:31], v[16:19]
ds_read_b128 v[72:75], v3 offset:9216
v_mfma_f32_16x16x32_bf16 v[24:27], v[76:79], a[84:87], v[24:27]
s_mul_i32 s40, s72, 28672
v_lshlrev_b32 v10, 16, v84
v_and_b32 v11, 0xffff0000, v84
v_mfma_f32_16x16x32_bf16 v[32:35], v[76:79], a[140:143], v[32:35]
s_add_u32 s61, s61, s40
v_sub_f32 v10, v10, v9
v_sub_f32 v11, v11, v9
v_mfma_f32_16x16x32_bf16 v[40:43], v[76:79], a[196:199], v[40:43]
s_add_u32 s61, s61, 12845056
v_cvt_pk_bf16_f32 v10, v10, v11
v_and_b32 v11, 0xffff0000, v10
v_mfma_f32_16x16x32_bf16 v[48:51], v[76:79], a[252:255], v[48:51]
s_mul_i32 s62, s73, 524288
v_lshlrev_b32 v10, 16, v10
v_mul_f32 v10, v10, v8
v_mfma_f32_16x16x32_bf16 v[56:59], v[76:79], v[172:175], v[56:59]
s_lshl_b32 s40, s72, 12
v_mul_f32 v11, v11, v8
v_cvt_pk_bf16_f32 v84, v10, v11
v_mfma_f32_16x16x32_bf16 v[64:67], v[76:79], v[228:231], v[64:67]
v_lshlrev_b32 v10, 16, v85
v_and_b32 v11, 0xffff0000, v85
s_waitcnt lgkmcnt(1)
v_mfma_f32_16x16x32_bf16 v[16:19], v[80:83], a[32:35], v[16:19]
ds_read_b128 v[76:79], v3 offset:10240
v_mfma_f32_16x16x32_bf16 v[24:27], v[80:83], a[88:91], v[24:27]
s_add_u32 s62, s62, s40
v_sub_f32 v10, v10, v9
v_sub_f32 v11, v11, v9
v_mfma_f32_16x16x32_bf16 v[32:35], v[80:83], a[144:147], v[32:35]
s_add_u32 s62, s62, 118603776
v_cvt_pk_bf16_f32 v10, v10, v11
v_and_b32 v11, 0xffff0000, v10
v_mfma_f32_16x16x32_bf16 v[40:43], v[80:83], a[200:203], v[40:43]
s_add_u32 s74, s73, 1
v_lshlrev_b32 v10, 16, v10
v_mul_f32 v10, v10, v8
v_mfma_f32_16x16x32_bf16 v[48:51], v[80:83], v[120:123], v[48:51]
s_cmp_ge_u32 s67, 2
s_cselect_b32 s74, 0, s74
v_mul_f32 v11, v11, v8
v_mfma_f32_16x16x32_bf16 v[56:59], v[80:83], v[176:179], v[56:59]
v_cvt_pk_bf16_f32 v85, v10, v11
v_lshlrev_b32 v10, 16, v86
v_mfma_f32_16x16x32_bf16 v[64:67], v[80:83], v[232:235], v[64:67]
v_and_b32 v11, 0xffff0000, v86
v_sub_f32 v10, v10, v9
s_waitcnt lgkmcnt(1)
v_mfma_f32_16x16x32_bf16 v[16:19], v[72:75], a[36:39], v[16:19]
ds_read_b128 v[80:83], v3 offset:11264
v_mfma_f32_16x16x32_bf16 v[24:27], v[72:75], a[92:95], v[24:27]
v_sub_f32 v11, v11, v9
v_cvt_pk_bf16_f32 v10, v10, v11
v_mfma_f32_16x16x32_bf16 v[32:35], v[72:75], a[148:151], v[32:35]
v_and_b32 v11, 0xffff0000, v10
v_lshlrev_b32 v10, 16, v10
v_mfma_f32_16x16x32_bf16 v[40:43], v[72:75], a[204:207], v[40:43]
v_mul_f32 v10, v10, v8
v_mul_f32 v11, v11, v8
v_mfma_f32_16x16x32_bf16 v[48:51], v[72:75], v[124:127], v[48:51]
v_cvt_pk_bf16_f32 v86, v10, v11
v_lshlrev_b32 v10, 16, v87
v_mfma_f32_16x16x32_bf16 v[56:59], v[72:75], v[180:183], v[56:59]
v_and_b32 v11, 0xffff0000, v87
v_sub_f32 v10, v10, v9
v_mfma_f32_16x16x32_bf16 v[64:67], v[72:75], v[236:239], v[64:67]
v_sub_f32 v11, v11, v9
v_cvt_pk_bf16_f32 v10, v10, v11
s_waitcnt lgkmcnt(1)
v_mfma_f32_16x16x32_bf16 v[16:19], v[76:79], a[40:43], v[16:19]
ds_read_b128 v[72:75], v3 offset:12288
v_mfma_f32_16x16x32_bf16 v[24:27], v[76:79], a[96:99], v[24:27]
v_and_b32 v11, 0xffff0000, v10
v_lshlrev_b32 v10, 16, v10
v_mfma_f32_16x16x32_bf16 v[32:35], v[76:79], a[152:155], v[32:35]
v_mul_f32 v10, v10, v8
v_mul_f32 v11, v11, v8
v_mfma_f32_16x16x32_bf16 v[40:43], v[76:79], a[208:211], v[40:43]
v_cvt_pk_bf16_f32 v87, v10, v11
v_mfma_f32_16x16x32_bf16 v[48:51], v[76:79], v[128:131], v[48:51]
buffer_store_dwordx4 v[84:87], v1, s[8:11], s64 offen sc1
v_mfma_f32_16x16x32_bf16 v[56:59], v[76:79], v[184:187], v[56:59]
v_mfma_f32_16x16x32_bf16 v[64:67], v[76:79], v[240:243], v[64:67]
s_waitcnt lgkmcnt(1)
v_mfma_f32_16x16x32_bf16 v[16:19], v[80:83], a[44:47], v[16:19]
ds_read_b128 v[76:79], v3 offset:13312
v_mfma_f32_16x16x32_bf16 v[24:27], v[80:83], a[100:103], v[24:27]
v_mfma_f32_16x16x32_bf16 v[32:35], v[80:83], a[156:159], v[32:35]
v_mfma_f32_16x16x32_bf16 v[40:43], v[80:83], a[212:215], v[40:43]
v_mfma_f32_16x16x32_bf16 v[48:51], v[80:83], v[132:135], v[48:51]
v_mfma_f32_16x16x32_bf16 v[56:59], v[80:83], v[188:191], v[56:59]
v_mfma_f32_16x16x32_bf16 v[64:67], v[80:83], v[244:247], v[64:67]
s_waitcnt lgkmcnt(1)
v_mfma_f32_16x16x32_bf16 v[16:19], v[72:75], a[48:51], v[16:19]
ds_read_b128 v[80:83], v3 offset:14336
v_mfma_f32_16x16x32_bf16 v[24:27], v[72:75], a[104:107], v[24:27]
v_mfma_f32_16x16x32_bf16 v[32:35], v[72:75], a[160:163], v[32:35]
v_mfma_f32_16x16x32_bf16 v[40:43], v[72:75], a[216:219], v[40:43]
v_mfma_f32_16x16x32_bf16 v[48:51], v[72:75], v[136:139], v[48:51]
v_mfma_f32_16x16x32_bf16 v[56:59], v[72:75], v[192:195], v[56:59]
v_mfma_f32_16x16x32_bf16 v[64:67], v[72:75], v[248:251], v[64:67]
s_waitcnt lgkmcnt(1)
v_mfma_f32_16x16x32_bf16 v[16:19], v[76:79], a[52:55], v[16:19]
ds_read_b128 v[72:75], v3 offset:15360
v_mfma_f32_16x16x32_bf16 v[24:27], v[76:79], a[108:111], v[24:27]
v_mfma_f32_16x16x32_bf16 v[32:35], v[76:79], a[164:167], v[32:35]
v_mfma_f32_16x16x32_bf16 v[40:43], v[76:79], a[220:223], v[40:43]
v_mfma_f32_16x16x32_bf16 v[48:51], v[76:79], v[140:143], v[48:51]
v_mfma_f32_16x16x32_bf16 v[56:59], v[76:79], v[196:199], v[56:59]
v_mfma_f32_16x16x32_bf16 v[64:67], v[76:79], v[252:255], v[64:67]
s_waitcnt lgkmcnt(1)
v_mfma_f32_16x16x32_bf16 v[20:23], v[80:83], a[0:3], 0
ds_read_b128 v[76:79], v3 offset:16384
v_mfma_f32_16x16x32_bf16 v[28:31], v[80:83], a[56:59], 0
v_mfma_f32_16x16x32_bf16 v[36:39], v[80:83], a[112:115], 0
v_mfma_f32_16x16x32_bf16 v[44:47], v[80:83], a[168:171], 0
s_waitcnt lgkmcnt(9)
v_mul_f32 v8, v92, v110
v_mul_f32 v9, v93, v110
v_mfma_f32_16x16x32_bf16 v[52:55], v[80:83], a[224:227], 0
v_mul_f32 v10, v94, v110
v_mul_f32 v11, v95, v110
v_mfma_f32_16x16x32_bf16 v[60:63], v[80:83], v[144:147], 0
v_fma_f32 v16, v16, v88, -v8
v_fma_f32 v17, v17, v89, -v9
v_mfma_f32_16x16x32_bf16 v[68:71], v[80:83], v[200:203], 0
v_fma_f32 v18, v18, v90, -v10
v_fma_f32 v19, v19, v91, -v11
s_waitcnt lgkmcnt(1)
v_mfma_f32_16x16x32_bf16 v[20:23], v[72:75], a[4:7], v[20:23]
ds_read_b128 v[80:83], v3 offset:17408
v_mfma_f32_16x16x32_bf16 v[28:31], v[72:75], a[60:63], v[28:31]
buffer_load_dword v13, v2, s[8:11], s62 offen sc1
v_cvt_pk_bf16_f32 v16, v16, v17
v_cvt_pk_bf16_f32 v17, v18, v19
v_mfma_f32_16x16x32_bf16 v[36:39], v[72:75], a[116:119], v[36:39]
v_mul_f32 v8, v92, v111
v_mul_f32 v9, v93, v111
v_mfma_f32_16x16x32_bf16 v[44:47], v[72:75], a[172:175], v[44:47]
v_mul_f32 v10, v94, v111
v_mul_f32 v11, v95, v111
v_mfma_f32_16x16x32_bf16 v[52:55], v[72:75], a[228:231], v[52:55]
v_fma_f32 v24, v24, v88, -v8
v_fma_f32 v25, v25, v89, -v9
v_mfma_f32_16x16x32_bf16 v[60:63], v[72:75], v[148:151], v[60:63]
v_fma_f32 v26, v26, v90, -v10
v_fma_f32 v27, v27, v91, -v11
v_mfma_f32_16x16x32_bf16 v[68:71], v[72:75], v[204:207], v[68:71]
v_cvt_pk_bf16_f32 v24, v24, v25
v_cvt_pk_bf16_f32 v25, v26, v27
s_waitcnt lgkmcnt(1)
v_mfma_f32_16x16x32_bf16 v[20:23], v[76:79], a[8:11], v[20:23]
ds_read_b128 v[72:75], v3 offset:18432
v_mfma_f32_16x16x32_bf16 v[28:31], v[76:79], a[64:67], v[28:31]
v_mul_f32 v8, v92, v112
v_mul_f32 v9, v93, v112
v_mfma_f32_16x16x32_bf16 v[36:39], v[76:79], a[120:123], v[36:39]
v_mul_f32 v10, v94, v112
v_mul_f32 v11, v95, v112
v_mfma_f32_16x16x32_bf16 v[44:47], v[76:79], a[176:179], v[44:47]
v_fma_f32 v32, v32, v88, -v8
v_fma_f32 v33, v33, v89, -v9
v_mfma_f32_16x16x32_bf16 v[52:55], v[76:79], a[232:235], v[52:55]
v_fma_f32 v34, v34, v90, -v10
v_fma_f32 v35, v35, v91, -v11
v_mfma_f32_16x16x32_bf16 v[60:63], v[76:79], v[152:155], v[60:63]
v_mov_b32 v12, s58
v_cvt_pk_bf16_f32 v32, v32, v33
v_mfma_f32_16x16x32_bf16 v[68:71], v[76:79], v[208:211], v[68:71]
v_cvt_pk_bf16_f32 v33, v34, v35
v_mul_f32 v8, v92, v113
s_waitcnt lgkmcnt(1)
v_mfma_f32_16x16x32_bf16 v[20:23], v[80:83], a[12:15], v[20:23]
ds_read_b128 v[76:79], v3 offset:19456
v_mfma_f32_16x16x32_bf16 v[28:31], v[80:83], a[68:71], v[28:31]
s_waitcnt vmcnt(1)
v_mul_f32 v9, v93, v113
v_mul_f32 v10, v94, v113
v_mfma_f32_16x16x32_bf16 v[36:39], v[80:83], a[124:127], v[36:39]
s_mov_b64 exec, 1
ds_add_rtn_u32 v12, v12, v15
s_mov_b64 exec, -1
v_mfma_f32_16x16x32_bf16 v[44:47], v[80:83], a[180:183], v[44:47]
v_mul_f32 v11, v95, v113
v_fma_f32 v40, v40, v88, -v8
v_mfma_f32_16x16x32_bf16 v[52:55], v[80:83], a[236:239], v[52:55]
v_fma_f32 v41, v41, v89, -v9
v_fma_f32 v42, v42, v90, -v10
v_mfma_f32_16x16x32_bf16 v[60:63], v[80:83], v[156:159], v[60:63]
v_fma_f32 v43, v43, v91, -v11
v_cvt_pk_bf16_f32 v40, v40, v41
v_mfma_f32_16x16x32_bf16 v[68:71], v[80:83], v[212:215], v[68:71]
v_cvt_pk_bf16_f32 v41, v42, v43
v_mul_f32 v8, v92, v114
s_waitcnt lgkmcnt(2)
v_mfma_f32_16x16x32_bf16 v[20:23], v[72:75], a[16:19], v[20:23]
ds_read_b128 v[80:83], v3 offset:20480
v_mfma_f32_16x16x32_bf16 v[28:31], v[72:75], a[72:75], v[28:31]
s_waitcnt lgkmcnt(1)
v_readfirstlane_b32 s52, v12
v_mul_f32 v9, v93, v114
v_mfma_f32_16x16x32_bf16 v[36:39], v[72:75], a[128:131], v[36:39]
s_and_b32 s52, s52, s93
s_cmp_eq_u32 s52, s93
s_cselect_b32 s52, s75, 2146435072
v_mfma_f32_16x16x32_bf16 v[44:47], v[72:75], a[184:187], v[44:47]
buffer_store_dword v15, off, s[8:11], s52 sc1
v_mul_f32 v10, v94, v114
v_mul_f32 v11, v95, v114
v_mfma_f32_16x16x32_bf16 v[52:55], v[72:75], a[240:243], v[52:55]
v_fma_f32 v48, v48, v88, -v8
v_fma_f32 v49, v49, v89, -v9
v_mfma_f32_16x16x32_bf16 v[60:63], v[72:75], v[160:163], v[60:63]
v_fma_f32 v50, v50, v90, -v10
v_fma_f32 v51, v51, v91, -v11
v_mfma_f32_16x16x32_bf16 v[68:71], v[72:75], v[216:219], v[68:71]
v_cvt_pk_bf16_f32 v48, v48, v49
v_cvt_pk_bf16_f32 v49, v50, v51
s_waitcnt lgkmcnt(2)
v_mfma_f32_16x16x32_bf16 v[20:23], v[76:79], a[20:23], v[20:23]
ds_read_b128 v[72:75], v3 offset:21504
v_mfma_f32_16x16x32_bf16 v[28:31], v[76:79], a[76:79], v[28:31]
v_mul_f32 v8, v92, v115
v_mul_f32 v9, v93, v115
v_mfma_f32_16x16x32_bf16 v[36:39], v[76:79], a[132:135], v[36:39]
v_mul_f32 v10, v94, v115
v_mul_f32 v11, v95, v115
v_mfma_f32_16x16x32_bf16 v[44:47], v[76:79], a[188:191], v[44:47]
v_fma_f32 v56, v56, v88, -v8
v_fma_f32 v57, v57, v89, -v9
v_mfma_f32_16x16x32_bf16 v[52:55], v[76:79], a[244:247], v[52:55]
v_fma_f32 v58, v58, v90, -v10
v_fma_f32 v59, v59, v91, -v11
v_mfma_f32_16x16x32_bf16 v[60:63], v[76:79], v[164:167], v[60:63]
v_cvt_pk_bf16_f32 v56, v56, v57
v_cvt_pk_bf16_f32 v57, v58, v59
v_mfma_f32_16x16x32_bf16 v[68:71], v[76:79], v[220:223], v[68:71]
v_mul_f32 v8, v92, v116
v_mul_f32 v9, v93, v116
s_waitcnt lgkmcnt(1)
v_mfma_f32_16x16x32_bf16 v[20:23], v[80:83], a[24:27], v[20:23]
ds_read_b128 v[76:79], v3 offset:22528
v_mfma_f32_16x16x32_bf16 v[28:31], v[80:83], a[80:83], v[28:31]
v_mul_f32 v10, v94, v116
v_mul_f32 v11, v95, v116
v_mfma_f32_16x16x32_bf16 v[36:39], v[80:83], a[136:139], v[36:39]
v_fma_f32 v64, v64, v88, -v8
v_fma_f32 v65, v65, v89, -v9
v_mfma_f32_16x16x32_bf16 v[44:47], v[80:83], a[192:195], v[44:47]
v_fma_f32 v66, v66, v90, -v10
v_fma_f32 v67, v67, v91, -v11
v_mfma_f32_16x16x32_bf16 v[52:55], v[80:83], a[248:251], v[52:55]
v_cvt_pk_bf16_f32 v64, v64, v65
v_cvt_pk_bf16_f32 v65, v66, v67
v_mfma_f32_16x16x32_bf16 v[60:63], v[80:83], v[168:171], v[60:63]
v_mfma_f32_16x16x32_bf16 v[68:71], v[80:83], v[224:227], v[68:71]
s_waitcnt lgkmcnt(1)
v_mfma_f32_16x16x32_bf16 v[20:23], v[72:75], a[28:31], v[20:23]
ds_read_b128 v[80:83], v3 offset:23552
v_mfma_f32_16x16x32_bf16 v[28:31], v[72:75], a[84:87], v[28:31]
v_mfma_f32_16x16x32_bf16 v[36:39], v[72:75], a[140:143], v[36:39]
v_mfma_f32_16x16x32_bf16 v[44:47], v[72:75], a[196:199], v[44:47]
v_mfma_f32_16x16x32_bf16 v[52:55], v[72:75], a[252:255], v[52:55]
v_mfma_f32_16x16x32_bf16 v[60:63], v[72:75], v[172:175], v[60:63]
s_waitcnt vmcnt(1)
v_subrev_u32 v14, s23, v14
v_ashrrev_i32 v14, 31, v14
v_mfma_f32_16x16x32_bf16 v[68:71], v[72:75], v[228:231], v[68:71]
v_or_b32 v13, v13, v14
v_cmp_eq_u32 vcc, -1, v13
s_waitcnt lgkmcnt(1)
v_mfma_f32_16x16x32_bf16 v[20:23], v[76:79], a[32:35], v[20:23]
ds_read_b128 v[72:75], v3 offset:24576
v_mfma_f32_16x16x32_bf16 v[28:31], v[76:79], a[88:91], v[28:31]
s_cmp_eq_u64 vcc, 0
s_cselect_b32 s97, 3, 1
s_and_b32 s97, s97, s74
v_mfma_f32_16x16x32_bf16 v[36:39], v[76:79], a[144:147], v[36:39]
s_add_u32 s56, s61, s50
s_add_u32 s57, s62, s51
v_mfma_f32_16x16x32_bf16 v[44:47], v[76:79], a[200:203], v[44:47]
s_cmp_lg_u32 s97, 0
s_cselect_b32 s56, s56, 2146435072
s_cselect_b32 s57, s57, 2146435072
v_mfma_f32_16x16x32_bf16 v[52:55], v[76:79], v[120:123], v[52:55]
s_cmp_lg_u32 s97, 0
s_cselect_b32 s52, 4, 24
v_add_u32 v13, s52, v0
v_mfma_f32_16x16x32_bf16 v[60:63], v[76:79], v[176:179], v[60:63]
v_mov_b32 v119, s94
v_mfma_f32_16x16x32_bf16 v[68:71], v[76:79], v[232:235], v[68:71]
ds_write_b32 v13, v119
s_waitcnt lgkmcnt(2)
v_mfma_f32_16x16x32_bf16 v[20:23], v[80:83], a[36:39], v[20:23]
ds_read_b128 v[76:79], v3 offset:25600
v_mfma_f32_16x16x32_bf16 v[28:31], v[80:83], a[92:95], v[28:31]
s_mov_b32 m0, s48
v_mfma_f32_16x16x32_bf16 v[36:39], v[80:83], a[148:151], v[36:39]
buffer_load_dwordx4 v1, s[8:11], s56 offen offset:0 sc1 lds
v_mfma_f32_16x16x32_bf16 v[44:47], v[80:83], a[204:207], v[44:47]
buffer_load_dwordx4 v1, s[8:11], s56 offen offset:1024 sc1 lds
v_mfma_f32_16x16x32_bf16 v[52:55], v[80:83], v[124:127], v[52:55]
v_mfma_f32_16x16x32_bf16 v[60:63], v[80:83], v[180:183], v[60:63]
v_mfma_f32_16x16x32_bf16 v[68:71], v[80:83], v[236:239], v[68:71]
buffer_load_dwordx4 v1, s[8:11], s56 offen offset:2048 sc1 lds
s_waitcnt lgkmcnt(2)
v_mfma_f32_16x16x32_bf16 v[20:23], v[72:75], a[40:43], v[20:23]
ds_read_b128 v[80:83], v3 offset:26624
v_mfma_f32_16x16x32_bf16 v[28:31], v[72:75], a[96:99], v[28:31]
v_mfma_f32_16x16x32_bf16 v[36:39], v[72:75], a[152:155], v[36:39]
v_mfma_f32_16x16x32_bf16 v[44:47], v[72:75], a[208:211], v[44:47]
buffer_load_dwordx4 v1, s[8:11], s56 offen offset:3072 sc1 lds
v_mfma_f32_16x16x32_bf16 v[52:55], v[72:75], v[128:131], v[52:55]
v_mfma_f32_16x16x32_bf16 v[60:63], v[72:75], v[184:187], v[60:63]
v_mfma_f32_16x16x32_bf16 v[68:71], v[72:75], v[240:243], v[68:71]
s_add_u32 m0, s48, 4096
s_add_u32 s51, s56, 4096
s_waitcnt lgkmcnt(1)
v_mfma_f32_16x16x32_bf16 v[20:23], v[76:79], a[44:47], v[20:23]
ds_read_b128 v[72:75], v3 offset:27648
v_mfma_f32_16x16x32_bf16 v[28:31], v[76:79], a[100:103], v[28:31]
buffer_load_dwordx4 v1, s[8:11], s51 offen offset:0 sc1 lds
v_mfma_f32_16x16x32_bf16 v[36:39], v[76:79], a[156:159], v[36:39]
v_mfma_f32_16x16x32_bf16 v[44:47], v[76:79], a[212:215], v[44:47]
v_mfma_f32_16x16x32_bf16 v[52:55], v[76:79], v[132:135], v[52:55]
buffer_load_dwordx4 v1, s[8:11], s51 offen offset:1024 sc1 lds
v_mfma_f32_16x16x32_bf16 v[60:63], v[76:79], v[188:191], v[60:63]
v_mfma_f32_16x16x32_bf16 v[68:71], v[76:79], v[244:247], v[68:71]
s_waitcnt lgkmcnt(1)
v_mfma_f32_16x16x32_bf16 v[20:23], v[80:83], a[48:51], v[20:23]
v_mfma_f32_16x16x32_bf16 v[28:31], v[80:83], a[104:107], v[28:31]
buffer_load_dwordx4 v1, s[8:11], s51 offen offset:2048 sc1 lds
v_mfma_f32_16x16x32_bf16 v[36:39], v[80:83], a[160:163], v[36:39]
v_mfma_f32_16x16x32_bf16 v[44:47], v[80:83], a[216:219], v[44:47]
v_mfma_f32_16x16x32_bf16 v[52:55], v[80:83], v[136:139], v[52:55]
s_mov_b32 m0, s49
v_mfma_f32_16x16x32_bf16 v[60:63], v[80:83], v[192:195], v[60:63]
buffer_load_dwordx4 v1, s[8:11], s57 offen sc1 lds
v_mfma_f32_16x16x32_bf16 v[68:71], v[80:83], v[248:251], v[68:71]
s_waitcnt lgkmcnt(0)
v_mfma_f32_16x16x32_bf16 v[20:23], v[72:75], a[52:55], v[20:23]
v_mfma_f32_16x16x32_bf16 v[28:31], v[72:75], a[108:111], v[28:31]
v_mfma_f32_16x16x32_bf16 v[36:39], v[72:75], a[164:167], v[36:39]
v_mfma_f32_16x16x32_bf16 v[44:47], v[72:75], a[220:223], v[44:47]
v_mfma_f32_16x16x32_bf16 v[52:55], v[72:75], v[140:143], v[52:55]
v_mfma_f32_16x16x32_bf16 v[60:63], v[72:75], v[196:199], v[60:63]
v_mfma_f32_16x16x32_bf16 v[68:71], v[72:75], v[252:255], v[68:71]
v_pk_mul_f32 v[8:9], v[100:101], v[110:111] op_sel:[0,0] op_sel_hi:[1,0]
v_pk_mul_f32 v[10:11], v[102:103], v[110:111] op_sel:[0,0] op_sel_hi:[1,0]
v_pk_fma_f32 v[20:21], v[20:21], v[96:97], v[8:9] neg_lo:[0,0,1] neg_hi:[0,0,1]
v_pk_fma_f32 v[22:23], v[22:23], v[98:99], v[10:11] neg_lo:[0,0,1] neg_hi:[0,0,1]
v_cvt_pk_bf16_f32 v18, v20, v21
v_cvt_pk_bf16_f32 v19, v22, v23
buffer_store_dwordx4 v[16:19], v1, s[8:11], s63 offen sc1
s_add_u32 s63, s63, 16384
v_pk_mul_f32 v[8:9], v[100:101], v[110:111] op_sel:[0,1] op_sel_hi:[1,1]
v_pk_mul_f32 v[10:11], v[102:103], v[110:111] op_sel:[0,1] op_sel_hi:[1,1]
v_pk_fma_f32 v[28:29], v[28:29], v[96:97], v[8:9] neg_lo:[0,0,1] neg_hi:[0,0,1]
v_pk_fma_f32 v[30:31], v[30:31], v[98:99], v[10:11] neg_lo:[0,0,1] neg_hi:[0,0,1]
v_cvt_pk_bf16_f32 v26, v28, v29
v_cvt_pk_bf16_f32 v27, v30, v31
buffer_store_dwordx4 v[24:27], v1, s[8:11], s63 offen sc1
s_add_u32 s63, s63, 16384
v_pk_mul_f32 v[8:9], v[100:101], v[112:113] op_sel:[0,0] op_sel_hi:[1,0]
v_pk_mul_f32 v[10:11], v[102:103], v[112:113] op_sel:[0,0] op_sel_hi:[1,0]
v_pk_fma_f32 v[36:37], v[36:37], v[96:97], v[8:9] neg_lo:[0,0,1] neg_hi:[0,0,1]
v_pk_fma_f32 v[38:39], v[38:39], v[98:99], v[10:11] neg_lo:[0,0,1] neg_hi:[0,0,1]
v_cvt_pk_bf16_f32 v34, v36, v37
v_cvt_pk_bf16_f32 v35, v38, v39
buffer_store_dwordx4 v[32:35], v1, s[8:11], s63 offen sc1
s_add_u32 s63, s63, 16384
v_pk_mul_f32 v[8:9], v[100:101], v[112:113] op_sel:[0,1] op_sel_hi:[1,1]
v_pk_mul_f32 v[10:11], v[102:103], v[112:113] op_sel:[0,1] op_sel_hi:[1,1]
v_pk_fma_f32 v[44:45], v[44:45], v[96:97], v[8:9] neg_lo:[0,0,1] neg_hi:[0,0,1]
v_pk_fma_f32 v[46:47], v[46:47], v[98:99], v[10:11] neg_lo:[0,0,1] neg_hi:[0,0,1]
v_cvt_pk_bf16_f32 v42, v44, v45
v_cvt_pk_bf16_f32 v43, v46, v47
buffer_store_dwordx4 v[40:43], v1, s[8:11], s63 offen sc1
s_add_u32 s63, s63, 16384
v_pk_mul_f32 v[8:9], v[100:101], v[114:115] op_sel:[0,0] op_sel_hi:[1,0]
v_pk_mul_f32 v[10:11], v[102:103], v[114:115] op_sel:[0,0] op_sel_hi:[1,0]
v_pk_fma_f32 v[52:53], v[52:53], v[96:97], v[8:9] neg_lo:[0,0,1] neg_hi:[0,0,1]
v_pk_fma_f32 v[54:55], v[54:55], v[98:99], v[10:11] neg_lo:[0,0,1] neg_hi:[0,0,1]
v_cvt_pk_bf16_f32 v50, v52, v53
v_cvt_pk_bf16_f32 v51, v54, v55
buffer_store_dwordx4 v[48:51], v1, s[8:11], s63 offen sc1
s_add_u32 s63, s63, 16384
v_pk_mul_f32 v[8:9], v[100:101], v[114:115] op_sel:[0,1] op_sel_hi:[1,1]
v_pk_mul_f32 v[10:11], v[102:103], v[114:115] op_sel:[0,1] op_sel_hi:[1,1]
v_pk_fma_f32 v[60:61], v[60:61], v[96:97], v[8:9] neg_lo:[0,0,1] neg_hi:[0,0,1]
v_pk_fma_f32 v[62:63], v[62:63], v[98:99], v[10:11] neg_lo:[0,0,1] neg_hi:[0,0,1]
v_cvt_pk_bf16_f32 v58, v60, v61
v_cvt_pk_bf16_f32 v59, v62, v63
buffer_store_dwordx4 v[56:59], v1, s[8:11], s63 offen sc1
s_add_u32 s63, s63, 16384
v_pk_mul_f32 v[8:9], v[100:101], v[116:117] op_sel:[0,0] op_sel_hi:[1,0]
v_pk_mul_f32 v[10:11], v[102:103], v[116:117] op_sel:[0,0] op_sel_hi:[1,0]
v_pk_fma_f32 v[68:69], v[68:69], v[96:97], v[8:9] neg_lo:[0,0,1] neg_hi:[0,0,1]
v_pk_fma_f32 v[70:71], v[70:71], v[98:99], v[10:11] neg_lo:[0,0,1] neg_hi:[0,0,1]
v_cvt_pk_bf16_f32 v66, v68, v69
v_cvt_pk_bf16_f32 v67, v70, v71
buffer_store_dwordx4 v[64:67], v1, s[8:11], s63 offen sc1
s_add_u32 s63, s63, 16384
s_mov_b32 s99, s77
s_mov_b32 s98, 1
s_xor_b32 s96, s96, 16
s_cmp_lg_u32 s74, 0
s_cbranch_scc1 LY_loop
s_cmp_eq_u32 s98, 0
s_cbranch_scc1 Lpp_62
s_waitcnt vmcnt(0)
v_mov_b32 v13, s96
s_mov_b64 exec, 1
ds_add_rtn_u32 v13, v13, v15 offset:0
s_mov_b64 exec, -1
s_waitcnt lgkmcnt(0)
v_readfirstlane_b32 s45, v13
s_nop 0
s_and_b32 s45, s45, s93
s_cmp_lg_u32 s45, s93
s_cbranch_scc1 Lpn_63
buffer_store_dword v15, off, s[8:11], s99 sc1
Lpn_63:
s_mov_b32 s98, 0
Lpp_62:
s_cmp_lg_u32 s22, 0
s_cbranch_scc1 L_done
s_waitcnt vmcnt(0) lgkmcnt(0)
s_barrier
s_branch L_roleT
Lxb_58:
s_cmp_lg_u32 s74, 2
s_cbranch_scc1 Lxn_59
s_cmp_eq_u32 s19, 0
s_cbranch_scc1 Lxf_64
v_mov_b32 v13, s94
ds_write_b32 v0, v13 offset:4
s_cmp_eq_u32 s98, 0
s_cbranch_scc1 Lpp_65
s_waitcnt vmcnt(0)
v_mov_b32 v13, s96
s_mov_b64 exec, 1
ds_add_rtn_u32 v13, v13, v15 offset:0
s_mov_b64 exec, -1
s_waitcnt lgkmcnt(0)
v_readfirstlane_b32 s45, v13
s_nop 0
s_and_b32 s45, s45, s93
s_cmp_lg_u32 s45, s93
s_cbranch_scc1 Lpn_66
buffer_store_dword v15, off, s[8:11], s99 sc1
Lpn_66:
s_mov_b32 s98, 0
Lpp_65:
s_branch Lxn_59
Lxe_61:
s_sleep 2
s_branch Lxn_59
Lxf_64:
s_cmp_lg_u32 s32, 3
s_cbranch_scc1 Lpq_71
s_branch Lpg_68
Lpf_67:
s_sleep 2
Lpg_68:
buffer_load_dword v13, v2, s[8:11], s62 offen sc1
buffer_load_dword v14, v118, s[8:11], s100 offen sc1
s_sub_u32 s36, s36, 1
s_cbranch_scc1 L_timeout_16
s_waitcnt vmcnt(0)
v_subrev_u32 v14, s23, v14
v_ashrrev_i32 v14, 31, v14
v_or_b32 v13, v13, v14
v_cmp_eq_u32 vcc, -1, v13
s_cmp_eq_u32 s98, 0
s_cbranch_scc1 Lpp_72
s_waitcnt vmcnt(0)
v_mov_b32 v13, s96
s_mov_b64 exec, 1
ds_add_rtn_u32 v13, v13, v15 offset:0
s_mov_b64 exec, -1
s_waitcnt lgkmcnt(0)
v_readfirstlane_b32 s45, v13
s_nop 0
s_and_b32 s45, s45, s93
s_cmp_lg_u32 s45, s93
s_cbranch_scc1 Lpn_73
buffer_store_dword v15, off, s[8:11], s99 sc1
Lpn_73:
s_mov_b32 s98, 0
Lpp_72:
s_cbranch_vccnz Lpf_67
v_mov_b32 v13, s94
ds_write_b32 v0, v13 offset:4
s_branch Lpe_70
Lpq_71:
s_cmp_eq_u32 s98, 0
s_cbranch_scc1 Lpp_74
s_waitcnt vmcnt(0)
v_mov_b32 v13, s96
s_mov_b64 exec, 1
ds_add_rtn_u32 v13, v13, v15 offset:0
s_mov_b64 exec, -1
s_waitcnt lgkmcnt(0)
v_readfirstlane_b32 s45, v13
s_nop 0
s_and_b32 s45, s45, s93
s_cmp_lg_u32 s45, s93
s_cbranch_scc1 Lpn_75
buffer_store_dword v15, off, s[8:11], s99 sc1
Lpn_75:
s_mov_b32 s98, 0
Lpp_74:
Lph_69:
s_sleep 1
ds_read_b32 v13, v0 offset:4
s_sub_u32 s92, s92, 1
s_cbranch_scc1 L_timeout_16
s_waitcnt lgkmcnt(0)
v_cmp_gt_u32 vcc, s94, v13
s_nop 0
s_cbranch_vccnz Lph_69
Lpe_70:
s_mov_b32 s19, 1
Lxn_59:
s_sub_u32 s36, s36, 1
s_cbranch_scc1 L_timeout_16
s_xor_b32 s44, s95, 32768
s_mul_i32 s42, s32, 7168
s_add_u32 s43, s61, s42
s_add_u32 s42, s42, s44
s_mov_b32 m0, s42
s_nop 0
buffer_load_dwordx4 v1, s[8:11], s43 offen offset:0 sc1 lds
buffer_load_dwordx4 v1, s[8:11], s43 offen offset:1024 sc1 lds
buffer_load_dwordx4 v1, s[8:11], s43 offen offset:2048 sc1 lds
buffer_load_dwordx4 v1, s[8:11], s43 offen offset:3072 sc1 lds
s_add_u32 s43, s43, 4096
s_add_u32 m0, s42, 4096
s_nop 0
buffer_load_dwordx4 v1, s[8:11], s43 offen offset:0 sc1 lds
buffer_load_dwordx4 v1, s[8:11], s43 offen offset:1024 sc1 lds
buffer_load_dwordx4 v1, s[8:11], s43 offen offset:2048 sc1 lds
s_lshl_b32 s42, s32, 10
s_add_u32 s43, s62, s42
s_add_u32 s42, s42, s44
s_add_u32 m0, s42, 28672
s_nop 0
buffer_load_dwordx4 v1, s[8:11], s43 offen sc1 lds
s_waitcnt vmcnt(0)
s_branch Lxt_57
L_done:
s_endpgm
L_timeout_1:
s_mov_b32 s40, 1
s_branch L_timeout
L_timeout_2:
s_mov_b32 s40, 2
s_branch L_timeout
L_timeout_3:
s_mov_b32 s40, 3
s_branch L_timeout
L_timeout_4:
s_mov_b32 s40, 4
s_branch L_timeout
L_timeout_5:
s_mov_b32 s40, 5
s_branch L_timeout
L_timeout_6:
s_mov_b32 s40, 6
s_branch L_timeout
L_timeout_7:
s_mov_b32 s40, 7
s_branch L_timeout
L_timeout_8:
s_mov_b32 s40, 8
s_branch L_timeout
L_timeout_9:
s_mov_b32 s40, 9
s_branch L_timeout
L_timeout_10:
s_mov_b32 s40, 10
s_branch L_timeout
L_timeout_11:
s_mov_b32 s40, 11
s_branch L_timeout
L_timeout_12:
s_mov_b32 s40, 12
s_branch L_timeout
L_timeout_13:
s_mov_b32 s40, 13
s_branch L_timeout
L_timeout_14:
s_mov_b32 s40, 14
s_branch L_timeout
L_timeout_15:
s_mov_b32 s40, 15
s_branch L_timeout
L_timeout_16:
s_mov_b32 s40, 16
s_branch L_timeout
L_timeout_17:
s_mov_b32 s40, 17
s_branch L_timeout
L_timeout_18:
s_mov_b32 s40, 18
s_branch L_timeout
L_timeout_19:
s_mov_b32 s40, 19
s_branch L_timeout
L_timeout_20:
s_mov_b32 s40, 20
s_branch L_timeout
L_timeout_21:
s_mov_b32 s40, 21
s_branch L_timeout
L_timeout_22:
s_mov_b32 s40, 22
s_branch L_timeout
L_timeout_23:
s_mov_b32 s40, 23
s_branch L_timeout
L_timeout:
s_mov_b64 exec, 1
s_lshl_b32 s41, s33, 8
s_or_b32 s40, s40, s41
s_lshl_b32 s41, s34, 16
s_or_b32 s40, s40, s41
s_lshl_b32 s41, s37, 24
s_or_b32 s40, s40, s41
s_and_b32 s41, s40, 7
s_lshl_b32 s41, s41, 5
v_mov_b32 v1, s40
v_mov_b32 v2, s41
buffer_store_dword v1, v2, s[12:15], 0 offen offset:8 sc1
s_waitcnt vmcnt(0)
s_endpgm
L_roleT:
v_mbcnt_lo_u32_b32 v0, -1, 0
v_mbcnt_hi_u32_b32 v0, -1, v0
v_lshlrev_b32 v1, 4, v0
s_mov_b32 s92, 0x1000000
s_mov_b32 s97, 0
s_mov_b32 s98, 0
s_mov_b32 s95, 0
v_min_u32 v2, 27, v0
v_lshlrev_b32 v2, 7, v2
v_min_u32 v119, 6, v0
v_lshlrev_b32 v119, 7, v119
s_and_b32 s59, s34, 15
s_lshr_b32 s77, s34, 4
s_lshr_b32 s38, s33, 2
s_mov_b32 s72, 0
s_and_b32 s42, s32, 1
s_mul_i32 s43, s32, 7
s_mul_i32 s44, s59, 28
s_add_u32 s44, s44, s43
s_add_u32 s60, s44, s42
s_mul_i32 s60, s60, 14336
s_mul_i32 s45, s42, 6
s_sub_u32 s45, 6, s45
s_add_u32 s61, s44, s45
s_mul_i32 s61, s61, 14336
s_add_u32 s64, s43, s42
s_lshr_b32 s64, s64, 1
s_add_u32 s65, s43, s45
s_lshr_b32 s65, s65, 1
s_lshl_b32 s78, s42, 3
s_lshl_b32 s40, s32, 9
s_add_u32 s40, s40, 65536
v_lshrrev_b32 v8, 4, v0
v_lshl_add_u32 v5, v8, 4, s40
v_lshlrev_b32 v6, 7, v8
v_and_b32 v9, 7, v0
v_lshl_add_u32 v6, v9, 4, v6
s_mul_i32 s40, s32, 6144
s_add_u32 s40, s40, 100352
v_add_u32 v7, s40, v1
s_mul_i32 s40, s42, 3072
s_add_u32 s40, s40, 100352
v_add_u32 v118, s40, v1
s_lshl_b32 s76, s32, 13
s_add_u32 s76, s76, 67584
v_and_b32 v9, 15, v0
v_lshlrev_b32 v8, 2, v8
v_sub_u32 v8, v9, v8
v_cmp_le_i32 s[20:21], 0, v8
v_cmp_le_i32 s[22:23], 1, v8
v_cmp_le_i32 s[24:25], 2, v8
v_cmp_le_i32 s[26:27], 3, v8
v_and_b32 v87, 0xf0, v1
v_bfe_u32 v9, v1, 8, 1
v_lshl_add_u32 v87, v9, 3, v87
s_mov_b32 s16, 2146435072
s_mov_b32 s17, 2146435072
s_cmp_eq_u32 s32, 0
s_cselect_b64 s[2:3], 0, s[20:21]
s_cselect_b64 s[20:21], s[20:21], -1
s_cselect_b64 s[4:5], 0, s[22:23]
s_cselect_b64 s[22:23], s[22:23], -1
s_cselect_b64 s[6:7], 0, s[24:25]
s_cselect_b64 s[24:25], s[24:25], -1
s_cselect_b64 s[30:31], 0, s[26:27]
s_cselect_b64 s[26:27], s[26:27], -1
s_mul_i32 s62, s38, 3670016
s_mul_i32 s40, s77, 28672
s_add_u32 s62, s62, s40
s_add_u32 s62, s62, 12845056
s_mul_i32 s63, s38, 524288
s_lshl_b32 s40, s77, 12
s_add_u32 s63, s63, s40
s_add_u32 s63, s63, 118603776
s_add_u32 s73, s38, 1
s_cmp_lt_u32 s77, 64
s_cselect_b32 s73, s73, 0
s_lshl_b32 s45, s59, 3
v_min_u32 v12, 7, v0
v_lshlrev_b32 v12, 7, v12
s_lshl_b32 s46, s45, 7
s_add_u32 s46, s46, 118571008
s_add_u32 s47, s46, 0
buffer_load_dword v8, v12, s[8:11], s47 offen sc1
s_branch Lwg_77
Lwf_76:
s_sleep 2
s_add_u32 s47, s46, 0
buffer_load_dword v8, v12, s[8:11], s47 offen sc1
s_sub_u32 s36, s36, 1
s_cbranch_scc1 L_timeout_14
Lwg_77:
s_waitcnt vmcnt(0)
v_cmp_ne_u32 vcc, 1, v8
s_nop 0
s_cbranch_vccnz Lwf_76
v_mov_b32 v72, 0x3f803f80
v_mov_b32 v73, 0x3f803f80
v_mov_b32 v74, 0x3f803f80
v_mov_b32 v75, 0x3f803f80
s_add_u32 s40, s60, 0
buffer_load_dwordx4 a[0:3], v1, s[8:11], s40 offen offset:0 sc1
buffer_load_dwordx4 a[4:7], v1, s[8:11], s40 offen offset:1024 sc1
buffer_load_dwordx4 a[8:11], v1, s[8:11], s40 offen offset:2048 sc1
buffer_load_dwordx4 a[12:15], v1, s[8:11], s40 offen offset:3072 sc1
s_add_u32 s40, s60, 4096
buffer_load_dwordx4 a[16:19], v1, s[8:11], s40 offen offset:0 sc1
buffer_load_dwordx4 a[20:23], v1, s[8:11], s40 offen offset:1024 sc1
buffer_load_dwordx4 a[24:27], v1, s[8:11], s40 offen offset:2048 sc1
buffer_load_dwordx4 a[28:31], v1, s[8:11], s40 offen offset:3072 sc1
s_add_u32 s40, s60, 8192
buffer_load_dwordx4 a[32:35], v1, s[8:11], s40 offen offset:0 sc1
buffer_load_dwordx4 a[36:39], v1, s[8:11], s40 offen offset:1024 sc1
buffer_load_dwordx4 a[40:43], v1, s[8:11], s40 offen offset:2048 sc1
buffer_load_dwordx4 a[44:47], v1, s[8:11], s40 offen offset:3072 sc1
s_add_u32 s40, s60, 12288
buffer_load_dwordx4 a[48:51], v1, s[8:11], s40 offen offset:0 sc1
buffer_load_dwordx4 a[52:55], v1, s[8:11], s40 offen offset:1024 sc1
s_add_u32 s40, s60, 14336
buffer_load_dwordx4 a[56:59], v1, s[8:11], s40 offen offset:0 sc1
buffer_load_dwordx4 a[60:63], v1, s[8:11], s40 offen offset:1024 sc1
buffer_load_dwordx4 a[64:67], v1, s[8:11], s40 offen offset:2048 sc1
buffer_load_dwordx4 a[68:71], v1, s[8:11], s40 offen offset:3072 sc1
s_add_u32 s40, s60, 18432
buffer_load_dwordx4 a[72:75], v1, s[8:11], s40 offen offset:0 sc1
buffer_load_dwordx4 a[76:79], v1, s[8:11], s40 offen offset:1024 sc1
buffer_load_dwordx4 a[80:83], v1, s[8:11], s40 offen offset:2048 sc1
buffer_load_dwordx4 a[84:87], v1, s[8:11], s40 offen offset:3072 sc1
s_add_u32 s40, s60, 22528
buffer_load_dwordx4 a[88:91], v1, s[8:11], s40 offen offset:0 sc1
buffer_load_dwordx4 a[92:95], v1, s[8:11], s40 offen offset:1024 sc1
buffer_load_dwordx4 a[96:99], v1, s[8:11], s40 offen offset:2048 sc1
buffer_load_dwordx4 a[100:103], v1, s[8:11], s40 offen offset:3072 sc1
s_add_u32 s40, s60, 26624
buffer_load_dwordx4 a[104:107], v1, s[8:11], s40 offen offset:0 sc1
buffer_load_dwordx4 a[108:111], v1, s[8:11], s40 offen offset:1024 sc1
s_add_u32 s40, s60, 28672
buffer_load_dwordx4 a[112:115], v1, s[8:11], s40 offen offset:0 sc1
buffer_load_dwordx4 a[116:119], v1, s[8:11], s40 offen offset:1024 sc1
buffer_load_dwordx4 a[120:123], v1, s[8:11], s40 offen offset:2048 sc1
buffer_load_dwordx4 a[124:127], v1, s[8:11], s40 offen offset:3072 sc1
s_add_u32 s40, s60, 32768
buffer_load_dwordx4 a[128:131], v1, s[8:11], s40 offen offset:0 sc1
buffer_load_dwordx4 a[132:135], v1, s[8:11], s40 offen offset:1024 sc1
buffer_load_dwordx4 a[136:139], v1, s[8:11], s40 offen offset:2048 sc1
buffer_load_dwordx4 a[140:143], v1, s[8:11], s40 offen offset:3072 sc1
s_add_u32 s40, s60, 36864
buffer_load_dwordx4 a[144:147], v1, s[8:11], s40 offen offset:0 sc1
buffer_load_dwordx4 a[148:151], v1, s[8:11], s40 offen offset:1024 sc1
buffer_load_dwordx4 a[152:155], v1, s[8:11], s40 offen offset:2048 sc1
buffer_load_dwordx4 a[156:159], v1, s[8:11], s40 offen offset:3072 sc1
s_add_u32 s40, s60, 40960
buffer_load_dwordx4 a[160:163], v1, s[8:11], s40 offen offset:0 sc1
buffer_load_dwordx4 a[164:167], v1, s[8:11], s40 offen offset:1024 sc1
s_add_u32 s40, s60, 43008
buffer_load_dwordx4 a[168:171], v1, s[8:11], s40 offen offset:0 sc1
buffer_load_dwordx4 a[172:175], v1, s[8:11], s40 offen offset:1024 sc1
buffer_load_dwordx4 a[176:179], v1, s[8:11], s40 offen offset:2048 sc1
buffer_load_dwordx4 a[180:183], v1, s[8:11], s40 offen offset:3072 sc1
s_add_u32 s40, s60, 47104
buffer_load_dwordx4 a[184:187], v1, s[8:11], s40 offen offset:0 sc1
buffer_load_dwordx4 a[188:191], v1, s[8:11], s40 offen offset:1024 sc1
buffer_load_dwordx4 a[192:195], v1, s[8:11], s40 offen offset:2048 sc1
buffer_load_dwordx4 a[196:199], v1, s[8:11], s40 offen offset:3072 sc1
s_add_u32 s40, s60, 51200
buffer_load_dwordx4 a[200:203], v1, s[8:11], s40 offen offset:0 sc1
buffer_load_dwordx4 a[204:207], v1, s[8:11], s40 offen offset:1024 sc1
buffer_load_dwordx4 a[208:211], v1, s[8:11], s40 offen offset:2048 sc1
buffer_load_dwordx4 a[212:215], v1, s[8:11], s40 offen offset:3072 sc1
s_add_u32 s40, s60, 55296
buffer_load_dwordx4 a[216:219], v1, s[8:11], s40 offen offset:0 sc1
buffer_load_dwordx4 a[220:223], v1, s[8:11], s40 offen offset:1024 sc1
s_waitcnt vmcnt(42)
v_mfma_f32_16x16x32_bf16 v[16:19], a[0:3], v[72:75], 0
v_mfma_f32_16x16x32_bf16 v[16:19], a[4:7], v[72:75], v[16:19]
v_mfma_f32_16x16x32_bf16 v[16:19], a[8:11], v[72:75], v[16:19]
v_mfma_f32_16x16x32_bf16 v[16:19], a[12:15], v[72:75], v[16:19]
v_mfma_f32_16x16x32_bf16 v[16:19], a[16:19], v[72:75], v[16:19]
v_mfma_f32_16x16x32_bf16 v[16:19], a[20:23], v[72:75], v[16:19]
v_mfma_f32_16x16x32_bf16 v[16:19], a[24:27], v[72:75], v[16:19]
v_mfma_f32_16x16x32_bf16 v[16:19], a[28:31], v[72:75], v[16:19]
v_mfma_f32_16x16x32_bf16 v[16:19], a[32:35], v[72:75], v[16:19]
v_mfma_f32_16x16x32_bf16 v[16:19], a[36:39], v[72:75], v[16:19]
v_mfma_f32_16x16x32_bf16 v[16:19], a[40:43], v[72:75], v[16:19]
v_mfma_f32_16x16x32_bf16 v[16:19], a[44:47], v[72:75], v[16:19]
v_mfma_f32_16x16x32_bf16 v[16:19], a[48:51], v[72:75], v[16:19]
v_mfma_f32_16x16x32_bf16 v[16:19], a[52:55], v[72:75], v[16:19]
s_add_u32 s40, s60, 57344
buffer_load_dwordx4 a[224:227], v1, s[8:11], s40 offen offset:0 sc1
buffer_load_dwordx4 a[228:231], v1, s[8:11], s40 offen offset:1024 sc1
buffer_load_dwordx4 a[232:235], v1, s[8:11], s40 offen offset:2048 sc1
buffer_load_dwordx4 a[236:239], v1, s[8:11], s40 offen offset:3072 sc1
s_add_u32 s40, s60, 61440
buffer_load_dwordx4 a[240:243], v1, s[8:11], s40 offen offset:0 sc1
buffer_load_dwordx4 a[244:247], v1, s[8:11], s40 offen offset:1024 sc1
buffer_load_dwordx4 a[248:251], v1, s[8:11], s40 offen offset:2048 sc1
buffer_load_dwordx4 a[252:255], v1, s[8:11], s40 offen offset:3072 sc1
s_add_u32 s40, s60, 65536
buffer_load_dwordx4 v[120:123], v1, s[8:11], s40 offen offset:0 sc1
buffer_load_dwordx4 v[124:127], v1, s[8:11], s40 offen offset:1024 sc1
buffer_load_dwordx4 v[128:131], v1, s[8:11], s40 offen offset:2048 sc1
buffer_load_dwordx4 v[132:135], v1, s[8:11], s40 offen offset:3072 sc1
s_add_u32 s40, s60, 69632
buffer_load_dwordx4 v[136:139], v1, s[8:11], s40 offen offset:0 sc1
buffer_load_dwordx4 v[140:143], v1, s[8:11], s40 offen offset:1024 sc1
s_waitcnt vmcnt(42)
v_mfma_f32_16x16x32_bf16 v[20:23], a[56:59], v[72:75], 0
v_mfma_f32_16x16x32_bf16 v[20:23], a[60:63], v[72:75], v[20:23]
v_mfma_f32_16x16x32_bf16 v[20:23], a[64:67], v[72:75], v[20:23]
v_mfma_f32_16x16x32_bf16 v[20:23], a[68:71], v[72:75], v[20:23]
v_mfma_f32_16x16x32_bf16 v[20:23], a[72:75], v[72:75], v[20:23]
v_mfma_f32_16x16x32_bf16 v[20:23], a[76:79], v[72:75], v[20:23]
v_mfma_f32_16x16x32_bf16 v[20:23], a[80:83], v[72:75], v[20:23]
v_mfma_f32_16x16x32_bf16 v[20:23], a[84:87], v[72:75], v[20:23]
v_mfma_f32_16x16x32_bf16 v[20:23], a[88:91], v[72:75], v[20:23]
v_mfma_f32_16x16x32_bf16 v[20:23], a[92:95], v[72:75], v[20:23]
v_mfma_f32_16x16x32_bf16 v[20:23], a[96:99], v[72:75], v[20:23]
v_mfma_f32_16x16x32_bf16 v[20:23], a[100:103], v[72:75], v[20:23]
v_mfma_f32_16x16x32_bf16 v[20:23], a[104:107], v[72:75], v[20:23]
v_mfma_f32_16x16x32_bf16 v[20:23], a[108:111], v[72:75], v[20:23]
s_add_u32 s40, s60, 71680
buffer_load_dwordx4 v[144:147], v1, s[8:11], s40 offen offset:0 sc1
buffer_load_dwordx4 v[148:151], v1, s[8:11], s40 offen offset:1024 sc1
buffer_load_dwordx4 v[152:155], v1, s[8:11], s40 offen offset:2048 sc1
buffer_load_dwordx4 v[156:159], v1, s[8:11], s40 offen offset:3072 sc1
s_add_u32 s40, s60, 75776
buffer_load_dwordx4 v[160:163], v1, s[8:11], s40 offen offset:0 sc1
buffer_load_dwordx4 v[164:167], v1, s[8:11], s40 offen offset:1024 sc1
buffer_load_dwordx4 v[168:171], v1, s[8:11], s40 offen offset:2048 sc1
buffer_load_dwordx4 v[172:175], v1, s[8:11], s40 offen offset:3072 sc1
s_add_u32 s40, s60, 79872
buffer_load_dwordx4 v[176:179], v1, s[8:11], s40 offen offset:0 sc1
buffer_load_dwordx4 v[180:183], v1, s[8:11], s40 offen offset:1024 sc1
buffer_load_dwordx4 v[184:187], v1, s[8:11], s40 offen offset:2048 sc1
buffer_load_dwordx4 v[188:191], v1, s[8:11], s40 offen offset:3072 sc1
s_add_u32 s40, s60, 83968
buffer_load_dwordx4 v[192:195], v1, s[8:11], s40 offen offset:0 sc1
buffer_load_dwordx4 v[196:199], v1, s[8:11], s40 offen offset:1024 sc1
s_waitcnt vmcnt(42)
v_mfma_f32_16x16x32_bf16 v[24:27], a[112:115], v[72:75], 0
v_mfma_f32_16x16x32_bf16 v[24:27], a[116:119], v[72:75], v[24:27]
v_mfma_f32_16x16x32_bf16 v[24:27], a[120:123], v[72:75], v[24:27]
v_mfma_f32_16x16x32_bf16 v[24:27], a[124:127], v[72:75], v[24:27]
v_mfma_f32_16x16x32_bf16 v[24:27], a[128:131], v[72:75], v[24:27]
v_mfma_f32_16x16x32_bf16 v[24:27], a[132:135], v[72:75], v[24:27]
v_mfma_f32_16x16x32_bf16 v[24:27], a[136:139], v[72:75], v[24:27]
v_mfma_f32_16x16x32_bf16 v[24:27], a[140:143], v[72:75], v[24:27]
v_mfma_f32_16x16x32_bf16 v[24:27], a[144:147], v[72:75], v[24:27]
v_mfma_f32_16x16x32_bf16 v[24:27], a[148:151], v[72:75], v[24:27]
v_mfma_f32_16x16x32_bf16 v[24:27], a[152:155], v[72:75], v[24:27]
v_mfma_f32_16x16x32_bf16 v[24:27], a[156:159], v[72:75], v[24:27]
v_mfma_f32_16x16x32_bf16 v[24:27], a[160:163], v[72:75], v[24:27]
v_mfma_f32_16x16x32_bf16 v[24:27], a[164:167], v[72:75], v[24:27]
s_add_u32 s40, s61, 0
buffer_load_dwordx4 v[200:203], v1, s[8:11], s40 offen offset:0 sc1
buffer_load_dwordx4 v[204:207], v1, s[8:11], s40 offen offset:1024 sc1
buffer_load_dwordx4 v[208:211], v1, s[8:11], s40 offen offset:2048 sc1
buffer_load_dwordx4 v[212:215], v1, s[8:11], s40 offen offset:3072 sc1
s_add_u32 s40, s61, 4096
buffer_load_dwordx4 v[216:219], v1, s[8:11], s40 offen offset:0 sc1
buffer_load_dwordx4 v[220:223], v1, s[8:11], s40 offen offset:1024 sc1
buffer_load_dwordx4 v[224:227], v1, s[8:11], s40 offen offset:2048 sc1
buffer_load_dwordx4 v[228:231], v1, s[8:11], s40 offen offset:3072 sc1
s_add_u32 s40, s61, 8192
buffer_load_dwordx4 v[232:235], v1, s[8:11], s40 offen offset:0 sc1
buffer_load_dwordx4 v[236:239], v1, s[8:11], s40 offen offset:1024 sc1
buffer_load_dwordx4 v[240:243], v1, s[8:11], s40 offen offset:2048 sc1
buffer_load_dwordx4 v[244:247], v1, s[8:11], s40 offen offset:3072 sc1
s_add_u32 s40, s61, 12288
buffer_load_dwordx4 v[248:251], v1, s[8:11], s40 offen offset:0 sc1
buffer_load_dwordx4 v[252:255], v1, s[8:11], s40 offen offset:1024 sc1
s_waitcnt vmcnt(42)
v_mfma_f32_16x16x32_bf16 v[28:31], a[168:171], v[72:75], 0
v_mfma_f32_16x16x32_bf16 v[28:31], a[172:175], v[72:75], v[28:31]
v_mfma_f32_16x16x32_bf16 v[28:31], a[176:179], v[72:75], v[28:31]
v_mfma_f32_16x16x32_bf16 v[28:31], a[180:183], v[72:75], v[28:31]
v_mfma_f32_16x16x32_bf16 v[28:31], a[184:187], v[72:75], v[28:31]
v_mfma_f32_16x16x32_bf16 v[28:31], a[188:191], v[72:75], v[28:31]
v_mfma_f32_16x16x32_bf16 v[28:31], a[192:195], v[72:75], v[28:31]
v_mfma_f32_16x16x32_bf16 v[28:31], a[196:199], v[72:75], v[28:31]
v_mfma_f32_16x16x32_bf16 v[28:31], a[200:203], v[72:75], v[28:31]
v_mfma_f32_16x16x32_bf16 v[28:31], a[204:207], v[72:75], v[28:31]
v_mfma_f32_16x16x32_bf16 v[28:31], a[208:211], v[72:75], v[28:31]
v_mfma_f32_16x16x32_bf16 v[28:31], a[212:215], v[72:75], v[28:31]
v_mfma_f32_16x16x32_bf16 v[28:31], a[216:219], v[72:75], v[28:31]
v_mfma_f32_16x16x32_bf16 v[28:31], a[220:223], v[72:75], v[28:31]
v_min_u32 v12, 63, v0
v_lshlrev_b32 v12, 7, v12
s_mov_b32 s46, 118571008
s_add_u32 s47, s46, 0
buffer_load_dword v8, v12, s[8:11], s47 offen sc1
s_add_u32 s47, s46, 8192
buffer_load_dword v9, v12, s[8:11], s47 offen sc1
s_add_u32 s47, s46, 16384
buffer_load_dword v10, v12, s[8:11], s47 offen sc1
s_add_u32 s47, s46, 24576
buffer_load_dword v11, v12, s[8:11], s47 offen sc1
s_waitcnt vmcnt(32)
v_mfma_f32_16x16x32_bf16 v[32:35], a[224:227], v[72:75], 0
v_mfma_f32_16x16x32_bf16 v[32:35], a[228:231], v[72:75], v[32:35]
v_mfma_f32_16x16x32_bf16 v[32:35], a[232:235], v[72:75], v[32:35]
v_mfma_f32_16x16x32_bf16 v[32:35], a[236:239], v[72:75], v[32:35]
v_mfma_f32_16x16x32_bf16 v[32:35], a[240:243], v[72:75], v[32:35]
v_mfma_f32_16x16x32_bf16 v[32:35], a[244:247], v[72:75], v[32:35]
v_mfma_f32_16x16x32_bf16 v[32:35], a[248:251], v[72:75], v[32:35]
v_mfma_f32_16x16x32_bf16 v[32:35], a[252:255], v[72:75], v[32:35]
v_mfma_f32_16x16x32_bf16 v[32:35], v[120:123], v[72:75], v[32:35]
v_mfma_f32_16x16x32_bf16 v[32:35], v[124:127], v[72:75], v[32:35]
v_mfma_f32_16x16x32_bf16 v[32:35], v[128:131], v[72:75], v[32:35]
v_mfma_f32_16x16x32_bf16 v[32:35], v[132:135], v[72:75], v[32:35]
v_mfma_f32_16x16x32_bf16 v[32:35], v[136:139], v[72:75], v[32:35]
v_mfma_f32_16x16x32_bf16 v[32:35], v[140:143], v[72:75], v[32:35]
s_waitcnt vmcnt(18)
v_mfma_f32_16x16x32_bf16 v[36:39], v[144:147], v[72:75], 0
v_mfma_f32_16x16x32_bf16 v[36:39], v[148:151], v[72:75], v[36:39]
v_mfma_f32_16x16x32_bf16 v[36:39], v[152:155], v[72:75], v[36:39]
v_mfma_f32_16x16x32_bf16 v[36:39], v[156:159], v[72:75], v[36:39]
v_mfma_f32_16x16x32_bf16 v[36:39], v[160:163], v[72:75], v[36:39]
v_mfma_f32_16x16x32_bf16 v[36:39], v[164:167], v[72:75], v[36:39]
v_mfma_f32_16x16x32_bf16 v[36:39], v[168:171], v[72:75], v[36:39]
v_mfma_f32_16x16x32_bf16 v[36:39], v[172:175], v[72:75], v[36:39]
v_mfma_f32_16x16x32_bf16 v[36:39], v[176:179], v[72:75], v[36:39]
v_mfma_f32_16x16x32_bf16 v[36:39], v[180:183], v[72:75], v[36:39]
v_mfma_f32_16x16x32_bf16 v[36:39], v[184:187], v[72:75], v[36:39]
v_mfma_f32_16x16x32_bf16 v[36:39], v[188:191], v[72:75], v[36:39]
v_mfma_f32_16x16x32_bf16 v[36:39], v[192:195], v[72:75], v[36:39]
v_mfma_f32_16x16x32_bf16 v[36:39], v[196:199], v[72:75], v[36:39]
s_waitcnt vmcnt(4)
v_mfma_f32_16x16x32_bf16 v[40:43], v[200:203], v[72:75], 0
v_mfma_f32_16x16x32_bf16 v[40:43], v[204:207], v[72:75], v[40:43]
v_mfma_f32_16x16x32_bf16 v[40:43], v[208:211], v[72:75], v[40:43]
v_mfma_f32_16x16x32_bf16 v[40:43], v[212:215], v[72:75], v[40:43]
v_mfma_f32_16x16x32_bf16 v[40:43], v[216:219], v[72:75], v[40:43]
v_mfma_f32_16x16x32_bf16 v[40:43], v[220:223], v[72:75], v[40:43]
v_mfma_f32_16x16x32_bf16 v[40:43], v[224:227], v[72:75], v[40:43]
v_mfma_f32_16x16x32_bf16 v[40:43], v[228:231], v[72:75], v[40:43]
v_mfma_f32_16x16x32_bf16 v[40:43], v[232:235], v[72:75], v[40:43]
v_mfma_f32_16x16x32_bf16 v[40:43], v[236:239], v[72:75], v[40:43]
v_mfma_f32_16x16x32_bf16 v[40:43], v[240:243], v[72:75], v[40:43]
v_mfma_f32_16x16x32_bf16 v[40:43], v[244:247], v[72:75], v[40:43]
v_mfma_f32_16x16x32_bf16 v[40:43], v[248:251], v[72:75], v[40:43]
v_mfma_f32_16x16x32_bf16 v[40:43], v[252:255], v[72:75], v[40:43]
s_branch Lwg_81
Lwf_80:
s_sleep 12
s_add_u32 s47, s46, 0
buffer_load_dword v8, v12, s[8:11], s47 offen sc1
s_add_u32 s47, s46, 8192
buffer_load_dword v9, v12, s[8:11], s47 offen sc1
s_add_u32 s47, s46, 16384
buffer_load_dword v10, v12, s[8:11], s47 offen sc1
s_add_u32 s47, s46, 24576
buffer_load_dword v11, v12, s[8:11], s47 offen sc1
s_sub_u32 s36, s36, 1
s_cbranch_scc1 L_timeout_14
Lwg_81:
s_waitcnt vmcnt(0)
v_and_b32 v8, v8, v9
v_and_b32 v8, v8, v10
v_and_b32 v8, v8, v11
v_cmp_ne_u32 vcc, 1, v8
s_nop 0
s_cbranch_vccnz Lwf_80
ds_write_b128 v5, v[16:19] offset:0
ds_write_b128 v5, v[20:23] offset:64
ds_write_b128 v5, v[24:27] offset:128
ds_write_b128 v5, v[28:31] offset:192
ds_write_b128 v5, v[32:35] offset:256
ds_write_b128 v5, v[36:39] offset:320
ds_write_b128 v5, v[40:43] offset:384
s_waitcnt lgkmcnt(0)
s_cmp_eq_u32 s38, 0
s_cbranch_scc1 Lta_82
v_min_u32 v8, 13, v0
v_lshlrev_b32 v8, 7, v8
s_lshl_b32 s40, s72, 13
s_add_u32 s40, s40, 118554624
Lwa_83:
buffer_load_dword v9, v8, s[8:11], s40 offen sc1
s_sub_u32 s36, s36, 1
s_cbranch_scc1 L_timeout_17
s_sleep 8
s_waitcnt vmcnt(0)
v_cmp_ne_u32 vcc, 1, v9
s_nop 0
s_cbranch_vccnz Lwa_83
Lta_82:
v_mov_b32 v0, 126464
v_mov_b32 v8, 0
v_mov_b32 v9, 0
v_mov_b32 v10, 0
v_mov_b32 v11, 0
ds_write_b128 v0, v[8:11]
ds_write_b128 v0, v[8:11] offset:16
s_mov_b32 s96, 126464
s_mov_b32 s94, 1
s_mov_b32 s93, 1
v_mov_b32 v15, 1
s_waitcnt lgkmcnt(0)
s_barrier
s_mov_b32 s19, 0
v_lshrrev_b32 v8, 8, v1
v_mul_u32_u24 v4, 896, v8
v_bfe_u32 v8, v1, 4, 4
v_lshl_add_u32 v4, v8, 3, v4
v_add_u32 v4, 28672, v4
LT_loop:
s_xor_b32 s44, s95, 32768
s_mul_i32 s45, s32, 7168
s_add_u32 s45, s45, s44
v_add_u32 v8, s45, v1
s_lshl_b32 s45, s32, 10
v_add_u32 v9, s45, v1
v_min_u32 v9, 3568, v9
v_add_u32 v9, s44, v9
s_cmp_eq_u32 s97, 0
s_cbranch_scc1 Lxb_85
s_waitcnt vmcnt(2)
Lxt_84:
s_cmp_eq_u32 s73, 1
s_cbranch_scc1 Lxv_87
ds_read_b128 v[16:19], v8 offset:0
ds_read_b128 v[20:23], v8 offset:1024
ds_read_b128 v[24:27], v8 offset:2048
ds_read_b128 v[28:31], v8 offset:3072
ds_read_b128 v[32:35], v8 offset:4096
ds_read_b128 v[36:39], v8 offset:5120
ds_read_b128 v[40:43], v8 offset:6144
ds_read_b128 v[44:47], v9 offset:28672
s_waitcnt lgkmcnt(6)
v_max3_u32 v10, v16, v17, v18
v_max3_u32 v11, v19, v20, v21
v_max3_u32 v10, v10, v22, v23
s_waitcnt lgkmcnt(4)
v_max3_u32 v10, v10, v24, v25
v_max3_u32 v11, v11, v26, v27
v_max3_u32 v10, v10, v28, v29
v_max3_u32 v11, v11, v30, v31
s_waitcnt lgkmcnt(2)
v_max3_u32 v10, v10, v32, v33
v_max3_u32 v11, v11, v34, v35
v_max3_u32 v10, v10, v36, v37
v_max3_u32 v11, v11, v38, v39
s_waitcnt lgkmcnt(0)
v_max3_u32 v10, v10, v40, v41
v_max3_u32 v11, v11, v42, v43
v_max3_u32 v10, v10, v44, v45
v_max3_u32 v11, v11, v46, v47
v_max_u32 v10, v10, v11
v_cmp_eq_u32 vcc, -1, v10
s_nop 0
s_cbranch_vccnz Lxe_88
Lxv_87:
s_xor_b32 s95, s95, 32768
v_add_u32 v3, s95, v1
v_xor_b32 v4, 32768, v4
s_barrier
ds_read_b128 v[72:75], v3 offset:0
ds_read_b128 v[76:79], v3 offset:1024
ds_read_b128 v[52:55], v118 offset:0
ds_read_b128 v[60:63], v118 offset:1024
ds_read_b128 v[68:71], v118 offset:2048
ds_read_b128 v[28:31], v118 offset:6144
ds_read_b128 v[36:39], v118 offset:7168
ds_read_b128 v[44:47], v118 offset:8192
s_waitcnt lgkmcnt(7)
v_mfma_f32_16x16x32_bf16 v[16:19], a[0:3], v[72:75], 0
ds_read_b128 v[80:83], v3 offset:2048
v_mfma_f32_16x16x32_bf16 v[24:27], a[56:59], v[72:75], 0
s_add_u32 s94, s94, 1
v_mov_b32 v8, 0xf149f2ca
v_mfma_f32_16x16x32_bf16 v[32:35], a[112:115], v[72:75], 0
s_cmp_lg_u32 s98, 0
s_cselect_b32 s53, s96, 126484
s_cselect_b32 s99, s99, 2146435072
v_mfma_f32_16x16x32_bf16 v[40:43], a[168:171], v[72:75], 0
s_mov_b32 s98, 0
s_mov_b32 s37, s77
s_add_u32 s77, s77, 2
v_mfma_f32_16x16x32_bf16 v[48:51], a[224:227], v[72:75], 0
s_xor_b32 s49, s95, 32768
s_mul_i32 s50, s32, 7168
s_add_u32 s48, s49, s50
v_mfma_f32_16x16x32_bf16 v[56:59], v[144:147], v[72:75], 0
s_lshl_b32 s51, s32, 10
s_add_u32 s49, s49, s51
s_add_u32 s49, s49, 28672
v_mfma_f32_16x16x32_bf16 v[64:67], v[200:203], v[72:75], 0
s_waitcnt lgkmcnt(3)
v_add_f32 v52, v52, v28
v_add_f32 v53, v53, v29
v_add_f32 v54, v54, v30
s_waitcnt lgkmcnt(7)
v_mfma_f32_16x16x32_bf16 v[16:19], a[4:7], v[76:79], v[16:19]
ds_read_b128 v[72:75], v3 offset:3072
v_mfma_f32_16x16x32_bf16 v[24:27], a[60:63], v[76:79], v[24:27]
s_mul_i32 s46, s37, 28672
v_add_f32 v55, v55, v31
v_mfma_f32_16x16x32_bf16 v[32:35], a[116:119], v[76:79], v[32:35]
ds_read_b128 v[28:31], v118 offset:12288
s_waitcnt lgkmcnt(4)
v_add_f32 v60, v60, v36
v_add_f32 v61, v61, v37
v_mfma_f32_16x16x32_bf16 v[40:43], a[172:175], v[76:79], v[40:43]
s_mul_i32 s47, s38, 1835008
v_add_f32 v62, v62, v38
v_add_f32 v63, v63, v39
v_mfma_f32_16x16x32_bf16 v[48:51], a[228:231], v[76:79], v[48:51]
ds_read_b128 v[36:39], v118 offset:13312
s_waitcnt lgkmcnt(4)
v_add_f32 v68, v68, v44
v_add_f32 v69, v69, v45
v_mfma_f32_16x16x32_bf16 v[56:59], v[148:151], v[76:79], v[56:59]
s_add_u32 s47, s47, s46
v_add_f32 v70, v70, v46
v_add_f32 v71, v71, v47
v_mfma_f32_16x16x32_bf16 v[64:67], v[204:207], v[76:79], v[64:67]
ds_read_b128 v[44:47], v118 offset:14336
s_waitcnt lgkmcnt(4)
v_mfma_f32_16x16x32_bf16 v[16:19], a[8:11], v[80:83], v[16:19]
ds_read_b128 v[76:79], v3 offset:4096
v_mfma_f32_16x16x32_bf16 v[24:27], a[64:67], v[80:83], v[24:27]
s_waitcnt lgkmcnt(3)
v_add_f32 v52, v52, v28
v_add_f32 v53, v53, v29
v_add_f32 v54, v54, v30
v_add_f32 v55, v55, v31
v_mfma_f32_16x16x32_bf16 v[32:35], a[120:123], v[80:83], v[32:35]
ds_read_b128 v[28:31], v118 offset:18432
s_waitcnt lgkmcnt(3)
v_add_f32 v60, v60, v36
v_add_f32 v61, v61, v37
v_mfma_f32_16x16x32_bf16 v[40:43], a[176:179], v[80:83], v[40:43]
s_add_u32 s47, s47, 20185088
v_add_f32 v62, v62, v38
v_add_f32 v63, v63, v39
v_mfma_f32_16x16x32_bf16 v[48:51], a[232:235], v[80:83], v[48:51]
ds_read_b128 v[36:39], v118 offset:19456
s_waitcnt lgkmcnt(3)
v_add_f32 v68, v68, v44
v_add_f32 v69, v69, v45
v_mfma_f32_16x16x32_bf16 v[56:59], v[152:155], v[80:83], v[56:59]
s_lshl_b32 s66, s64, 10
v_add_f32 v70, v70, v46
v_add_f32 v71, v71, v47
v_mfma_f32_16x16x32_bf16 v[64:67], v[208:211], v[80:83], v[64:67]
ds_read_b128 v[44:47], v118 offset:20480
s_waitcnt lgkmcnt(7)
v_mfma_f32_16x16x32_bf16 v[16:19], a[12:15], v[72:75], v[16:19]
ds_read_b128 v[80:83], v3 offset:5120
v_mfma_f32_16x16x32_bf16 v[24:27], a[68:71], v[72:75], v[24:27]
s_waitcnt lgkmcnt(3)
v_add_f32 v52, v52, v28
v_add_f32 v53, v53, v29
v_add_f32 v54, v54, v30
v_add_f32 v55, v55, v31
v_mfma_f32_16x16x32_bf16 v[32:35], a[124:127], v[72:75], v[32:35]
s_waitcnt lgkmcnt(2)
v_add_f32 v60, v60, v36
v_add_f32 v61, v61, v37
v_add_f32 v62, v62, v38
v_add_f32 v63, v63, v39
v_mfma_f32_16x16x32_bf16 v[40:43], a[180:183], v[72:75], v[40:43]
s_waitcnt lgkmcnt(1)
v_add_f32 v68, v68, v44
v_add_f32 v69, v69, v45
v_add_f32 v70, v70, v46
v_add_f32 v71, v71, v47
v_mfma_f32_16x16x32_bf16 v[48:51], a[236:239], v[72:75], v[48:51]
s_add_u32 s66, s66, s47
v_cndmask_b32 v52, v8, v52, s[20:21]
v_cndmask_b32 v60, v8, v60, s[2:3]
v_cndmask_b32 v53, v8, v53, s[22:23]
v_cndmask_b32 v61, v8, v61, s[4:5]
v_mfma_f32_16x16x32_bf16 v[56:59], v[156:159], v[72:75], v[56:59]
s_lshl_b32 s67, s65, 10
v_cndmask_b32 v54, v8, v54, s[24:25]
v_cndmask_b32 v62, v8, v62, s[6:7]
v_cndmask_b32 v55, v8, v55, s[26:27]
v_cndmask_b32 v63, v8, v63, s[30:31]
v_mfma_f32_16x16x32_bf16 v[64:67], v[212:215], v[72:75], v[64:67]
v_max3_f32 v9, v52, v53, v54
v_max3_f32 v10, v55, v60, v61
v_max3_f32 v9, v9, v62, v63
v_max3_f32 v10, v10, v68, v69
s_waitcnt lgkmcnt(4)
v_mfma_f32_16x16x32_bf16 v[16:19], a[16:19], v[76:79], v[16:19]
ds_read_b128 v[72:75], v3 offset:6144
v_mfma_f32_16x16x32_bf16 v[24:27], a[72:75], v[76:79], v[24:27]
s_add_u32 s67, s67, s47
v_max3_f32 v9, v9, v70, v71
v_max_f32 v9, v9, v10
v_mov_b32 v10, v9
v_mfma_f32_16x16x32_bf16 v[32:35], a[128:131], v[76:79], v[32:35]
s_mul_i32 s47, s38, 458752
v_permlane16_swap_b32 v9, v10
v_max_f32 v9, v9, v10
v_mov_b32 v10, v9
v_mfma_f32_16x16x32_bf16 v[40:43], a[184:187], v[76:79], v[40:43]
s_mul_i32 s46, s37, 7168
v_permlane32_swap_b32 v9, v10
v_max_f32 v9, v9, v10
v_mul_f32 v9, v9, v86
v_mfma_f32_16x16x32_bf16 v[48:51], a[240:243], v[76:79], v[48:51]
s_add_u32 s47, s47, s46
v_fma_f32 v52, v52, v86, -v9
v_fma_f32 v53, v53, v86, -v9
v_fma_f32 v54, v54, v86, -v9
v_fma_f32 v55, v55, v86, -v9
v_mfma_f32_16x16x32_bf16 v[56:59], v[160:163], v[76:79], v[56:59]
s_add_u32 s47, s47, 117506048
v_fma_f32 v60, v60, v86, -v9
v_fma_f32 v61, v61, v86, -v9
v_fma_f32 v62, v62, v86, -v9
v_fma_f32 v63, v63, v86, -v9
v_mfma_f32_16x16x32_bf16 v[64:67], v[216:219], v[76:79], v[64:67]
v_fma_f32 v68, v68, v86, -v9
v_fma_f32 v69, v69, v86, -v9
v_fma_f32 v70, v70, v86, -v9
v_fma_f32 v71, v71, v86, -v9
s_waitcnt lgkmcnt(1)
v_mfma_f32_16x16x32_bf16 v[16:19], a[20:23], v[80:83], v[16:19]
ds_read_b128 v[76:79], v3 offset:7168
v_mfma_f32_16x16x32_bf16 v[24:27], a[76:79], v[80:83], v[24:27]
s_lshl_b32 s68, s64, 9
v_exp_f32 v52, v52
v_exp_f32 v53, v53
v_mfma_f32_16x16x32_bf16 v[32:35], a[132:135], v[80:83], v[32:35]
s_add_u32 s68, s68, s47
v_exp_f32 v54, v54
v_exp_f32 v55, v55
v_mfma_f32_16x16x32_bf16 v[40:43], a[188:191], v[80:83], v[40:43]
s_lshl_b32 s69, s65, 9
v_exp_f32 v60, v60
v_exp_f32 v61, v61
v_mfma_f32_16x16x32_bf16 v[48:51], a[244:247], v[80:83], v[48:51]
s_add_u32 s69, s69, s47
v_exp_f32 v62, v62
v_exp_f32 v63, v63
v_mfma_f32_16x16x32_bf16 v[56:59], v[164:167], v[80:83], v[56:59]
s_add_u32 s69, s69, s78
v_exp_f32 v68, v68
v_exp_f32 v69, v69
v_mfma_f32_16x16x32_bf16 v[64:67], v[220:223], v[80:83], v[64:67]
v_exp_f32 v70, v70
v_exp_f32 v71, v71
s_waitcnt lgkmcnt(1)
v_mfma_f32_16x16x32_bf16 v[16:19], a[24:27], v[72:75], v[16:19]
ds_read_b128 v[80:83], v3 offset:8192
v_mfma_f32_16x16x32_bf16 v[24:27], a[80:83], v[72:75], v[24:27]
s_mul_i32 s47, s38, 2621440
v_add_f32 v28, v52, v53
v_add_f32 v29, v54, v55
v_add_f32 v30, v60, v61
v_add_f32 v31, v62, v63
v_mfma_f32_16x16x32_bf16 v[32:35], a[136:139], v[72:75], v[32:35]
s_mul_i32 s46, s37, 40960
v_add_f32 v36, v68, v69
v_add_f32 v37, v70, v71
v_add_f32 v28, v28, v29
v_add_f32 v30, v30, v31
v_mfma_f32_16x16x32_bf16 v[40:43], a[192:195], v[72:75], v[40:43]
s_add_u32 s47, s47, s46
v_add_f32 v36, v36, v37
v_add_f32 v9, v28, v30
v_fmac_f32 v9, 0.5, v36
v_mov_b32 v10, v9
v_mfma_f32_16x16x32_bf16 v[48:51], a[248:251], v[72:75], v[48:51]
s_mul_i32 s46, s32, 20480
v_permlane16_swap_b32 v9, v10
v_add_f32 v9, v9, v10
v_mov_b32 v10, v9
v_mfma_f32_16x16x32_bf16 v[56:59], v[168:171], v[72:75], v[56:59]
s_add_u32 s47, s47, s46
v_permlane32_swap_b32 v9, v10
v_add_f32 v9, v9, v10
v_mfma_f32_16x16x32_bf16 v[64:67], v[224:227], v[72:75], v[64:67]
v_rcp_f32 v9, v9
s_waitcnt lgkmcnt(1)
v_mfma_f32_16x16x32_bf16 v[16:19], a[28:31], v[76:79], v[16:19]
ds_read_b128 v[72:75], v3 offset:9216
v_mfma_f32_16x16x32_bf16 v[24:27], a[84:87], v[76:79], v[24:27]
s_add_u32 s47, s47, 97255424
v_mul_f32 v52, v52, v9
v_mul_f32 v53, v53, v9
v_cvt_pk_bf16_f32 v110, v52, v53
v_mul_f32 v54, v54, v9
v_mfma_f32_16x16x32_bf16 v[32:35], a[140:143], v[76:79], v[32:35]
s_lshl_b32 s70, s59, 10
v_mul_f32 v55, v55, v9
v_cvt_pk_bf16_f32 v111, v54, v55
v_mul_f32 v60, v60, v9
v_mul_f32 v61, v61, v9
v_mfma_f32_16x16x32_bf16 v[40:43], a[196:199], v[76:79], v[40:43]
s_add_u32 s70, s70, s47
v_cvt_pk_bf16_f32 v112, v60, v61
v_mul_f32 v62, v62, v9
v_mul_f32 v63, v63, v9
v_cvt_pk_bf16_f32 v113, v62, v63
v_mfma_f32_16x16x32_bf16 v[48:51], a[252:255], v[76:79], v[48:51]
s_lshl_b32 s46, s59, 8
v_mul_f32 v68, v68, v9
v_mul_f32 v69, v69, v9
v_cvt_pk_bf16_f32 v114, v68, v69
v_mul_f32 v70, v70, v9
v_mfma_f32_16x16x32_bf16 v[56:59], v[172:175], v[76:79], v[56:59]
s_add_u32 s71, s47, s46
v_mul_f32 v71, v71, v9
v_cvt_pk_bf16_f32 v115, v70, v71
v_mfma_f32_16x16x32_bf16 v[64:67], v[228:231], v[76:79], v[64:67]
buffer_store_dwordx4 v[110:113], v1, s[8:11], s16 offen sc1
s_waitcnt lgkmcnt(1)
v_mfma_f32_16x16x32_bf16 v[16:19], a[32:35], v[80:83], v[16:19]
ds_read_b128 v[76:79], v3 offset:10240
v_mfma_f32_16x16x32_bf16 v[24:27], a[88:91], v[80:83], v[24:27]
buffer_store_dwordx2 v[114:115], v87, s[8:11], s17 offen sc1
s_mov_b32 s16, 2146435072
s_mov_b32 s17, 2146435072
v_mfma_f32_16x16x32_bf16 v[32:35], a[144:147], v[80:83], v[32:35]
ds_read2_b64 v[88:91], v4 offset0:0 offset1:16
v_mfma_f32_16x16x32_bf16 v[40:43], a[200:203], v[80:83], v[40:43]
ds_read2_b64 v[92:95], v4 offset0:32 offset1:48
v_mfma_f32_16x16x32_bf16 v[48:51], v[120:123], v[80:83], v[48:51]
ds_read2_b64 v[96:99], v4 offset0:64 offset1:80
v_mfma_f32_16x16x32_bf16 v[56:59], v[176:179], v[80:83], v[56:59]
ds_read2_b64 v[100:103], v4 offset0:96 offset1:112
s_add_u32 s71, s71, 16384
v_mfma_f32_16x16x32_bf16 v[64:67], v[232:235], v[80:83], v[64:67]
s_mul_i32 s62, s38, 3670016
s_mul_i32 s40, s77, 28672
s_waitcnt lgkmcnt(5)
v_mfma_f32_16x16x32_bf16 v[16:19], a[36:39], v[72:75], v[16:19]
ds_read_b128 v[80:83], v3 offset:11264
v_mfma_f32_16x16x32_bf16 v[24:27], a[92:95], v[72:75], v[24:27]
s_add_u32 s62, s62, s40
s_add_u32 s62, s62, 12845056
s_mul_i32 s63, s38, 524288
v_mfma_f32_16x16x32_bf16 v[32:35], a[148:151], v[72:75], v[32:35]
s_waitcnt lgkmcnt(1)
v_add_f32 v88, v88, v90
v_add_f32 v92, v92, v94
v_mfma_f32_16x16x32_bf16 v[40:43], a[204:207], v[72:75], v[40:43]
s_lshl_b32 s40, s77, 12
v_add_f32 v96, v96, v98
v_add_f32 v89, v89, v91
v_mfma_f32_16x16x32_bf16 v[48:51], v[124:127], v[72:75], v[48:51]
s_add_u32 s63, s63, s40
v_add_f32 v93, v93, v95
v_add_f32 v97, v97, v99
v_mfma_f32_16x16x32_bf16 v[56:59], v[180:183], v[72:75], v[56:59]
s_add_u32 s63, s63, 118603776
v_add_f32 v88, v88, v92
v_add_f32 v96, v96, v100
v_mfma_f32_16x16x32_bf16 v[64:67], v[236:239], v[72:75], v[64:67]
v_add_f32 v89, v89, v93
v_add_f32 v97, v97, v101
s_waitcnt lgkmcnt(5)
v_mfma_f32_16x16x32_bf16 v[16:19], a[40:43], v[76:79], v[16:19]
ds_read_b128 v[72:75], v3 offset:12288
v_mfma_f32_16x16x32_bf16 v[24:27], a[96:99], v[76:79], v[24:27]
s_add_u32 s73, s38, 1
v_add_f32 v90, v88, v96
v_add_f32 v88, v88, v96
v_mfma_f32_16x16x32_bf16 v[32:35], a[152:155], v[76:79], v[32:35]
s_cmp_lt_u32 s77, 64
s_cselect_b32 s73, s73, 0
v_add_f32 v91, v89, v97
v_mfma_f32_16x16x32_bf16 v[40:43], a[208:211], v[76:79], v[40:43]
s_lshr_b32 s54, s37, 5
v_add_f32 v89, v89, v97
v_mfma_f32_16x16x32_bf16 v[48:51], v[128:131], v[76:79], v[48:51]
s_lshl_b32 s54, s54, 12
v_permlane16_swap_b32 v88, v90
v_mfma_f32_16x16x32_bf16 v[56:59], v[184:187], v[76:79], v[56:59]
s_and_b32 s55, s37, 31
v_permlane16_swap_b32 v89, v91
v_mfma_f32_16x16x32_bf16 v[64:67], v[240:243], v[76:79], v[64:67]
v_add_f32 v88, v88, v90
v_add_f32 v89, v89, v91
s_waitcnt lgkmcnt(1)
v_mfma_f32_16x16x32_bf16 v[16:19], a[44:47], v[80:83], v[16:19]
ds_read_b128 v[76:79], v3 offset:13312
v_mfma_f32_16x16x32_bf16 v[24:27], a[100:103], v[80:83], v[24:27]
s_lshl2_add_u32 s54, s55, s54
v_mul_f32 v88, 0x3b124925, v88
v_mul_f32 v89, 0x3b124925, v89
v_mfma_f32_16x16x32_bf16 v[32:35], a[156:159], v[80:83], v[32:35]
s_lshl_b32 s55, s38, 13
v_fma_f32 v89, -v88, v88, v89
v_max_f32 v89, 0, v89
v_mfma_f32_16x16x32_bf16 v[40:43], a[212:215], v[80:83], v[40:43]
s_add_u32 s54, s54, s55
v_cvt_pk_bf16_f32 v88, v89, v88
v_lshlrev_b32 v89, 16, v88
v_mfma_f32_16x16x32_bf16 v[48:51], v[132:135], v[80:83], v[48:51]
s_add_u32 s74, s54, 118439936
v_and_b32 v106, 0xffff0000, v88
v_add_f32 v89, 0x3727c5ac, v89
v_mfma_f32_16x16x32_bf16 v[56:59], v[188:191], v[80:83], v[56:59]
s_lshr_b32 s54, s37, 5
v_cvt_pk_bf16_f32 v89, v89, v89
v_lshlrev_b32 v89, 16, v89
v_mfma_f32_16x16x32_bf16 v[64:67], v[244:247], v[80:83], v[64:67]
v_sqrt_f32 v89, v89
s_waitcnt lgkmcnt(1)
v_mfma_f32_16x16x32_bf16 v[16:19], a[48:51], v[72:75], v[16:19]
ds_read_b128 v[80:83], v3 offset:14336
v_mfma_f32_16x16x32_bf16 v[24:27], a[104:107], v[72:75], v[24:27]
s_lshl_b32 s54, s54, 12
v_cvt_pk_bf16_f32 v89, v89, v89
v_lshlrev_b32 v89, 16, v89
v_mfma_f32_16x16x32_bf16 v[32:35], a[160:163], v[72:75], v[32:35]
s_and_b32 s55, s37, 31
v_rcp_f32 v104, v89
v_mfma_f32_16x16x32_bf16 v[40:43], a[216:219], v[72:75], v[40:43]
s_lshl2_add_u32 s54, s55, s54
v_mov_b32 v105, v104
v_mov_b32 v107, v106
v_mfma_f32_16x16x32_bf16 v[48:51], v[136:139], v[72:75], v[48:51]
s_lshl_b32 s55, s38, 13
v_permlane32_swap_b32 v104, v105
v_mfma_f32_16x16x32_bf16 v[56:59], v[192:195], v[72:75], v[56:59]
s_add_u32 s54, s54, s55
v_permlane32_swap_b32 v106, v107
v_mfma_f32_16x16x32_bf16 v[64:67], v[248:251], v[72:75], v[64:67]
s_add_u32 s79, s54, 118472704
s_lshl_b32 s41, s59, 7
s_waitcnt lgkmcnt(1)
v_mfma_f32_16x16x32_bf16 v[16:19], a[52:55], v[76:79], v[16:19]
ds_read_b128 v[72:75], v3 offset:15360
v_mfma_f32_16x16x32_bf16 v[24:27], a[108:111], v[76:79], v[24:27]
s_add_u32 s79, s79, s41
v_mov_b32 v12, s53
v_mfma_f32_16x16x32_bf16 v[32:35], a[164:167], v[76:79], v[32:35]
s_waitcnt vmcnt(0)
v_mfma_f32_16x16x32_bf16 v[40:43], a[220:223], v[76:79], v[40:43]
s_mov_b64 exec, 1
ds_add_rtn_u32 v12, v12, v15
s_mov_b64 exec, -1
v_mfma_f32_16x16x32_bf16 v[48:51], v[140:143], v[76:79], v[48:51]
v_mfma_f32_16x16x32_bf16 v[56:59], v[196:199], v[76:79], v[56:59]
v_mfma_f32_16x16x32_bf16 v[64:67], v[252:255], v[76:79], v[64:67]
s_waitcnt lgkmcnt(2)
v_mfma_f32_16x16x32_bf16 v[20:23], a[0:3], v[80:83], 0
ds_read_b128 v[76:79], v3 offset:16384
v_mfma_f32_16x16x32_bf16 v[28:31], a[56:59], v[80:83], 0
buffer_load_dword v13, v119, s[8:11], s74 offen sc1
v_mfma_f32_16x16x32_bf16 v[36:39], a[112:115], v[80:83], 0
s_waitcnt lgkmcnt(1)
v_readfirstlane_b32 s52, v12
v_mfma_f32_16x16x32_bf16 v[44:47], a[168:171], v[80:83], 0
s_and_b32 s52, s52, s93
s_cmp_eq_u32 s52, s93
s_cselect_b32 s52, s99, 2146435072
v_mfma_f32_16x16x32_bf16 v[52:55], a[224:227], v[80:83], 0
buffer_store_dword v15, off, s[8:11], s52 sc1
ds_read_b128 v[110:113], v5 offset:0
v_mfma_f32_16x16x32_bf16 v[60:63], v[144:147], v[80:83], 0
ds_read_b128 v[114:117], v5 offset:64
v_mfma_f32_16x16x32_bf16 v[68:71], v[200:203], v[80:83], 0
s_waitcnt lgkmcnt(4)
v_mfma_f32_16x16x32_bf16 v[20:23], a[4:7], v[72:75], v[20:23]
ds_read_b128 v[80:83], v3 offset:17408
v_mfma_f32_16x16x32_bf16 v[28:31], a[60:63], v[72:75], v[28:31]
v_mfma_f32_16x16x32_bf16 v[36:39], a[116:119], v[72:75], v[36:39]
v_mfma_f32_16x16x32_bf16 v[44:47], a[172:175], v[72:75], v[44:47]
s_waitcnt lgkmcnt(2)
v_fma_f32 v16, -v106, v110, v16
v_fma_f32 v17, -v106, v111, v17
v_mfma_f32_16x16x32_bf16 v[52:55], a[228:231], v[72:75], v[52:55]
v_fma_f32 v18, -v106, v112, v18
v_fma_f32 v19, -v106, v113, v19
v_mfma_f32_16x16x32_bf16 v[60:63], v[148:151], v[72:75], v[60:63]
v_cvt_pk_bf16_f32 v88, v16, v17
v_cvt_pk_bf16_f32 v89, v18, v19
v_mfma_f32_16x16x32_bf16 v[68:71], v[204:207], v[72:75], v[68:71]
ds_read_b128 v[110:113], v5 offset:128
s_waitcnt lgkmcnt(4)
v_mfma_f32_16x16x32_bf16 v[20:23], a[8:11], v[76:79], v[20:23]
ds_read_b128 v[72:75], v3 offset:18432
v_mfma_f32_16x16x32_bf16 v[28:31], a[64:67], v[76:79], v[28:31]
s_waitcnt lgkmcnt(3)
v_fma_f32 v24, -v106, v114, v24
v_fma_f32 v25, -v106, v115, v25
v_mfma_f32_16x16x32_bf16 v[36:39], a[120:123], v[76:79], v[36:39]
v_fma_f32 v26, -v106, v116, v26
v_fma_f32 v27, -v106, v117, v27
v_mfma_f32_16x16x32_bf16 v[44:47], a[176:179], v[76:79], v[44:47]
v_cvt_pk_bf16_f32 v90, v24, v25
v_cvt_pk_bf16_f32 v91, v26, v27
v_mfma_f32_16x16x32_bf16 v[52:55], a[232:235], v[76:79], v[52:55]
ds_read_b128 v[114:117], v5 offset:192
s_waitcnt lgkmcnt(2)
v_mfma_f32_16x16x32_bf16 v[60:63], v[152:155], v[76:79], v[60:63]
v_fma_f32 v32, -v106, v110, v32
v_fma_f32 v33, -v106, v111, v33
v_mfma_f32_16x16x32_bf16 v[68:71], v[208:211], v[76:79], v[68:71]
v_fma_f32 v34, -v106, v112, v34
v_fma_f32 v35, -v106, v113, v35
s_waitcnt lgkmcnt(3)
v_mfma_f32_16x16x32_bf16 v[20:23], a[12:15], v[80:83], v[20:23]
ds_read_b128 v[76:79], v3 offset:19456
v_mfma_f32_16x16x32_bf16 v[28:31], a[68:71], v[80:83], v[28:31]
buffer_load_dword v14, v2, s[8:11], s63 offen sc1
v_cvt_pk_bf16_f32 v92, v32, v33
v_cvt_pk_bf16_f32 v93, v34, v35
v_mfma_f32_16x16x32_bf16 v[36:39], a[124:127], v[80:83], v[36:39]
ds_read_b128 v[110:113], v5 offset:256
s_waitcnt lgkmcnt(2)
v_mfma_f32_16x16x32_bf16 v[44:47], a[180:183], v[80:83], v[44:47]
v_fma_f32 v40, -v106, v114, v40
v_fma_f32 v41, -v106, v115, v41
v_mfma_f32_16x16x32_bf16 v[52:55], a[236:239], v[80:83], v[52:55]
v_fma_f32 v42, -v106, v116, v42
v_fma_f32 v43, -v106, v117, v43
v_mfma_f32_16x16x32_bf16 v[60:63], v[156:159], v[80:83], v[60:63]
v_cvt_pk_bf16_f32 v94, v40, v41
v_cvt_pk_bf16_f32 v95, v42, v43
v_mfma_f32_16x16x32_bf16 v[68:71], v[212:215], v[80:83], v[68:71]
ds_read_b128 v[114:117], v5 offset:320
s_waitcnt lgkmcnt(4)
v_mfma_f32_16x16x32_bf16 v[20:23], a[16:19], v[72:75], v[20:23]
ds_read_b128 v[80:83], v3 offset:20480
v_mfma_f32_16x16x32_bf16 v[28:31], a[72:75], v[72:75], v[28:31]
s_waitcnt lgkmcnt(2)
v_fma_f32 v48, -v106, v110, v48
v_fma_f32 v49, -v106, v111, v49
v_mfma_f32_16x16x32_bf16 v[36:39], a[128:131], v[72:75], v[36:39]
v_fma_f32 v50, -v106, v112, v50
v_fma_f32 v51, -v106, v113, v51
v_mfma_f32_16x16x32_bf16 v[44:47], a[184:187], v[72:75], v[44:47]
v_cvt_pk_bf16_f32 v96, v48, v49
v_cvt_pk_bf16_f32 v97, v50, v51
v_mfma_f32_16x16x32_bf16 v[52:55], a[240:243], v[72:75], v[52:55]
ds_read_b128 v[110:113], v5 offset:384
s_waitcnt lgkmcnt(2)
v_mfma_f32_16x16x32_bf16 v[60:63], v[160:163], v[72:75], v[60:63]
v_fma_f32 v56, -v106, v114, v56
v_fma_f32 v57, -v106, v115, v57
v_mfma_f32_16x16x32_bf16 v[68:71], v[216:219], v[72:75], v[68:71]
v_fma_f32 v58, -v106, v116, v58
v_fma_f32 v59, -v106, v117, v59
s_waitcnt lgkmcnt(4)
v_mfma_f32_16x16x32_bf16 v[20:23], a[20:23], v[76:79], v[20:23]
ds_read_b128 v[72:75], v3 offset:21504
v_mfma_f32_16x16x32_bf16 v[28:31], a[76:79], v[76:79], v[28:31]
v_cvt_pk_bf16_f32 v98, v56, v57
v_cvt_pk_bf16_f32 v99, v58, v59
v_mfma_f32_16x16x32_bf16 v[36:39], a[132:135], v[76:79], v[36:39]
s_waitcnt lgkmcnt(1)
v_fma_f32 v64, -v106, v110, v64
v_fma_f32 v65, -v106, v111, v65
v_mfma_f32_16x16x32_bf16 v[44:47], a[188:191], v[76:79], v[44:47]
v_fma_f32 v66, -v106, v112, v66
v_fma_f32 v67, -v106, v113, v67
v_mfma_f32_16x16x32_bf16 v[52:55], a[244:247], v[76:79], v[52:55]
s_waitcnt vmcnt(2)
v_cmp_ne_u32 vcc, 1, v13
v_cvt_pk_bf16_f32 v100, v64, v65
v_mfma_f32_16x16x32_bf16 v[60:63], v[164:167], v[76:79], v[60:63]
v_cvt_pk_bf16_f32 v101, v66, v67
v_mfma_f32_16x16x32_bf16 v[68:71], v[220:223], v[76:79], v[68:71]
s_waitcnt lgkmcnt(2)
v_mfma_f32_16x16x32_bf16 v[20:23], a[24:27], v[80:83], v[20:23]
ds_read_b128 v[76:79], v3 offset:22528
v_mfma_f32_16x16x32_bf16 v[28:31], a[80:83], v[80:83], v[28:31]
s_cmp_eq_u64 vcc, 0
s_cselect_b32 s75, 1, 0
s_cselect_b32 s28, s66, 2146435072
v_mfma_f32_16x16x32_bf16 v[36:39], a[136:139], v[80:83], v[36:39]
s_cmp_lg_u32 s75, 0
s_cselect_b32 s29, s67, 2146435072
s_cselect_b32 s18, 8, 24
v_mfma_f32_16x16x32_bf16 v[44:47], a[192:195], v[80:83], v[44:47]
v_add_u32 v13, s18, v0
v_mov_b32 v108, s94
v_mfma_f32_16x16x32_bf16 v[52:55], a[248:251], v[80:83], v[52:55]
ds_write_b32 v13, v108
v_mfma_f32_16x16x32_bf16 v[60:63], v[168:171], v[80:83], v[60:63]
s_add_u32 s58, s28, 0
s_add_u32 m0, s76, 0
v_mfma_f32_16x16x32_bf16 v[68:71], v[224:227], v[80:83], v[68:71]
buffer_load_dwordx4 v1, s[8:11], s58 offen offset:0 sc1 lds
s_waitcnt lgkmcnt(2)
v_mfma_f32_16x16x32_bf16 v[20:23], a[28:31], v[72:75], v[20:23]
ds_read_b128 v[80:83], v3 offset:23552
v_mfma_f32_16x16x32_bf16 v[28:31], a[84:87], v[72:75], v[28:31]
buffer_load_dwordx4 v1, s[8:11], s58 offen offset:1024 sc1 lds
v_mfma_f32_16x16x32_bf16 v[36:39], a[140:143], v[72:75], v[36:39]
v_mfma_f32_16x16x32_bf16 v[44:47], a[196:199], v[72:75], v[44:47]
buffer_load_dwordx4 v1, s[8:11], s58 offen offset:2048 sc1 lds
v_mfma_f32_16x16x32_bf16 v[52:55], a[252:255], v[72:75], v[52:55]
v_mfma_f32_16x16x32_bf16 v[60:63], v[172:175], v[72:75], v[60:63]
s_add_u32 s58, s29, 0
s_add_u32 m0, s76, 3072
v_mfma_f32_16x16x32_bf16 v[68:71], v[228:231], v[72:75], v[68:71]
buffer_load_dwordx4 v1, s[8:11], s58 offen sc1 lds
s_waitcnt lgkmcnt(2)
v_mfma_f32_16x16x32_bf16 v[20:23], a[32:35], v[76:79], v[20:23]
ds_read_b128 v[72:75], v3 offset:24576
v_mfma_f32_16x16x32_bf16 v[28:31], a[88:91], v[76:79], v[28:31]
s_add_u32 s58, s28, 14336
s_add_u32 m0, s76, 4096
v_mfma_f32_16x16x32_bf16 v[36:39], a[144:147], v[76:79], v[36:39]
buffer_load_dwordx4 v1, s[8:11], s58 offen offset:0 sc1 lds
v_mfma_f32_16x16x32_bf16 v[44:47], a[200:203], v[76:79], v[44:47]
v_mfma_f32_16x16x32_bf16 v[52:55], v[120:123], v[76:79], v[52:55]
v_mfma_f32_16x16x32_bf16 v[60:63], v[176:179], v[76:79], v[60:63]
buffer_load_dwordx4 v1, s[8:11], s58 offen offset:1024 sc1 lds
v_mfma_f32_16x16x32_bf16 v[68:71], v[232:235], v[76:79], v[68:71]
s_waitcnt lgkmcnt(1)
v_mfma_f32_16x16x32_bf16 v[20:23], a[36:39], v[80:83], v[20:23]
ds_read_b128 v[76:79], v3 offset:25600
v_mfma_f32_16x16x32_bf16 v[28:31], a[92:95], v[80:83], v[28:31]
s_waitcnt vmcnt(6)
v_cmp_eq_u32 vcc, -1, v14
v_mfma_f32_16x16x32_bf16 v[36:39], a[148:151], v[80:83], v[36:39]
buffer_load_dwordx4 v1, s[8:11], s58 offen offset:2048 sc1 lds
v_mfma_f32_16x16x32_bf16 v[44:47], a[204:207], v[80:83], v[44:47]
s_cmp_eq_u64 vcc, 0
s_cselect_b32 s97, 3, 1
s_and_b32 s97, s97, s73
v_mfma_f32_16x16x32_bf16 v[52:55], v[124:127], v[80:83], v[52:55]
s_add_u32 s58, s29, 14336
s_add_u32 m0, s76, 7168
v_mfma_f32_16x16x32_bf16 v[60:63], v[180:183], v[80:83], v[60:63]
s_add_u32 s56, s62, s50
s_add_u32 s57, s63, s51
v_mfma_f32_16x16x32_bf16 v[68:71], v[236:239], v[80:83], v[68:71]
s_waitcnt lgkmcnt(1)
v_mfma_f32_16x16x32_bf16 v[20:23], a[40:43], v[72:75], v[20:23]
ds_read_b128 v[80:83], v3 offset:26624
v_mfma_f32_16x16x32_bf16 v[28:31], a[96:99], v[72:75], v[28:31]
s_cmp_lg_u32 s97, 0
s_cselect_b32 s56, s56, 2146435072
s_cselect_b32 s57, s57, 2146435072
v_mfma_f32_16x16x32_bf16 v[36:39], a[152:155], v[72:75], v[36:39]
buffer_load_dwordx4 v1, s[8:11], s58 offen sc1 lds
s_cmp_lg_u32 s97, 0
s_cselect_b32 s52, 4, 24
v_mfma_f32_16x16x32_bf16 v[44:47], a[208:211], v[72:75], v[44:47]
v_add_u32 v14, s52, v0
v_mov_b32 v12, s94
v_mfma_f32_16x16x32_bf16 v[52:55], v[128:131], v[72:75], v[52:55]
ds_write_b32 v14, v12
s_mov_b32 m0, s48
v_mfma_f32_16x16x32_bf16 v[60:63], v[184:187], v[72:75], v[60:63]
buffer_load_dwordx4 v1, s[8:11], s56 offen offset:0 sc1 lds
v_mfma_f32_16x16x32_bf16 v[68:71], v[240:243], v[72:75], v[68:71]
buffer_load_dwordx4 v1, s[8:11], s56 offen offset:1024 sc1 lds
s_waitcnt lgkmcnt(2)
v_mfma_f32_16x16x32_bf16 v[20:23], a[44:47], v[76:79], v[20:23]
ds_read_b128 v[72:75], v3 offset:27648
v_mfma_f32_16x16x32_bf16 v[28:31], a[100:103], v[76:79], v[28:31]
buffer_load_dwordx4 v1, s[8:11], s56 offen offset:2048 sc1 lds
v_mfma_f32_16x16x32_bf16 v[36:39], a[156:159], v[76:79], v[36:39]
v_mfma_f32_16x16x32_bf16 v[44:47], a[212:215], v[76:79], v[44:47]
buffer_load_dwordx4 v1, s[8:11], s56 offen offset:3072 sc1 lds
v_mfma_f32_16x16x32_bf16 v[52:55], v[132:135], v[76:79], v[52:55]
v_mfma_f32_16x16x32_bf16 v[60:63], v[188:191], v[76:79], v[60:63]
s_add_u32 m0, s48, 4096
s_add_u32 s51, s56, 4096
v_mfma_f32_16x16x32_bf16 v[68:71], v[244:247], v[76:79], v[68:71]
buffer_load_dwordx4 v1, s[8:11], s51 offen offset:0 sc1 lds
s_waitcnt lgkmcnt(2)
v_mfma_f32_16x16x32_bf16 v[20:23], a[48:51], v[80:83], v[20:23]
v_mfma_f32_16x16x32_bf16 v[28:31], a[104:107], v[80:83], v[28:31]
v_mfma_f32_16x16x32_bf16 v[36:39], a[160:163], v[80:83], v[36:39]
buffer_load_dwordx4 v1, s[8:11], s51 offen offset:1024 sc1 lds
v_mfma_f32_16x16x32_bf16 v[44:47], a[216:219], v[80:83], v[44:47]
v_mfma_f32_16x16x32_bf16 v[52:55], v[136:139], v[80:83], v[52:55]
v_mfma_f32_16x16x32_bf16 v[60:63], v[192:195], v[80:83], v[60:63]
buffer_load_dwordx4 v1, s[8:11], s51 offen offset:2048 sc1 lds
v_mfma_f32_16x16x32_bf16 v[68:71], v[248:251], v[80:83], v[68:71]
s_waitcnt lgkmcnt(0)
v_mfma_f32_16x16x32_bf16 v[20:23], a[52:55], v[72:75], v[20:23]
s_mov_b32 m0, s49
v_mfma_f32_16x16x32_bf16 v[28:31], a[108:111], v[72:75], v[28:31]
buffer_load_dwordx4 v1, s[8:11], s57 offen sc1 lds
v_mfma_f32_16x16x32_bf16 v[36:39], a[164:167], v[72:75], v[36:39]
v_mfma_f32_16x16x32_bf16 v[44:47], a[220:223], v[72:75], v[44:47]
v_mfma_f32_16x16x32_bf16 v[52:55], v[140:143], v[72:75], v[52:55]
v_mfma_f32_16x16x32_bf16 v[60:63], v[196:199], v[72:75], v[60:63]
v_mfma_f32_16x16x32_bf16 v[68:71], v[252:255], v[72:75], v[68:71]
ds_read_b128 v[110:113], v5 offset:0
ds_read_b128 v[114:117], v5 offset:64
s_waitcnt lgkmcnt(1)
v_fma_f32 v20, -v107, v110, v20
v_fma_f32 v21, -v107, v111, v21
v_fma_f32 v22, -v107, v112, v22
v_fma_f32 v23, -v107, v113, v23
v_cvt_pk_bf16_f32 v72, v20, v21
v_cvt_pk_bf16_f32 v73, v22, v23
ds_read_b128 v[110:113], v5 offset:128
s_waitcnt lgkmcnt(1)
v_fma_f32 v28, -v107, v114, v28
v_fma_f32 v29, -v107, v115, v29
v_fma_f32 v30, -v107, v116, v30
v_fma_f32 v31, -v107, v117, v31
v_cvt_pk_bf16_f32 v74, v28, v29
v_cvt_pk_bf16_f32 v75, v30, v31
ds_read_b128 v[114:117], v5 offset:192
s_waitcnt lgkmcnt(1)
v_fma_f32 v36, -v107, v110, v36
v_fma_f32 v37, -v107, v111, v37
v_fma_f32 v38, -v107, v112, v38
v_fma_f32 v39, -v107, v113, v39
v_cvt_pk_bf16_f32 v76, v36, v37
v_cvt_pk_bf16_f32 v77, v38, v39
ds_read_b128 v[110:113], v5 offset:256
s_waitcnt lgkmcnt(1)
v_fma_f32 v44, -v107, v114, v44
v_fma_f32 v45, -v107, v115, v45
v_fma_f32 v46, -v107, v116, v46
v_fma_f32 v47, -v107, v117, v47
v_cvt_pk_bf16_f32 v78, v44, v45
v_cvt_pk_bf16_f32 v79, v46, v47
ds_read_b128 v[114:117], v5 offset:320
s_waitcnt lgkmcnt(1)
v_fma_f32 v52, -v107, v110, v52
v_fma_f32 v53, -v107, v111, v53
v_fma_f32 v54, -v107, v112, v54
v_fma_f32 v55, -v107, v113, v55
v_cvt_pk_bf16_f32 v80, v52, v53
v_cvt_pk_bf16_f32 v81, v54, v55
ds_read_b128 v[110:113], v5 offset:384
s_waitcnt lgkmcnt(1)
v_fma_f32 v60, -v107, v114, v60
v_fma_f32 v61, -v107, v115, v61
v_fma_f32 v62, -v107, v116, v62
v_fma_f32 v63, -v107, v117, v63
v_cvt_pk_bf16_f32 v82, v60, v61
v_cvt_pk_bf16_f32 v83, v62, v63
s_waitcnt lgkmcnt(0)
v_fma_f32 v68, -v107, v110, v68
v_fma_f32 v69, -v107, v111, v69
v_fma_f32 v70, -v107, v112, v70
v_fma_f32 v71, -v107, v113, v71
v_cvt_pk_bf16_f32 v84, v68, v69
v_cvt_pk_bf16_f32 v85, v70, v71
s_cmp_lg_u32 s75, 0
s_cbranch_scc1 Ltq_89
s_cmp_lg_u32 s32, 3
s_cbranch_scc1 Lpq_94
s_branch Lpg_91
Lpf_90:
s_sleep 2
Lpg_91:
buffer_load_dword v8, v119, s[8:11], s74 offen sc1
s_sub_u32 s36, s36, 1
s_cbranch_scc1 L_timeout_18
s_waitcnt vmcnt(0)
v_cmp_ne_u32 vcc, 1, v8
s_cmp_eq_u32 s98, 0
s_cbranch_scc1 Lpp_95
s_waitcnt vmcnt(0)
v_mov_b32 v8, s96
s_mov_b64 exec, 1
ds_add_rtn_u32 v8, v8, v15 offset:0
s_mov_b64 exec, -1
s_waitcnt lgkmcnt(0)
v_readfirstlane_b32 s45, v8
s_nop 0
s_and_b32 s45, s45, s93
s_cmp_lg_u32 s45, s93
s_cbranch_scc1 Lpn_96
buffer_store_dword v15, off, s[8:11], s99 sc1
Lpn_96:
s_mov_b32 s98, 0
Lpp_95:
s_cbranch_vccnz Lpf_90
v_mov_b32 v8, s94
ds_write_b32 v0, v8 offset:8
s_branch Lpe_93
Lpq_94:
s_cmp_eq_u32 s98, 0
s_cbranch_scc1 Lpp_97
s_waitcnt vmcnt(0)
v_mov_b32 v8, s96
s_mov_b64 exec, 1
ds_add_rtn_u32 v8, v8, v15 offset:0
s_mov_b64 exec, -1
s_waitcnt lgkmcnt(0)
v_readfirstlane_b32 s45, v8
s_nop 0
s_and_b32 s45, s45, s93
s_cmp_lg_u32 s45, s93
s_cbranch_scc1 Lpn_98
buffer_store_dword v15, off, s[8:11], s99 sc1
Lpn_98:
s_mov_b32 s98, 0
Lpp_97:
Lph_92:
s_sleep 1
ds_read_b32 v8, v0 offset:8
s_sub_u32 s92, s92, 1
s_cbranch_scc1 L_timeout_18
s_waitcnt lgkmcnt(0)
v_cmp_gt_u32 vcc, s94, v8
s_nop 0
s_cbranch_vccnz Lph_92
Lpe_93:
s_add_u32 s46, s66, 0
s_add_u32 m0, s76, 0
s_nop 0
buffer_load_dwordx4 v1, s[8:11], s46 offen offset:0 sc1 lds
buffer_load_dwordx4 v1, s[8:11], s46 offen offset:1024 sc1 lds
buffer_load_dwordx4 v1, s[8:11], s46 offen offset:2048 sc1 lds
s_add_u32 s46, s67, 0
s_add_u32 m0, s76, 3072
s_nop 0
buffer_load_dwordx4 v1, s[8:11], s46 offen sc1 lds
s_add_u32 s46, s66, 14336
s_add_u32 m0, s76, 4096
s_nop 0
buffer_load_dwordx4 v1, s[8:11], s46 offen offset:0 sc1 lds
buffer_load_dwordx4 v1, s[8:11], s46 offen offset:1024 sc1 lds
buffer_load_dwordx4 v1, s[8:11], s46 offen offset:2048 sc1 lds
s_add_u32 s46, s67, 14336
s_add_u32 m0, s76, 7168
s_nop 0
buffer_load_dwordx4 v1, s[8:11], s46 offen sc1 lds
s_mov_b32 s75, 1
Ltq_89:
buffer_load_dwordx4 v[44:47], v6, s[8:11], s68 offen offset:0 sc1
buffer_load_dwordx4 v[48:51], v6, s[8:11], s68 offen offset:512 sc1
buffer_load_dwordx4 v[52:55], v6, s[8:11], s68 offen offset:1024 sc1
buffer_load_dwordx2 v[56:57], v6, s[8:11], s69 offen sc1
v_add_u32 v8, s76, v1
v_add_u32 v9, s78, v8
s_cmp_eq_u32 s32, 0
s_cselect_b64 s[42:43], -1, 0
v_cndmask_b32 v86, v105, v104, s[42:43]
s_waitcnt vmcnt(4)
ds_read_b128 v[16:19], v8 offset:0
ds_read_b128 v[20:23], v8 offset:4096
ds_read_b128 v[24:27], v8 offset:1024
ds_read_b128 v[28:31], v8 offset:5120
ds_read_b128 v[32:35], v8 offset:2048
ds_read_b128 v[36:39], v8 offset:6144
ds_read_b64 v[40:41], v9 offset:3072
ds_read_b64 v[42:43], v9 offset:7168
s_waitcnt lgkmcnt(6)
v_mfma_f32_16x16x32_bf16 v[60:63], v[16:19], v[88:91], 0
v_mfma_f32_16x16x32_bf16 v[64:67], v[16:19], v[72:75], 0
v_mfma_f32_16x16x32_bf16 v[68:71], v[20:23], v[72:75], 0
s_waitcnt lgkmcnt(4)
v_mfma_f32_16x16x32_bf16 v[60:63], v[24:27], v[92:95], v[60:63]
v_mfma_f32_16x16x32_bf16 v[64:67], v[24:27], v[76:79], v[64:67]
v_mfma_f32_16x16x32_bf16 v[68:71], v[28:31], v[76:79], v[68:71]
s_waitcnt lgkmcnt(2)
v_mfma_f32_16x16x32_bf16 v[60:63], v[32:35], v[96:99], v[60:63]
v_mfma_f32_16x16x32_bf16 v[64:67], v[32:35], v[80:83], v[64:67]
v_mfma_f32_16x16x32_bf16 v[68:71], v[36:39], v[80:83], v[68:71]
s_waitcnt lgkmcnt(0)
v_mfma_f32_16x16x16_bf16 v[60:63], v[40:41], v[100:101], v[60:63]
v_mfma_f32_16x16x16_bf16 v[64:67], v[40:41], v[84:85], v[64:67]
v_mfma_f32_16x16x16_bf16 v[68:71], v[42:43], v[84:85], v[68:71]
s_nop 0
ds_write_b128 v7, v[60:63] offset:0
s_nop 2
ds_write_b128 v7, v[64:67] offset:3072
s_nop 2
ds_write_b128 v7, v[68:71] offset:4096
s_branch Ltm_100
Ltm_99:
s_sleep 2
s_cmp_lg_u32 s97, 0
s_cbranch_scc1 Lhr_101
s_cmp_eq_u32 s73, 0
s_cbranch_scc1 Lhr_101
buffer_load_dword v14, v2, s[8:11], s63 offen sc1
s_waitcnt vmcnt(0)
v_cmp_eq_u32 vcc, -1, v14
s_nop 0
s_cbranch_vccnz Lhr_101
v_mov_b32 v14, s94
ds_write_b32 v0, v14 offset:4
s_xor_b32 s44, s95, 32768
s_mul_i32 s42, s32, 7168
s_add_u32 s43, s62, s42
s_add_u32 s42, s42, s44
s_mov_b32 m0, s42
s_nop 0
buffer_load_dwordx4 v1, s[8:11], s43 offen offset:0 sc1 lds
buffer_load_dwordx4 v1, s[8:11], s43 offen offset:1024 sc1 lds
buffer_load_dwordx4 v1, s[8:11], s43 offen offset:2048 sc1 lds
buffer_load_dwordx4 v1, s[8:11], s43 offen offset:3072 sc1 lds
s_add_u32 s43, s43, 4096
s_add_u32 m0, s42, 4096
s_nop 0
buffer_load_dwordx4 v1, s[8:11], s43 offen offset:0 sc1 lds
buffer_load_dwordx4 v1, s[8:11], s43 offen offset:1024 sc1 lds
buffer_load_dwordx4 v1, s[8:11], s43 offen offset:2048 sc1 lds
s_lshl_b32 s42, s32, 10
s_add_u32 s43, s63, s42
s_add_u32 s42, s42, s44
s_add_u32 m0, s42, 28672
s_nop 0
buffer_load_dwordx4 v1, s[8:11], s43 offen sc1 lds
s_mov_b32 s97, 1
Lhr_101:
buffer_load_dwordx4 v[44:47], v6, s[8:11], s68 offen offset:0 sc1
buffer_load_dwordx4 v[48:51], v6, s[8:11], s68 offen offset:512 sc1
buffer_load_dwordx4 v[52:55], v6, s[8:11], s68 offen offset:1024 sc1
buffer_load_dwordx2 v[56:57], v6, s[8:11], s69 offen sc1
s_sub_u32 s36, s36, 1
s_cbranch_scc1 L_timeout_19
Ltm_100:
s_waitcnt vmcnt(0)
v_max3_u32 v8, v44, v45, v46
v_max3_u32 v8, v8, v47, v48
v_max3_u32 v8, v8, v49, v50
v_max3_u32 v8, v8, v51, v52
v_max3_u32 v8, v8, v53, v54
v_max3_u32 v8, v8, v55, v56
v_max_u32 v8, v8, v57
v_cmp_eq_u32 vcc, -1, v8
s_nop 0
s_cbranch_vccnz Ltm_99
v_mfma_f32_16x16x32_bf16 v[104:107], v[44:47], v[88:91], 0
v_mfma_f32_16x16x32_bf16 v[108:111], v[44:47], v[72:75], 0
v_mfma_f32_16x16x32_bf16 v[104:107], v[48:51], v[92:95], v[104:107]
v_mfma_f32_16x16x32_bf16 v[108:111], v[48:51], v[76:79], v[108:111]
v_mfma_f32_16x16x32_bf16 v[104:107], v[52:55], v[96:99], v[104:107]
v_mfma_f32_16x16x32_bf16 v[108:111], v[52:55], v[80:83], v[108:111]
s_nop 1
v_mfma_f32_16x16x16_bf16 v[104:107], v[56:57], v[100:101], v[104:107]
s_nop 1
v_mfma_f32_16x16x16_bf16 v[108:111], v[56:57], v[84:85], v[108:111]
s_nop 4
ds_write_b128 v7, v[104:107] offset:2048
s_nop 2
ds_write_b128 v7, v[108:111] offset:5120
s_waitcnt lgkmcnt(0)
s_barrier
s_cmp_ge_u32 s32, 2
s_cbranch_scc1 LT_post
s_cmp_ge_u32 s37, 2
s_cselect_b32 s42, s97, 0
s_cmp_lg_u32 s42, 0
s_cselect_b32 s16, s70, s16
s_cselect_b32 s17, s71, s17
s_cbranch_scc1 LT_pend
ds_read_b128 v[16:19], v118 offset:0
ds_read_b128 v[20:23], v118 offset:1024
ds_read_b128 v[24:27], v118 offset:2048
ds_read_b128 v[28:31], v118 offset:6144
ds_read_b128 v[32:35], v118 offset:7168
ds_read_b128 v[36:39], v118 offset:8192
ds_read_b128 v[40:43], v118 offset:12288
ds_read_b128 v[44:47], v118 offset:13312
ds_read_b128 v[48:51], v118 offset:14336
ds_read_b128 v[52:55], v118 offset:18432
ds_read_b128 v[56:59], v118 offset:19456
ds_read_b128 v[60:63], v118 offset:20480
v_mov_b32 v8, 0xf149f2ca
s_waitcnt lgkmcnt(6)
v_pk_add_f32 v[16:17], v[16:17], v[28:29]
v_pk_add_f32 v[18:19], v[18:19], v[30:31]
v_pk_add_f32 v[20:21], v[20:21], v[32:33]
v_pk_add_f32 v[22:23], v[22:23], v[34:35]
v_pk_add_f32 v[24:25], v[24:25], v[36:37]
v_pk_add_f32 v[26:27], v[26:27], v[38:39]
s_waitcnt lgkmcnt(3)
v_pk_add_f32 v[16:17], v[16:17], v[40:41]
v_pk_add_f32 v[18:19], v[18:19], v[42:43]
v_pk_add_f32 v[20:21], v[20:21], v[44:45]
v_pk_add_f32 v[22:23], v[22:23], v[46:47]
v_pk_add_f32 v[24:25], v[24:25], v[48:49]
v_pk_add_f32 v[26:27], v[26:27], v[50:51]
s_waitcnt lgkmcnt(0)
v_pk_add_f32 v[16:17], v[16:17], v[52:53]
v_pk_add_f32 v[18:19], v[18:19], v[54:55]
v_pk_add_f32 v[20:21], v[20:21], v[56:57]
v_pk_add_f32 v[22:23], v[22:23], v[58:59]
v_pk_add_f32 v[24:25], v[24:25], v[60:61]
v_pk_add_f32 v[26:27], v[26:27], v[62:63]
v_cndmask_b32 v16, v8, v16, s[20:21]
v_cndmask_b32 v20, v8, v20, s[2:3]
v_cndmask_b32 v17, v8, v17, s[22:23]
v_cndmask_b32 v21, v8, v21, s[4:5]
v_cndmask_b32 v18, v8, v18, s[24:25]
v_cndmask_b32 v22, v8, v22, s[6:7]
v_cndmask_b32 v19, v8, v19, s[26:27]
v_cndmask_b32 v23, v8, v23, s[30:31]
v_max3_f32 v9, v16, v17, v18
v_max3_f32 v10, v19, v20, v21
v_max3_f32 v9, v9, v22, v23
v_max3_f32 v10, v10, v24, v25
v_max3_f32 v9, v9, v26, v27
v_max_f32 v9, v9, v10
v_mov_b32 v10, v9
s_nop 1
v_permlane16_swap_b32 v9, v10
v_max_f32 v9, v9, v10
v_mov_b32 v10, v9
s_nop 1
v_permlane32_swap_b32 v9, v10
v_max_f32 v9, v9, v10
v_mul_f32 v8, v9, v86
v_pk_fma_f32 v[16:17], v[16:17], v[86:87], v[8:9] op_sel_hi:[1,0,0] neg_lo:[0,0,1] neg_hi:[0,0,1]
v_pk_fma_f32 v[18:19], v[18:19], v[86:87], v[8:9] op_sel_hi:[1,0,0] neg_lo:[0,0,1] neg_hi:[0,0,1]
v_pk_fma_f32 v[20:21], v[20:21], v[86:87], v[8:9] op_sel_hi:[1,0,0] neg_lo:[0,0,1] neg_hi:[0,0,1]
v_pk_fma_f32 v[22:23], v[22:23], v[86:87], v[8:9] op_sel_hi:[1,0,0] neg_lo:[0,0,1] neg_hi:[0,0,1]
v_pk_fma_f32 v[24:25], v[24:25], v[86:87], v[8:9] op_sel_hi:[1,0,0] neg_lo:[0,0,1] neg_hi:[0,0,1]
v_pk_fma_f32 v[26:27], v[26:27], v[86:87], v[8:9] op_sel_hi:[1,0,0] neg_lo:[0,0,1] neg_hi:[0,0,1]
v_exp_f32 v16, v16
v_exp_f32 v17, v17
v_exp_f32 v18, v18
v_exp_f32 v19, v19
v_exp_f32 v20, v20
v_exp_f32 v21, v21
v_exp_f32 v22, v22
v_exp_f32 v23, v23
v_exp_f32 v24, v24
v_exp_f32 v25, v25
v_exp_f32 v26, v26
v_exp_f32 v27, v27
v_add_f32 v28, v16, v17
v_add_f32 v29, v18, v19
v_add_f32 v30, v20, v21
v_add_f32 v31, v22, v23
v_add_f32 v32, v24, v25
v_add_f32 v33, v26, v27
v_add_f32 v28, v28, v29
v_add_f32 v30, v30, v31
v_add_f32 v32, v32, v33
v_add_f32 v9, v28, v30
v_fmac_f32 v9, 0.5, v32
v_mov_b32 v10, v9
s_nop 1
v_permlane16_swap_b32 v9, v10
v_add_f32 v9, v9, v10
v_mov_b32 v10, v9
s_nop 1
v_permlane32_swap_b32 v9, v10
v_add_f32 v9, v9, v10
v_rcp_f32 v8, v9
s_nop 0
v_pk_mul_f32 v[16:17], v[16:17], v[8:9] op_sel_hi:[1,0]
v_pk_mul_f32 v[18:19], v[18:19], v[8:9] op_sel_hi:[1,0]
v_pk_mul_f32 v[20:21], v[20:21], v[8:9] op_sel_hi:[1,0]
v_pk_mul_f32 v[22:23], v[22:23], v[8:9] op_sel_hi:[1,0]
v_pk_mul_f32 v[24:25], v[24:25], v[8:9] op_sel_hi:[1,0]
v_pk_mul_f32 v[26:27], v[26:27], v[8:9] op_sel_hi:[1,0]
v_cvt_pk_bf16_f32 v110, v16, v17
v_cvt_pk_bf16_f32 v111, v18, v19
v_cvt_pk_bf16_f32 v112, v20, v21
v_cvt_pk_bf16_f32 v113, v22, v23
v_cvt_pk_bf16_f32 v114, v24, v25
v_cvt_pk_bf16_f32 v115, v26, v27
buffer_store_dwordx4 v[110:113], v1, s[8:11], s70 offen sc1
buffer_store_dwordx2 v[114:115], v87, s[8:11], s71 offen sc1
LT_pend:
s_mov_b32 s99, s79
s_mov_b32 s98, 1
s_xor_b32 s96, s96, 16
s_cmp_ge_u32 s37, 2
s_cbranch_scc1 LT_post
s_cmp_eq_u32 s98, 0
s_cbranch_scc1 Lpp_102
s_waitcnt vmcnt(0)
v_mov_b32 v14, s96
s_mov_b64 exec, 1
ds_add_rtn_u32 v14, v14, v15 offset:0
s_mov_b64 exec, -1
s_waitcnt lgkmcnt(0)
v_readfirstlane_b32 s45, v14
s_nop 0
s_and_b32 s45, s45, s93
s_cmp_lg_u32 s45, s93
s_cbranch_scc1 Lpn_103
buffer_store_dword v15, off, s[8:11], s99 sc1
Lpn_103:
s_mov_b32 s98, 0
Lpp_102:
LT_post:
s_cmp_lg_u32 s73, 0
s_cbranch_scc1 LT_loop
s_cmp_eq_u32 s98, 0
s_cbranch_scc1 Lpp_104
s_waitcnt vmcnt(0)
v_mov_b32 v14, s96
s_mov_b64 exec, 1
ds_add_rtn_u32 v14, v14, v15 offset:0
s_mov_b64 exec, -1
s_waitcnt lgkmcnt(0)
v_readfirstlane_b32 s45, v14
s_nop 0
s_and_b32 s45, s45, s93
s_cmp_lg_u32 s45, s93
s_cbranch_scc1 Lpn_105
buffer_store_dword v15, off, s[8:11], s99 sc1
Lpn_105:
s_mov_b32 s98, 0
Lpp_104:
s_branch L_done
Lxb_85:
s_cmp_lg_u32 s73, 2
s_cbranch_scc1 Lxn_86
s_cmp_eq_u32 s19, 0
s_cbranch_scc1 Lxf_106
v_mov_b32 v14, s94
ds_write_b32 v0, v14 offset:4
s_cmp_eq_u32 s98, 0
s_cbranch_scc1 Lpp_107
s_waitcnt vmcnt(0)
v_mov_b32 v14, s96
s_mov_b64 exec, 1
ds_add_rtn_u32 v14, v14, v15 offset:0
s_mov_b64 exec, -1
s_waitcnt lgkmcnt(0)
v_readfirstlane_b32 s45, v14
s_nop 0
s_and_b32 s45, s45, s93
s_cmp_lg_u32 s45, s93
s_cbranch_scc1 Lpn_108
buffer_store_dword v15, off, s[8:11], s99 sc1
Lpn_108:
s_mov_b32 s98, 0
Lpp_107:
s_branch Lxn_86
Lxe_88:
s_sleep 2
s_branch Lxn_86
Lxf_106:
s_cmp_lg_u32 s32, 3
s_cbranch_scc1 Lpq_113
s_branch Lpg_110
Lpf_109:
s_sleep 2
Lpg_110:
buffer_load_dword v14, v2, s[8:11], s63 offen sc1
s_sub_u32 s36, s36, 1
s_cbranch_scc1 L_timeout_17
s_waitcnt vmcnt(0)
v_cmp_eq_u32 vcc, -1, v14
s_cmp_eq_u32 s98, 0
s_cbranch_scc1 Lpp_114
s_waitcnt vmcnt(0)
v_mov_b32 v14, s96
s_mov_b64 exec, 1
ds_add_rtn_u32 v14, v14, v15 offset:0
s_mov_b64 exec, -1
s_waitcnt lgkmcnt(0)
v_readfirstlane_b32 s45, v14
s_nop 0
s_and_b32 s45, s45, s93
s_cmp_lg_u32 s45, s93
s_cbranch_scc1 Lpn_115
buffer_store_dword v15, off, s[8:11], s99 sc1
Lpn_115:
s_mov_b32 s98, 0
Lpp_114:
s_cbranch_vccnz Lpf_109
v_mov_b32 v14, s94
ds_write_b32 v0, v14 offset:4
s_branch Lpe_112
Lpq_113:
s_cmp_eq_u32 s98, 0
s_cbranch_scc1 Lpp_116
s_waitcnt vmcnt(0)
v_mov_b32 v14, s96
s_mov_b64 exec, 1
ds_add_rtn_u32 v14, v14, v15 offset:0
s_mov_b64 exec, -1
s_waitcnt lgkmcnt(0)
v_readfirstlane_b32 s45, v14
s_nop 0
s_and_b32 s45, s45, s93
s_cmp_lg_u32 s45, s93
s_cbranch_scc1 Lpn_117
buffer_store_dword v15, off, s[8:11], s99 sc1
Lpn_117:
s_mov_b32 s98, 0
Lpp_116:
Lph_111:
s_sleep 1
ds_read_b32 v14, v0 offset:4
s_sub_u32 s92, s92, 1
s_cbranch_scc1 L_timeout_17
s_waitcnt lgkmcnt(0)
v_cmp_gt_u32 vcc, s94, v14
s_nop 0
s_cbranch_vccnz Lph_111
Lpe_112:
s_mov_b32 s19, 1
Lxn_86:
s_sub_u32 s36, s36, 1
s_cbranch_scc1 L_timeout_17
s_xor_b32 s44, s95, 32768
s_mul_i32 s42, s32, 7168
s_add_u32 s43, s62, s42
s_add_u32 s42, s42, s44
s_mov_b32 m0, s42
s_nop 0
buffer_load_dwordx4 v1, s[8:11], s43 offen offset:0 sc1 lds
buffer_load_dwordx4 v1, s[8:11], s43 offen offset:1024 sc1 lds
buffer_load_dwordx4 v1, s[8:11], s43 offen offset:2048 sc1 lds
buffer_load_dwordx4 v1, s[8:11], s43 offen offset:3072 sc1 lds
s_add_u32 s43, s43, 4096
s_add_u32 m0, s42, 4096
s_nop 0
buffer_load_dwordx4 v1, s[8:11], s43 offen offset:0 sc1 lds
buffer_load_dwordx4 v1, s[8:11], s43 offen offset:1024 sc1 lds
buffer_load_dwordx4 v1, s[8:11], s43 offen offset:2048 sc1 lds
s_lshl_b32 s42, s32, 10
s_add_u32 s43, s63, s42
s_add_u32 s42, s42, s44
s_add_u32 m0, s42, 28672
s_nop 0
buffer_load_dwordx4 v1, s[8:11], s43 offen sc1 lds
s_waitcnt vmcnt(0)
s_branch Lxt_84
L_roleO:
s_lshr_b32 s38, s40, 1
s_and_b32 s65, s40, 1
s_mov_b32 s59, s41
v_mbcnt_lo_u32_b32 v0, -1, 0
v_mbcnt_hi_u32_b32 v0, -1, v0
v_lshlrev_b32 v1, 4, v0
s_mov_b32 s92, 0x1000000
s_mov_b32 s97, 0
s_mov_b32 s98, 0
s_mov_b32 s95, 0
v_min_u32 v2, 15, v0
v_lshlrev_b32 v2, 7, v2
v_mov_b32 v3, 0
s_mov_b32 s77, 3
s_mul_i32 s28, s59, s77
v_min_u32 v12, 63, v0
v_lshlrev_b32 v12, 7, v12
s_mov_b32 s46, 118571008
s_add_u32 s47, s46, 0
buffer_load_dword v8, v12, s[8:11], s47 offen sc1
s_add_u32 s47, s46, 8192
buffer_load_dword v9, v12, s[8:11], s47 offen sc1
s_add_u32 s47, s46, 16384
buffer_load_dword v10, v12, s[8:11], s47 offen sc1
s_add_u32 s47, s46, 24576
buffer_load_dword v11, v12, s[8:11], s47 offen sc1
s_branch Lwg_119
Lwf_118:
s_sleep 12
s_add_u32 s47, s46, 0
buffer_load_dword v8, v12, s[8:11], s47 offen sc1
s_add_u32 s47, s46, 8192
buffer_load_dword v9, v12, s[8:11], s47 offen sc1
s_add_u32 s47, s46, 16384
buffer_load_dword v10, v12, s[8:11], s47 offen sc1
s_add_u32 s47, s46, 24576
buffer_load_dword v11, v12, s[8:11], s47 offen sc1
s_sub_u32 s36, s36, 1
s_cbranch_scc1 L_timeout_14
Lwg_119:
s_waitcnt vmcnt(0)
v_and_b32 v8, v8, v9
v_and_b32 v8, v8, v10
v_and_b32 v8, v8, v11
v_cmp_ne_u32 vcc, 1, v8
s_nop 0
s_cbranch_vccnz Lwf_118
s_lshl_b32 s47, s38, 6
s_add_u32 s47, s47, s65
s_mul_i32 s71, s47, 458752
s_lshl_b32 s40, s28, 15
s_add_u32 s71, s71, s40
s_lshl_b32 s40, s32, 12
s_add_u32 s71, s71, s40
s_add_u32 s71, s71, 23855104
s_mul_i32 s41, s47, 40960
s_add_u32 s63, s41, s40
s_add_u32 s63, s63, 97255424
s_lshl_b32 s40, s32, 10
s_add_u32 s64, s41, s40
s_add_u32 s64, s64, 97271808
s_mul_i32 s60, s47, 114688
s_add_u32 s60, s60, s40
s_lshl_b32 s40, s28, 13
s_add_u32 s60, s60, s40
s_add_u32 s60, s60, 82575360
s_cmp_eq_u32 s59, 4
s_cselect_b32 s76, 2146435072, 0
s_cmp_eq_u32 s77, 2
s_cselect_b32 s76, 2146435072, s76
s_lshr_b32 s44, s32, 1
s_and_b32 s45, s32, 1
s_mov_b32 s46, s28
s_mul_i32 s40, s45, 14
s_add_u32 s46, s46, s40
s_lshl_b32 s47, s38, 7
s_add_u32 s47, s47, s65
s_mul_i32 s42, s47, 28672
s_add_u32 s42, s42, 12845056
s_lshl_b32 s43, s47, 12
s_add_u32 s43, s43, 118865920
s_add_u32 s40, s46, s44
s_lshl_b32 s41, s40, 10
s_add_u32 s72, s42, s41
s_lshl_b32 s41, s40, 7
s_add_u32 s62, s43, s41
s_add_u32 s40, s46, 2
s_lshl_b32 s41, s40, 10
s_add_u32 s73, s42, s41
s_lshl_b32 s41, s40, 7
s_add_u32 s75, s43, s41
s_cmp_lg_u32 s44, 0
s_cselect_b32 s78, 2146435072, s76
s_mul_i32 s40, s32, 12288
v_add_u32 v4, s40, v1
s_lshl_b32 s40, s44, 12
s_lshl_b32 s41, s45, 10
s_add_u32 s40, s40, s41
v_add_u32 v5, s40, v1
s_add_u32 s41, s41, 8192
v_add_u32 v7, s41, v1
v_and_b32 v6, 15, v0
v_lshlrev_b32 v6, 3, v6
s_mov_b32 s70, 0
s_mov_b32 s27, 0
s_mov_b32 s66, 1
s_lshr_b32 s54, s65, 5
s_lshl_b32 s54, s54, 12
s_and_b32 s55, s65, 31
s_lshl2_add_u32 s54, s55, s54
s_lshl_b32 s55, s38, 13
s_add_u32 s54, s54, s55
s_add_u32 s67, s54, 118423552
s_add_u32 s68, s67, 32768
s_add_u32 s69, s67, 49152
s_add_u32 s61, s72, 1835008
s_add_u32 s74, s73, 1835008
s_or_b32 s74, s74, s78
s_or_b32 s79, s75, s78
s_lshl1_add_u32 s47, s59, s65
v_mov_b32 v8, -1
v_mov_b32 v9, -1
v_mov_b32 v10, -1
v_mov_b32 v11, -1
s_mov_b32 s40, 0
s_mov_b32 s41, 0
s_mov_b32 s42, 32
Lar_120:
s_add_u32 s43, s61, s40
buffer_store_dwordx4 v[8:11], v1, s[8:11], s43 offen sc1
s_add_u32 s43, s62, s41
buffer_store_dwordx2 v[8:9], v6, s[8:11], s43 offen sc1
s_add_u32 s43, s74, s40
buffer_store_dwordx4 v[8:11], v1, s[8:11], s43 offen sc1
s_add_u32 s43, s79, s41
buffer_store_dwordx2 v[8:9], v6, s[8:11], s43 offen sc1
s_waitcnt vmcnt(32)
s_add_u32 s40, s40, 57344
s_add_u32 s41, s41, 8192
s_sub_u32 s42, s42, 1
s_cmp_lg_u32 s42, 0
s_cbranch_scc1 Lar_120
s_waitcnt vmcnt(0)
s_barrier
s_lshl_b32 s40, s38, 13
s_lshl_b32 s41, s47, 7
s_add_u32 s40, s40, s41
s_add_u32 s40, s40, 118489088
s_cmp_eq_u32 s32, 0
s_cselect_b32 s40, s40, 2146435072
v_mov_b32 v8, 1
buffer_store_dword v8, off, s[8:11], s40 sc1
v_mov_b32 v0, 126464
v_mov_b32 v8, 0
v_mov_b32 v9, 0
v_mov_b32 v10, 0
v_mov_b32 v11, 0
ds_write_b128 v0, v[8:11]
ds_write_b128 v0, v[8:11] offset:16
s_mov_b32 s96, 126464
s_mov_b32 s94, 1
s_mov_b32 s93, 3
v_mov_b32 v15, 1
s_waitcnt lgkmcnt(0)
s_barrier
LO_loop0:
s_cmp_lg_u32 s97, 0
s_cbranch_scc1 Lo1_121
s_cmp_lg_u32 s32, 3
s_cbranch_scc1 Lpq_127
s_branch Lpg_124
Lpf_123:
s_sleep 2
Lpg_124:
buffer_load_dword v144, v2, s[8:11], s67 offen sc1
s_sub_u32 s36, s36, 1
s_cbranch_scc1 L_timeout_20
s_waitcnt vmcnt(0)
v_cmp_ne_u32 vcc, 1, v144
s_cmp_eq_u32 s98, 0
s_cbranch_scc1 Lpp_128
s_waitcnt vmcnt(0)
v_mov_b32 v144, s96
s_mov_b64 exec, 1
ds_add_rtn_u32 v144, v144, v15 offset:0
s_mov_b64 exec, -1
s_waitcnt lgkmcnt(0)
v_readfirstlane_b32 s45, v144
s_nop 0
s_and_b32 s45, s45, s93
s_cmp_lg_u32 s45, s93
s_cbranch_scc1 Lpn_129
buffer_store_dword v15, off, s[8:11], s99 sc1
Lpn_129:
s_mov_b32 s98, 0
Lpp_128:
s_cbranch_vccnz Lpf_123
v_mov_b32 v144, s94
ds_write_b32 v0, v144 offset:4
s_branch Lpe_126
Lpq_127:
s_cmp_eq_u32 s98, 0
s_cbranch_scc1 Lpp_130
s_waitcnt vmcnt(0)
v_mov_b32 v144, s96
s_mov_b64 exec, 1
ds_add_rtn_u32 v144, v144, v15 offset:0
s_mov_b64 exec, -1
s_waitcnt lgkmcnt(0)
v_readfirstlane_b32 s45, v144
s_nop 0
s_and_b32 s45, s45, s93
s_cmp_lg_u32 s45, s93
s_cbranch_scc1 Lpn_131
buffer_store_dword v15, off, s[8:11], s99 sc1
Lpn_131:
s_mov_b32 s98, 0
Lpp_130:
Lph_125:
s_sleep 1
ds_read_b32 v144, v0 offset:4
s_sub_u32 s92, s92, 1
s_cbranch_scc1 L_timeout_20
s_waitcnt lgkmcnt(0)
v_cmp_gt_u32 vcc, s94, v144
s_nop 0
s_cbranch_vccnz Lph_125
Lpe_126:
s_mov_b32 s29, 0
s_add_u32 s43, s71, 0
s_or_b32 s43, s43, s29
buffer_load_dwordx4 a[0:3], v1, s[8:11], s43 offen offset:0 sc1
buffer_load_dwordx4 a[4:7], v1, s[8:11], s43 offen offset:1024 sc1
buffer_load_dwordx4 a[8:11], v1, s[8:11], s43 offen offset:2048 sc1
buffer_load_dwordx4 a[12:15], v1, s[8:11], s43 offen offset:3072 sc1
s_add_u32 s43, s71, 16384
s_or_b32 s43, s43, s29
buffer_load_dwordx4 a[16:19], v1, s[8:11], s43 offen offset:0 sc1
buffer_load_dwordx4 a[20:23], v1, s[8:11], s43 offen offset:1024 sc1
buffer_load_dwordx4 a[24:27], v1, s[8:11], s43 offen offset:2048 sc1
buffer_load_dwordx4 a[28:31], v1, s[8:11], s43 offen offset:3072 sc1
s_add_u32 s43, s71, 32768
s_or_b32 s43, s43, s29
buffer_load_dwordx4 a[32:35], v1, s[8:11], s43 offen offset:0 sc1
buffer_load_dwordx4 a[36:39], v1, s[8:11], s43 offen offset:1024 sc1
buffer_load_dwordx4 a[40:43], v1, s[8:11], s43 offen offset:2048 sc1
buffer_load_dwordx4 a[44:47], v1, s[8:11], s43 offen offset:3072 sc1
s_add_u32 s43, s71, 49152
s_or_b32 s43, s43, s29
buffer_load_dwordx4 a[48:51], v1, s[8:11], s43 offen offset:0 sc1
buffer_load_dwordx4 a[52:55], v1, s[8:11], s43 offen offset:1024 sc1
buffer_load_dwordx4 a[56:59], v1, s[8:11], s43 offen offset:2048 sc1
buffer_load_dwordx4 a[60:63], v1, s[8:11], s43 offen offset:3072 sc1
s_add_u32 s43, s71, 65536
s_or_b32 s43, s43, s29
s_or_b32 s43, s43, s76
buffer_load_dwordx4 a[64:67], v1, s[8:11], s43 offen offset:0 sc1
buffer_load_dwordx4 a[68:71], v1, s[8:11], s43 offen offset:1024 sc1
buffer_load_dwordx4 a[72:75], v1, s[8:11], s43 offen offset:2048 sc1
buffer_load_dwordx4 a[76:79], v1, s[8:11], s43 offen offset:3072 sc1
s_add_u32 s43, s71, 81920
s_or_b32 s43, s43, s29
s_or_b32 s43, s43, s76
buffer_load_dwordx4 a[80:83], v1, s[8:11], s43 offen offset:0 sc1
buffer_load_dwordx4 a[84:87], v1, s[8:11], s43 offen offset:1024 sc1
buffer_load_dwordx4 a[88:91], v1, s[8:11], s43 offen offset:2048 sc1
buffer_load_dwordx4 a[92:95], v1, s[8:11], s43 offen offset:3072 sc1
s_or_b32 s43, s72, s29
buffer_load_dwordx4 v[128:131], v1, s[8:11], s43 offen sc1
s_or_b32 s43, s73, s29
s_or_b32 s43, s43, s78
buffer_load_dwordx4 v[132:135], v1, s[8:11], s43 offen sc1
s_waitcnt vmcnt(8)
Lo1_121:
s_mov_b32 s37, s65
s_add_u32 s61, s72, 1835008
s_add_u32 s74, s73, 1835008
s_or_b32 s74, s74, s78
s_add_u32 s65, s65, 2
s_add_u32 s71, s71, 917504
s_add_u32 s72, s72, 57344
s_add_u32 s73, s73, 57344
s_cmp_lt_u32 s65, 64
s_cselect_b32 s66, 1, 0
s_lshr_b32 s54, s65, 5
s_lshl_b32 s54, s54, 12
s_and_b32 s55, s65, 31
s_lshl2_add_u32 s54, s55, s54
s_lshl_b32 s55, s38, 13
s_add_u32 s54, s54, s55
s_add_u32 s67, s54, 118423552
s_cmp_lg_u32 s27, 0
s_cbranch_scc1 Lop_132
s_cmp_lg_u32 s32, 3
s_cbranch_scc1 Lpq_137
s_branch Lpg_134
Lpf_133:
s_sleep 2
Lpg_134:
buffer_load_dword v145, v2, s[8:11], s69 offen sc1
s_sub_u32 s36, s36, 1
s_cbranch_scc1 L_timeout_21
s_waitcnt vmcnt(0)
v_cmp_ne_u32 vcc, 1, v145
s_cmp_eq_u32 s98, 0
s_cbranch_scc1 Lpp_138
s_waitcnt vmcnt(0)
v_mov_b32 v145, s96
s_mov_b64 exec, 1
ds_add_rtn_u32 v145, v145, v15 offset:0
s_mov_b64 exec, -1
s_waitcnt lgkmcnt(0)
v_readfirstlane_b32 s45, v145
s_nop 0
s_and_b32 s45, s45, s93
s_cmp_lg_u32 s45, s93
s_cbranch_scc1 Lpn_139
buffer_store_dword v15, off, s[8:11], s99 sc1
Lpn_139:
s_mov_b32 s98, 0
Lpp_138:
s_cbranch_vccnz Lpf_133
v_mov_b32 v145, s94
ds_write_b32 v0, v145 offset:8
s_branch Lpe_136
Lpq_137:
s_cmp_eq_u32 s98, 0
s_cbranch_scc1 Lpp_140
s_waitcnt vmcnt(0)
v_mov_b32 v145, s96
s_mov_b64 exec, 1
ds_add_rtn_u32 v145, v145, v15 offset:0
s_mov_b64 exec, -1
s_waitcnt lgkmcnt(0)
v_readfirstlane_b32 s45, v145
s_nop 0
s_and_b32 s45, s45, s93
s_cmp_lg_u32 s45, s93
s_cbranch_scc1 Lpn_141
buffer_store_dword v15, off, s[8:11], s99 sc1
Lpn_141:
s_mov_b32 s98, 0
Lpp_140:
Lph_135:
s_sleep 1
ds_read_b32 v145, v0 offset:8
s_sub_u32 s92, s92, 1
s_cbranch_scc1 L_timeout_21
s_waitcnt lgkmcnt(0)
v_cmp_gt_u32 vcc, s94, v145
s_nop 0
s_cbranch_vccnz Lph_135
Lpe_136:
Lop_132:
s_add_u32 s42, s63, 0
buffer_load_dwordx4 v[88:91], v1, s[8:11], s42 offen offset:0 sc1
buffer_load_dwordx4 v[92:95], v1, s[8:11], s42 offen offset:1024 sc1
buffer_load_dwordx4 v[96:99], v1, s[8:11], s42 offen offset:2048 sc1
buffer_load_dwordx4 v[100:103], v1, s[8:11], s42 offen offset:3072 sc1
buffer_load_dword v144, v2, s[8:11], s67 offen sc1
buffer_load_dword v146, off, s[8:11], s68 sc1
s_add_u32 s42, s63, 20480
buffer_load_dwordx4 v[108:111], v1, s[8:11], s42 offen offset:0 sc1
buffer_load_dwordx4 v[112:115], v1, s[8:11], s42 offen offset:1024 sc1
buffer_load_dwordx4 v[116:119], v1, s[8:11], s42 offen offset:2048 sc1
buffer_load_dwordx4 v[120:123], v1, s[8:11], s42 offen offset:3072 sc1
s_add_u32 s42, s64, 0
buffer_load_dwordx4 v[104:107], v1, s[8:11], s42 offen sc1
s_add_u32 s42, s64, 20480
buffer_load_dwordx4 v[124:127], v1, s[8:11], s42 offen sc1
s_waitcnt vmcnt(11)
v_mfma_f32_16x16x32_bf16 v[16:19], a[0:3], v[88:91], 0
v_mfma_f32_16x16x32_bf16 v[24:27], a[16:19], v[88:91], 0
v_mfma_f32_16x16x32_bf16 v[32:35], a[32:35], v[88:91], 0
v_mfma_f32_16x16x32_bf16 v[40:43], a[48:51], v[88:91], 0
v_mfma_f32_16x16x32_bf16 v[48:51], a[64:67], v[88:91], 0
v_mfma_f32_16x16x32_bf16 v[56:59], a[80:83], v[88:91], 0
s_waitcnt vmcnt(10)
v_mfma_f32_16x16x32_bf16 v[16:19], a[4:7], v[92:95], v[16:19]
v_mfma_f32_16x16x32_bf16 v[24:27], a[20:23], v[92:95], v[24:27]
v_mfma_f32_16x16x32_bf16 v[32:35], a[36:39], v[92:95], v[32:35]
v_mfma_f32_16x16x32_bf16 v[40:43], a[52:55], v[92:95], v[40:43]
v_mfma_f32_16x16x32_bf16 v[48:51], a[68:71], v[92:95], v[48:51]
v_mfma_f32_16x16x32_bf16 v[56:59], a[84:87], v[92:95], v[56:59]
s_waitcnt vmcnt(9)
v_mfma_f32_16x16x32_bf16 v[16:19], a[8:11], v[96:99], v[16:19]
v_mfma_f32_16x16x32_bf16 v[24:27], a[24:27], v[96:99], v[24:27]
v_mfma_f32_16x16x32_bf16 v[32:35], a[40:43], v[96:99], v[32:35]
v_mfma_f32_16x16x32_bf16 v[40:43], a[56:59], v[96:99], v[40:43]
v_mfma_f32_16x16x32_bf16 v[48:51], a[72:75], v[96:99], v[48:51]
v_mfma_f32_16x16x32_bf16 v[56:59], a[88:91], v[96:99], v[56:59]
s_waitcnt vmcnt(8)
v_mfma_f32_16x16x32_bf16 v[16:19], a[12:15], v[100:103], v[16:19]
v_mfma_f32_16x16x32_bf16 v[24:27], a[28:31], v[100:103], v[24:27]
v_mfma_f32_16x16x32_bf16 v[32:35], a[44:47], v[100:103], v[32:35]
v_mfma_f32_16x16x32_bf16 v[40:43], a[60:63], v[100:103], v[40:43]
v_mfma_f32_16x16x32_bf16 v[48:51], a[76:79], v[100:103], v[48:51]
v_mfma_f32_16x16x32_bf16 v[56:59], a[92:95], v[100:103], v[56:59]
s_waitcnt vmcnt(6)
v_cmp_ne_u32 vcc, 1, v144
v_readfirstlane_b32 s70, v146
s_add_u32 s47, s94, 1
s_cmp_eq_u64 vcc, 0
s_cselect_b32 s97, s66, 0
s_cmp_lg_u32 s97, 0
s_cselect_b32 s29, 0, 2146435072
s_cselect_b32 s44, 4, 24
v_add_u32 v144, s44, v0
v_mov_b32 v145, s47
ds_write_b32 v144, v145
s_cmp_lg_u32 s70, 0
s_cselect_b32 s30, 0, 2146435072
s_cselect_b32 s44, 12, 24
s_or_b32 s31, s29, s30
v_add_u32 v146, s44, v0
v_mov_b32 v147, s94
ds_write_b32 v146, v147
s_waitcnt vmcnt(5)
v_mfma_f32_16x16x32_bf16 v[20:23], a[0:3], v[108:111], 0
v_mfma_f32_16x16x32_bf16 v[28:31], a[16:19], v[108:111], 0
s_add_u32 s42, s60, 0
s_or_b32 s42, s42, s30
buffer_load_dwordx4 v[64:67], v1, s[8:11], s42 offen sc1
v_mfma_f32_16x16x32_bf16 v[36:39], a[32:35], v[108:111], 0
v_mfma_f32_16x16x32_bf16 v[44:47], a[48:51], v[108:111], 0
s_add_u32 s42, s60, 4096
s_or_b32 s42, s42, s30
buffer_load_dwordx4 v[68:71], v1, s[8:11], s42 offen sc1
v_mfma_f32_16x16x32_bf16 v[52:55], a[64:67], v[108:111], 0
v_mfma_f32_16x16x32_bf16 v[60:63], a[80:83], v[108:111], 0
s_add_u32 s42, s60, 8192
s_or_b32 s42, s42, s30
buffer_load_dwordx4 v[72:75], v1, s[8:11], s42 offen sc1
s_waitcnt vmcnt(7)
v_mfma_f32_16x16x32_bf16 v[20:23], a[4:7], v[112:115], v[20:23]
v_mfma_f32_16x16x32_bf16 v[28:31], a[20:23], v[112:115], v[28:31]
s_add_u32 s42, s60, 12288
s_or_b32 s42, s42, s30
buffer_load_dwordx4 v[76:79], v1, s[8:11], s42 offen sc1
v_mfma_f32_16x16x32_bf16 v[36:39], a[36:39], v[112:115], v[36:39]
v_mfma_f32_16x16x32_bf16 v[44:47], a[52:55], v[112:115], v[44:47]
s_add_u32 s42, s60, 16384
s_or_b32 s42, s42, s30
s_or_b32 s42, s42, s76
buffer_load_dwordx4 v[80:83], v1, s[8:11], s42 offen sc1
v_mfma_f32_16x16x32_bf16 v[52:55], a[68:71], v[112:115], v[52:55]
v_mfma_f32_16x16x32_bf16 v[60:63], a[84:87], v[112:115], v[60:63]
s_add_u32 s42, s60, 20480
s_or_b32 s42, s42, s30
s_or_b32 s42, s42, s76
buffer_load_dwordx4 v[84:87], v1, s[8:11], s42 offen sc1
s_waitcnt vmcnt(9)
v_mfma_f32_16x16x32_bf16 v[20:23], a[8:11], v[116:119], v[20:23]
s_add_u32 s43, s71, 0
s_or_b32 s43, s43, s31
buffer_load_dwordx4 a[96:99], v1, s[8:11], s43 offen offset:0 sc1
v_mfma_f32_16x16x32_bf16 v[28:31], a[24:27], v[116:119], v[28:31]
buffer_load_dwordx4 a[100:103], v1, s[8:11], s43 offen offset:1024 sc1
v_mfma_f32_16x16x32_bf16 v[36:39], a[40:43], v[116:119], v[36:39]
buffer_load_dwordx4 a[104:107], v1, s[8:11], s43 offen offset:2048 sc1
v_mfma_f32_16x16x32_bf16 v[44:47], a[56:59], v[116:119], v[44:47]
buffer_load_dwordx4 a[108:111], v1, s[8:11], s43 offen offset:3072 sc1
v_mfma_f32_16x16x32_bf16 v[52:55], a[72:75], v[116:119], v[52:55]
s_add_u32 s43, s71, 16384
s_or_b32 s43, s43, s31
buffer_load_dwordx4 a[112:115], v1, s[8:11], s43 offen offset:0 sc1
v_mfma_f32_16x16x32_bf16 v[60:63], a[88:91], v[116:119], v[60:63]
buffer_load_dwordx4 a[116:119], v1, s[8:11], s43 offen offset:1024 sc1
s_waitcnt vmcnt(14)
v_mfma_f32_16x16x32_bf16 v[20:23], a[12:15], v[120:123], v[20:23]
buffer_load_dwordx4 a[120:123], v1, s[8:11], s43 offen offset:2048 sc1
v_mfma_f32_16x16x32_bf16 v[28:31], a[28:31], v[120:123], v[28:31]
buffer_load_dwordx4 a[124:127], v1, s[8:11], s43 offen offset:3072 sc1
v_mfma_f32_16x16x32_bf16 v[36:39], a[44:47], v[120:123], v[36:39]
v_mfma_f32_16x16x32_bf16 v[44:47], a[60:63], v[120:123], v[44:47]
v_mfma_f32_16x16x32_bf16 v[52:55], a[76:79], v[120:123], v[52:55]
v_mfma_f32_16x16x32_bf16 v[60:63], a[92:95], v[120:123], v[60:63]
s_cmp_lg_u32 s70, 0
s_cbranch_scc1 Lo2_122
s_cmp_lg_u32 s32, 3
s_cbranch_scc1 Lpq_146
s_branch Lpg_143
Lpf_142:
s_sleep 2
Lpg_143:
buffer_load_dword v145, v3, s[8:11], s68 offen sc1
s_sub_u32 s36, s36, 1
s_cbranch_scc1 L_timeout_21
s_waitcnt vmcnt(0)
v_cmp_ne_u32 vcc, 1, v145
s_cmp_eq_u32 s98, 0
s_cbranch_scc1 Lpp_147
s_waitcnt vmcnt(0)
v_mov_b32 v145, s96
s_mov_b64 exec, 1
ds_add_rtn_u32 v145, v145, v15 offset:0
s_mov_b64 exec, -1
s_waitcnt lgkmcnt(0)
v_readfirstlane_b32 s45, v145
s_nop 0
s_and_b32 s45, s45, s93
s_cmp_lg_u32 s45, s93
s_cbranch_scc1 Lpn_148
buffer_store_dword v15, off, s[8:11], s99 sc1
Lpn_148:
s_mov_b32 s98, 0
Lpp_147:
s_cbranch_vccnz Lpf_142
v_mov_b32 v145, s94
ds_write_b32 v0, v145 offset:12
s_branch Lpe_145
Lpq_146:
s_cmp_eq_u32 s98, 0
s_cbranch_scc1 Lpp_149
s_waitcnt vmcnt(0)
v_mov_b32 v145, s96
s_mov_b64 exec, 1
ds_add_rtn_u32 v145, v145, v15 offset:0
s_mov_b64 exec, -1
s_waitcnt lgkmcnt(0)
v_readfirstlane_b32 s45, v145
s_nop 0
s_and_b32 s45, s45, s93
s_cmp_lg_u32 s45, s93
s_cbranch_scc1 Lpn_150
buffer_store_dword v15, off, s[8:11], s99 sc1
Lpn_150:
s_mov_b32 s98, 0
Lpp_149:
Lph_144:
s_sleep 1
ds_read_b32 v145, v0 offset:12
s_sub_u32 s92, s92, 1
s_cbranch_scc1 L_timeout_21
s_waitcnt lgkmcnt(0)
v_cmp_gt_u32 vcc, s94, v145
s_nop 0
s_cbranch_vccnz Lph_144
Lpe_145:
s_mov_b32 s30, 0
s_add_u32 s42, s60, 0
s_or_b32 s42, s42, s30
buffer_load_dwordx4 v[64:67], v1, s[8:11], s42 offen sc1
s_add_u32 s42, s60, 4096
s_or_b32 s42, s42, s30
buffer_load_dwordx4 v[68:71], v1, s[8:11], s42 offen sc1
s_add_u32 s42, s60, 8192
s_or_b32 s42, s42, s30
buffer_load_dwordx4 v[72:75], v1, s[8:11], s42 offen sc1
s_add_u32 s42, s60, 12288
s_or_b32 s42, s42, s30
buffer_load_dwordx4 v[76:79], v1, s[8:11], s42 offen sc1
s_add_u32 s42, s60, 16384
s_or_b32 s42, s42, s30
s_or_b32 s42, s42, s76
buffer_load_dwordx4 v[80:83], v1, s[8:11], s42 offen sc1
s_add_u32 s42, s60, 20480
s_or_b32 s42, s42, s30
s_or_b32 s42, s42, s76
buffer_load_dwordx4 v[84:87], v1, s[8:11], s42 offen sc1
buffer_load_dword v147, off, s[8:11], s31 sc1
buffer_load_dword v147, off, s[8:11], s31 sc1
buffer_load_dword v147, off, s[8:11], s31 sc1
buffer_load_dword v147, off, s[8:11], s31 sc1
buffer_load_dword v147, off, s[8:11], s31 sc1
buffer_load_dword v147, off, s[8:11], s31 sc1
buffer_load_dword v147, off, s[8:11], s31 sc1
buffer_load_dword v147, off, s[8:11], s31 sc1
Lo2_122:
s_add_u32 s94, s94, 1
s_add_u32 s68, s67, 32768
s_add_u32 s69, s67, 49152
s_add_u32 s63, s63, 81920
s_add_u32 s64, s64, 81920
s_add_u32 s60, s60, 229376
s_add_u32 s43, s71, 32768
s_or_b32 s43, s43, s29
buffer_load_dwordx4 a[128:131], v1, s[8:11], s43 offen offset:0 sc1
buffer_load_dwordx4 a[132:135], v1, s[8:11], s43 offen offset:1024 sc1
buffer_load_dwordx4 a[136:139], v1, s[8:11], s43 offen offset:2048 sc1
buffer_load_dwordx4 a[140:143], v1, s[8:11], s43 offen offset:3072 sc1
s_waitcnt vmcnt(17)
v_mfma_f32_16x16x32_bf16 v[16:19], v[64:67], v[104:107], v[16:19]
v_mfma_f32_16x16x32_bf16 v[20:23], v[64:67], v[124:127], v[20:23]
s_waitcnt vmcnt(16)
v_mfma_f32_16x16x32_bf16 v[24:27], v[68:71], v[104:107], v[24:27]
v_mfma_f32_16x16x32_bf16 v[28:31], v[68:71], v[124:127], v[28:31]
s_waitcnt vmcnt(15)
v_mfma_f32_16x16x32_bf16 v[32:35], v[72:75], v[104:107], v[32:35]
v_mfma_f32_16x16x32_bf16 v[36:39], v[72:75], v[124:127], v[36:39]
ds_write_b128 v4, v[16:19] offset:0
ds_write_b128 v4, v[20:23] offset:1024
s_waitcnt vmcnt(14)
v_mfma_f32_16x16x32_bf16 v[40:43], v[76:79], v[104:107], v[40:43]
v_mfma_f32_16x16x32_bf16 v[44:47], v[76:79], v[124:127], v[44:47]
ds_write_b128 v4, v[24:27] offset:2048
ds_write_b128 v4, v[28:31] offset:3072
s_waitcnt vmcnt(13)
v_mfma_f32_16x16x32_bf16 v[48:51], v[80:83], v[104:107], v[48:51]
v_mfma_f32_16x16x32_bf16 v[52:55], v[80:83], v[124:127], v[52:55]
ds_write_b128 v4, v[32:35] offset:4096
ds_write_b128 v4, v[36:39] offset:5120
s_waitcnt vmcnt(12)
v_mfma_f32_16x16x32_bf16 v[56:59], v[84:87], v[104:107], v[56:59]
v_mfma_f32_16x16x32_bf16 v[60:63], v[84:87], v[124:127], v[60:63]
ds_write_b128 v4, v[40:43] offset:6144
ds_write_b128 v4, v[44:47] offset:7168
buffer_load_dword v148, v2, s[8:11], s69 offen sc1
ds_write_b128 v4, v[48:51] offset:8192
ds_write_b128 v4, v[52:55] offset:9216
ds_write_b128 v4, v[56:59] offset:10240
s_nop 2
ds_write_b128 v4, v[60:63] offset:11264
s_waitcnt lgkmcnt(0)
s_barrier
ds_read_b128 v[16:19], v5 offset:0
ds_read_b128 v[20:23], v5 offset:2048
ds_read_b128 v[24:27], v5 offset:12288
ds_read_b128 v[28:31], v5 offset:14336
ds_read_b128 v[32:35], v5 offset:24576
ds_read_b128 v[36:39], v5 offset:26624
ds_read_b128 v[40:43], v5 offset:36864
ds_read_b128 v[44:47], v5 offset:38912
ds_read_b128 v[64:67], v7 offset:0
ds_read_b128 v[68:71], v7 offset:2048
ds_read_b128 v[72:75], v7 offset:12288
ds_read_b128 v[76:79], v7 offset:14336
ds_read_b128 v[80:83], v7 offset:24576
ds_read_b128 v[84:87], v7 offset:26624
ds_read_b128 v[88:91], v7 offset:36864
ds_read_b128 v[92:95], v7 offset:38912
s_waitcnt lgkmcnt(8)
v_pk_add_f32 v[16:17], v[16:17], v[24:25]
v_pk_add_f32 v[32:33], v[32:33], v[40:41]
v_pk_add_f32 v[18:19], v[18:19], v[26:27]
v_pk_add_f32 v[34:35], v[34:35], v[42:43]
v_pk_add_f32 v[20:21], v[20:21], v[28:29]
v_pk_add_f32 v[36:37], v[36:37], v[44:45]
v_pk_add_f32 v[22:23], v[22:23], v[30:31]
v_pk_add_f32 v[38:39], v[38:39], v[46:47]
v_pk_add_f32 v[16:17], v[16:17], v[32:33]
v_pk_add_f32 v[18:19], v[18:19], v[34:35]
v_pk_add_f32 v[20:21], v[20:21], v[36:37]
v_pk_add_f32 v[22:23], v[22:23], v[38:39]
v_lshlrev_b32 v8, 16, v128
v_and_b32 v9, 0xffff0000, v128
v_add_f32 v8, v8, v16
v_add_f32 v9, v9, v17
v_cvt_pk_bf16_f32 v24, v8, v9
v_lshlrev_b32 v8, 16, v129
v_and_b32 v9, 0xffff0000, v129
v_add_f32 v8, v8, v18
v_add_f32 v9, v9, v19
v_cvt_pk_bf16_f32 v25, v8, v9
v_lshlrev_b32 v8, 16, v130
v_and_b32 v9, 0xffff0000, v130
v_add_f32 v8, v8, v20
v_add_f32 v9, v9, v21
v_cvt_pk_bf16_f32 v26, v8, v9
v_lshlrev_b32 v8, 16, v131
v_and_b32 v9, 0xffff0000, v131
v_add_f32 v8, v8, v22
v_add_f32 v9, v9, v23
v_cvt_pk_bf16_f32 v27, v8, v9
v_min_u32 v24, -2, v24
v_min_u32 v25, -2, v25
v_min_u32 v26, -2, v26
v_min_u32 v27, -2, v27
buffer_store_dwordx4 v[24:27], v1, s[8:11], s61 offen sc1
v_lshlrev_b32 v8, 16, v24
v_and_b32 v9, 0xffff0000, v24
v_add_f32 v28, v8, v9
v_mul_f32 v29, v8, v8
v_fmac_f32 v29, v9, v9
v_lshlrev_b32 v8, 16, v25
v_and_b32 v9, 0xffff0000, v25
v_add_f32 v28, v28, v8
v_fmac_f32 v29, v8, v8
v_add_f32 v28, v28, v9
v_fmac_f32 v29, v9, v9
v_lshlrev_b32 v8, 16, v26
v_and_b32 v9, 0xffff0000, v26
v_add_f32 v28, v28, v8
v_fmac_f32 v29, v8, v8
v_add_f32 v28, v28, v9
v_fmac_f32 v29, v9, v9
v_lshlrev_b32 v8, 16, v27
v_and_b32 v9, 0xffff0000, v27
v_add_f32 v28, v28, v8
v_fmac_f32 v29, v8, v8
v_add_f32 v28, v28, v9
v_fmac_f32 v29, v9, v9
v_mov_b32 v8, v28
v_mov_b32 v9, v29
s_nop 0
v_permlane16_swap_b32 v28, v8
v_permlane16_swap_b32 v29, v9
v_add_f32 v28, v28, v8
v_add_f32 v29, v29, v9
v_mov_b32 v8, v28
v_mov_b32 v9, v29
s_nop 0
v_permlane32_swap_b32 v28, v8
v_permlane32_swap_b32 v29, v9
v_add_f32 v28, v28, v8
v_add_f32 v29, v29, v9
v_min_u32 v28, -2, v28
v_min_u32 v29, -2, v29
buffer_store_dwordx2 v[28:29], v6, s[8:11], s62 offen sc1
s_cmp_lg_u32 s78, 0
s_cbranch_scc1 Los_151
s_waitcnt lgkmcnt(0)
v_pk_add_f32 v[64:65], v[64:65], v[72:73]
v_pk_add_f32 v[80:81], v[80:81], v[88:89]
v_pk_add_f32 v[66:67], v[66:67], v[74:75]
v_pk_add_f32 v[82:83], v[82:83], v[90:91]
v_pk_add_f32 v[68:69], v[68:69], v[76:77]
v_pk_add_f32 v[84:85], v[84:85], v[92:93]
v_pk_add_f32 v[70:71], v[70:71], v[78:79]
v_pk_add_f32 v[86:87], v[86:87], v[94:95]
v_pk_add_f32 v[64:65], v[64:65], v[80:81]
v_pk_add_f32 v[66:67], v[66:67], v[82:83]
v_pk_add_f32 v[68:69], v[68:69], v[84:85]
v_pk_add_f32 v[70:71], v[70:71], v[86:87]
v_lshlrev_b32 v8, 16, v132
v_and_b32 v9, 0xffff0000, v132
v_add_f32 v8, v8, v64
v_add_f32 v9, v9, v65
v_cvt_pk_bf16_f32 v72, v8, v9
v_lshlrev_b32 v8, 16, v133
v_and_b32 v9, 0xffff0000, v133
v_add_f32 v8, v8, v66
v_add_f32 v9, v9, v67
v_cvt_pk_bf16_f32 v73, v8, v9
v_lshlrev_b32 v8, 16, v134
v_and_b32 v9, 0xffff0000, v134
v_add_f32 v8, v8, v68
v_add_f32 v9, v9, v69
v_cvt_pk_bf16_f32 v74, v8, v9
v_lshlrev_b32 v8, 16, v135
v_and_b32 v9, 0xffff0000, v135
v_add_f32 v8, v8, v70
v_add_f32 v9, v9, v71
v_cvt_pk_bf16_f32 v75, v8, v9
v_min_u32 v72, -2, v72
v_min_u32 v73, -2, v73
v_min_u32 v74, -2, v74
v_min_u32 v75, -2, v75
buffer_store_dwordx4 v[72:75], v1, s[8:11], s74 offen sc1
v_lshlrev_b32 v8, 16, v72
v_and_b32 v9, 0xffff0000, v72
v_add_f32 v76, v8, v9
v_mul_f32 v77, v8, v8
v_fmac_f32 v77, v9, v9
v_lshlrev_b32 v8, 16, v73
v_and_b32 v9, 0xffff0000, v73
v_add_f32 v76, v76, v8
v_fmac_f32 v77, v8, v8
v_add_f32 v76, v76, v9
v_fmac_f32 v77, v9, v9
v_lshlrev_b32 v8, 16, v74
v_and_b32 v9, 0xffff0000, v74
v_add_f32 v76, v76, v8
v_fmac_f32 v77, v8, v8
v_add_f32 v76, v76, v9
v_fmac_f32 v77, v9, v9
v_lshlrev_b32 v8, 16, v75
v_and_b32 v9, 0xffff0000, v75
v_add_f32 v76, v76, v8
v_fmac_f32 v77, v8, v8
v_add_f32 v76, v76, v9
v_fmac_f32 v77, v9, v9
v_mov_b32 v8, v76
v_mov_b32 v9, v77
s_nop 0
v_permlane16_swap_b32 v76, v8
v_permlane16_swap_b32 v77, v9
v_add_f32 v76, v76, v8
v_add_f32 v77, v77, v9
v_mov_b32 v8, v76
v_mov_b32 v9, v77
s_nop 0
v_permlane32_swap_b32 v76, v8
v_permlane32_swap_b32 v77, v9
v_add_f32 v76, v76, v8
v_add_f32 v77, v77, v9
v_min_u32 v76, -2, v76
v_min_u32 v77, -2, v77
buffer_store_dwordx2 v[76:77], v6, s[8:11], s75 offen sc1
Los_151:
s_add_u32 s62, s62, 8192
s_add_u32 s75, s75, 8192
s_waitcnt lgkmcnt(0)
s_barrier
s_add_u32 s43, s71, 49152
s_or_b32 s43, s43, s29
buffer_load_dwordx4 a[144:147], v1, s[8:11], s43 offen offset:0 sc1
buffer_load_dwordx4 a[148:151], v1, s[8:11], s43 offen offset:1024 sc1
buffer_load_dwordx4 a[152:155], v1, s[8:11], s43 offen offset:2048 sc1
buffer_load_dwordx4 a[156:159], v1, s[8:11], s43 offen offset:3072 sc1
s_add_u32 s43, s71, 65536
s_or_b32 s43, s43, s29
s_or_b32 s43, s43, s76
buffer_load_dwordx4 a[160:163], v1, s[8:11], s43 offen offset:0 sc1
buffer_load_dwordx4 a[164:167], v1, s[8:11], s43 offen offset:1024 sc1
buffer_load_dwordx4 a[168:171], v1, s[8:11], s43 offen offset:2048 sc1
buffer_load_dwordx4 a[172:175], v1, s[8:11], s43 offen offset:3072 sc1
s_add_u32 s43, s71, 81920
s_or_b32 s43, s43, s29
s_or_b32 s43, s43, s76
buffer_load_dwordx4 a[176:179], v1, s[8:11], s43 offen offset:0 sc1
buffer_load_dwordx4 a[180:183], v1, s[8:11], s43 offen offset:1024 sc1
buffer_load_dwordx4 a[184:187], v1, s[8:11], s43 offen offset:2048 sc1
buffer_load_dwordx4 a[188:191], v1, s[8:11], s43 offen offset:3072 sc1
s_or_b32 s43, s72, s29
buffer_load_dwordx4 v[136:139], v1, s[8:11], s43 offen sc1
s_or_b32 s43, s73, s29
s_or_b32 s43, s43, s78
buffer_load_dwordx4 v[140:143], v1, s[8:11], s43 offen sc1
s_cmp_lg_u32 s70, 0
s_cbranch_scc1 Lyb_152
s_add_u32 s43, s71, 0
s_or_b32 s43, s43, s29
buffer_load_dwordx4 a[96:99], v1, s[8:11], s43 offen offset:0 sc1
buffer_load_dwordx4 a[100:103], v1, s[8:11], s43 offen offset:1024 sc1
buffer_load_dwordx4 a[104:107], v1, s[8:11], s43 offen offset:2048 sc1
buffer_load_dwordx4 a[108:111], v1, s[8:11], s43 offen offset:3072 sc1
s_add_u32 s43, s71, 16384
s_or_b32 s43, s43, s29
buffer_load_dwordx4 a[112:115], v1, s[8:11], s43 offen offset:0 sc1
buffer_load_dwordx4 a[116:119], v1, s[8:11], s43 offen offset:1024 sc1
buffer_load_dwordx4 a[120:123], v1, s[8:11], s43 offen offset:2048 sc1
buffer_load_dwordx4 a[124:127], v1, s[8:11], s43 offen offset:3072 sc1
Lyb_152:
s_waitcnt vmcnt(16)
v_cmp_ne_u32 vcc, 1, v148
s_nop 0
s_cmp_eq_u64 vcc, 0
s_cselect_b32 s27, 1, 0
s_cselect_b32 s44, 8, 24
v_add_u32 v148, s44, v0
v_mov_b32 v149, s94
ds_write_b32 v148, v149
s_cmp_eq_u32 s66, 0
s_cbranch_scc1 L_done
LO_loop1:
s_cmp_lg_u32 s97, 0
s_cbranch_scc1 Lo1_153
s_cmp_lg_u32 s32, 3
s_cbranch_scc1 Lpq_159
s_branch Lpg_156
Lpf_155:
s_sleep 2
Lpg_156:
buffer_load_dword v144, v2, s[8:11], s67 offen sc1
s_sub_u32 s36, s36, 1
s_cbranch_scc1 L_timeout_20
s_waitcnt vmcnt(0)
v_cmp_ne_u32 vcc, 1, v144
s_cmp_eq_u32 s98, 0
s_cbranch_scc1 Lpp_160
s_waitcnt vmcnt(0)
v_mov_b32 v144, s96
s_mov_b64 exec, 1
ds_add_rtn_u32 v144, v144, v15 offset:0
s_mov_b64 exec, -1
s_waitcnt lgkmcnt(0)
v_readfirstlane_b32 s45, v144
s_nop 0
s_and_b32 s45, s45, s93
s_cmp_lg_u32 s45, s93
s_cbranch_scc1 Lpn_161
buffer_store_dword v15, off, s[8:11], s99 sc1
Lpn_161:
s_mov_b32 s98, 0
Lpp_160:
s_cbranch_vccnz Lpf_155
v_mov_b32 v144, s94
ds_write_b32 v0, v144 offset:4
s_branch Lpe_158
Lpq_159:
s_cmp_eq_u32 s98, 0
s_cbranch_scc1 Lpp_162
s_waitcnt vmcnt(0)
v_mov_b32 v144, s96
s_mov_b64 exec, 1
ds_add_rtn_u32 v144, v144, v15 offset:0
s_mov_b64 exec, -1
s_waitcnt lgkmcnt(0)
v_readfirstlane_b32 s45, v144
s_nop 0
s_and_b32 s45, s45, s93
s_cmp_lg_u32 s45, s93
s_cbranch_scc1 Lpn_163
buffer_store_dword v15, off, s[8:11], s99 sc1
Lpn_163:
s_mov_b32 s98, 0
Lpp_162:
Lph_157:
s_sleep 1
ds_read_b32 v144, v0 offset:4
s_sub_u32 s92, s92, 1
s_cbranch_scc1 L_timeout_20
s_waitcnt lgkmcnt(0)
v_cmp_gt_u32 vcc, s94, v144
s_nop 0
s_cbranch_vccnz Lph_157
Lpe_158:
s_mov_b32 s29, 0
s_add_u32 s43, s71, 0
s_or_b32 s43, s43, s29
buffer_load_dwordx4 a[96:99], v1, s[8:11], s43 offen offset:0 sc1
buffer_load_dwordx4 a[100:103], v1, s[8:11], s43 offen offset:1024 sc1
buffer_load_dwordx4 a[104:107], v1, s[8:11], s43 offen offset:2048 sc1
buffer_load_dwordx4 a[108:111], v1, s[8:11], s43 offen offset:3072 sc1
s_add_u32 s43, s71, 16384
s_or_b32 s43, s43, s29
buffer_load_dwordx4 a[112:115], v1, s[8:11], s43 offen offset:0 sc1
buffer_load_dwordx4 a[116:119], v1, s[8:11], s43 offen offset:1024 sc1
buffer_load_dwordx4 a[120:123], v1, s[8:11], s43 offen offset:2048 sc1
buffer_load_dwordx4 a[124:127], v1, s[8:11], s43 offen offset:3072 sc1
s_add_u32 s43, s71, 32768
s_or_b32 s43, s43, s29
buffer_load_dwordx4 a[128:131], v1, s[8:11], s43 offen offset:0 sc1
buffer_load_dwordx4 a[132:135], v1, s[8:11], s43 offen offset:1024 sc1
buffer_load_dwordx4 a[136:139], v1, s[8:11], s43 offen offset:2048 sc1
buffer_load_dwordx4 a[140:143], v1, s[8:11], s43 offen offset:3072 sc1
s_add_u32 s43, s71, 49152
s_or_b32 s43, s43, s29
buffer_load_dwordx4 a[144:147], v1, s[8:11], s43 offen offset:0 sc1
buffer_load_dwordx4 a[148:151], v1, s[8:11], s43 offen offset:1024 sc1
buffer_load_dwordx4 a[152:155], v1, s[8:11], s43 offen offset:2048 sc1
buffer_load_dwordx4 a[156:159], v1, s[8:11], s43 offen offset:3072 sc1
s_add_u32 s43, s71, 65536
s_or_b32 s43, s43, s29
s_or_b32 s43, s43, s76
buffer_load_dwordx4 a[160:163], v1, s[8:11], s43 offen offset:0 sc1
buffer_load_dwordx4 a[164:167], v1, s[8:11], s43 offen offset:1024 sc1
buffer_load_dwordx4 a[168:171], v1, s[8:11], s43 offen offset:2048 sc1
buffer_load_dwordx4 a[172:175], v1, s[8:11], s43 offen offset:3072 sc1
s_add_u32 s43, s71, 81920
s_or_b32 s43, s43, s29
s_or_b32 s43, s43, s76
buffer_load_dwordx4 a[176:179], v1, s[8:11], s43 offen offset:0 sc1
buffer_load_dwordx4 a[180:183], v1, s[8:11], s43 offen offset:1024 sc1
buffer_load_dwordx4 a[184:187], v1, s[8:11], s43 offen offset:2048 sc1
buffer_load_dwordx4 a[188:191], v1, s[8:11], s43 offen offset:3072 sc1
s_or_b32 s43, s72, s29
buffer_load_dwordx4 v[136:139], v1, s[8:11], s43 offen sc1
s_or_b32 s43, s73, s29
s_or_b32 s43, s43, s78
buffer_load_dwordx4 v[140:143], v1, s[8:11], s43 offen sc1
s_waitcnt vmcnt(8)
Lo1_153:
s_mov_b32 s37, s65
s_add_u32 s61, s72, 1835008
s_add_u32 s74, s73, 1835008
s_or_b32 s74, s74, s78
s_add_u32 s65, s65, 2
s_add_u32 s71, s71, 917504
s_add_u32 s72, s72, 57344
s_add_u32 s73, s73, 57344
s_cmp_lt_u32 s65, 64
s_cselect_b32 s66, 1, 0
s_lshr_b32 s54, s65, 5
s_lshl_b32 s54, s54, 12
s_and_b32 s55, s65, 31
s_lshl2_add_u32 s54, s55, s54
s_lshl_b32 s55, s38, 13
s_add_u32 s54, s54, s55
s_add_u32 s67, s54, 118423552
s_cmp_lg_u32 s27, 0
s_cbranch_scc1 Lop_164
s_cmp_lg_u32 s32, 3
s_cbranch_scc1 Lpq_169
s_branch Lpg_166
Lpf_165:
s_sleep 2
Lpg_166:
buffer_load_dword v145, v2, s[8:11], s69 offen sc1
s_sub_u32 s36, s36, 1
s_cbranch_scc1 L_timeout_21
s_waitcnt vmcnt(0)
v_cmp_ne_u32 vcc, 1, v145
s_cmp_eq_u32 s98, 0
s_cbranch_scc1 Lpp_170
s_waitcnt vmcnt(0)
v_mov_b32 v145, s96
s_mov_b64 exec, 1
ds_add_rtn_u32 v145, v145, v15 offset:0
s_mov_b64 exec, -1
s_waitcnt lgkmcnt(0)
v_readfirstlane_b32 s45, v145
s_nop 0
s_and_b32 s45, s45, s93
s_cmp_lg_u32 s45, s93
s_cbranch_scc1 Lpn_171
buffer_store_dword v15, off, s[8:11], s99 sc1
Lpn_171:
s_mov_b32 s98, 0
Lpp_170:
s_cbranch_vccnz Lpf_165
v_mov_b32 v145, s94
ds_write_b32 v0, v145 offset:8
s_branch Lpe_168
Lpq_169:
s_cmp_eq_u32 s98, 0
s_cbranch_scc1 Lpp_172
s_waitcnt vmcnt(0)
v_mov_b32 v145, s96
s_mov_b64 exec, 1
ds_add_rtn_u32 v145, v145, v15 offset:0
s_mov_b64 exec, -1
s_waitcnt lgkmcnt(0)
v_readfirstlane_b32 s45, v145
s_nop 0
s_and_b32 s45, s45, s93
s_cmp_lg_u32 s45, s93
s_cbranch_scc1 Lpn_173
buffer_store_dword v15, off, s[8:11], s99 sc1
Lpn_173:
s_mov_b32 s98, 0
Lpp_172:
Lph_167:
s_sleep 1
ds_read_b32 v145, v0 offset:8
s_sub_u32 s92, s92, 1
s_cbranch_scc1 L_timeout_21
s_waitcnt lgkmcnt(0)
v_cmp_gt_u32 vcc, s94, v145
s_nop 0
s_cbranch_vccnz Lph_167
Lpe_168:
Lop_164:
s_add_u32 s42, s63, 0
buffer_load_dwordx4 v[88:91], v1, s[8:11], s42 offen offset:0 sc1
buffer_load_dwordx4 v[92:95], v1, s[8:11], s42 offen offset:1024 sc1
buffer_load_dwordx4 v[96:99], v1, s[8:11], s42 offen offset:2048 sc1
buffer_load_dwordx4 v[100:103], v1, s[8:11], s42 offen offset:3072 sc1
buffer_load_dword v144, v2, s[8:11], s67 offen sc1
buffer_load_dword v146, off, s[8:11], s68 sc1
s_add_u32 s42, s63, 20480
buffer_load_dwordx4 v[108:111], v1, s[8:11], s42 offen offset:0 sc1
buffer_load_dwordx4 v[112:115], v1, s[8:11], s42 offen offset:1024 sc1
buffer_load_dwordx4 v[116:119], v1, s[8:11], s42 offen offset:2048 sc1
buffer_load_dwordx4 v[120:123], v1, s[8:11], s42 offen offset:3072 sc1
s_add_u32 s42, s64, 0
buffer_load_dwordx4 v[104:107], v1, s[8:11], s42 offen sc1
s_add_u32 s42, s64, 20480
buffer_load_dwordx4 v[124:127], v1, s[8:11], s42 offen sc1
s_waitcnt vmcnt(11)
v_mfma_f32_16x16x32_bf16 v[16:19], a[96:99], v[88:91], 0
v_mfma_f32_16x16x32_bf16 v[24:27], a[112:115], v[88:91], 0
v_mfma_f32_16x16x32_bf16 v[32:35], a[128:131], v[88:91], 0
v_mfma_f32_16x16x32_bf16 v[40:43], a[144:147], v[88:91], 0
v_mfma_f32_16x16x32_bf16 v[48:51], a[160:163], v[88:91], 0
v_mfma_f32_16x16x32_bf16 v[56:59], a[176:179], v[88:91], 0
s_waitcnt vmcnt(10)
v_mfma_f32_16x16x32_bf16 v[16:19], a[100:103], v[92:95], v[16:19]
v_mfma_f32_16x16x32_bf16 v[24:27], a[116:119], v[92:95], v[24:27]
v_mfma_f32_16x16x32_bf16 v[32:35], a[132:135], v[92:95], v[32:35]
v_mfma_f32_16x16x32_bf16 v[40:43], a[148:151], v[92:95], v[40:43]
v_mfma_f32_16x16x32_bf16 v[48:51], a[164:167], v[92:95], v[48:51]
v_mfma_f32_16x16x32_bf16 v[56:59], a[180:183], v[92:95], v[56:59]
s_waitcnt vmcnt(9)
v_mfma_f32_16x16x32_bf16 v[16:19], a[104:107], v[96:99], v[16:19]
v_mfma_f32_16x16x32_bf16 v[24:27], a[120:123], v[96:99], v[24:27]
v_mfma_f32_16x16x32_bf16 v[32:35], a[136:139], v[96:99], v[32:35]
v_mfma_f32_16x16x32_bf16 v[40:43], a[152:155], v[96:99], v[40:43]
v_mfma_f32_16x16x32_bf16 v[48:51], a[168:171], v[96:99], v[48:51]
v_mfma_f32_16x16x32_bf16 v[56:59], a[184:187], v[96:99], v[56:59]
s_waitcnt vmcnt(8)
v_mfma_f32_16x16x32_bf16 v[16:19], a[108:111], v[100:103], v[16:19]
v_mfma_f32_16x16x32_bf16 v[24:27], a[124:127], v[100:103], v[24:27]
v_mfma_f32_16x16x32_bf16 v[32:35], a[140:143], v[100:103], v[32:35]
v_mfma_f32_16x16x32_bf16 v[40:43], a[156:159], v[100:103], v[40:43]
v_mfma_f32_16x16x32_bf16 v[48:51], a[172:175], v[100:103], v[48:51]
v_mfma_f32_16x16x32_bf16 v[56:59], a[188:191], v[100:103], v[56:59]
s_waitcnt vmcnt(6)
v_cmp_ne_u32 vcc, 1, v144
v_readfirstlane_b32 s70, v146
s_add_u32 s47, s94, 1
s_cmp_eq_u64 vcc, 0
s_cselect_b32 s97, s66, 0
s_cmp_lg_u32 s97, 0
s_cselect_b32 s29, 0, 2146435072
s_cselect_b32 s44, 4, 24
v_add_u32 v144, s44, v0
v_mov_b32 v145, s47
ds_write_b32 v144, v145
s_cmp_lg_u32 s70, 0
s_cselect_b32 s30, 0, 2146435072
s_cselect_b32 s44, 12, 24
s_or_b32 s31, s29, s30
v_add_u32 v146, s44, v0
v_mov_b32 v147, s94
ds_write_b32 v146, v147
s_waitcnt vmcnt(5)
v_mfma_f32_16x16x32_bf16 v[20:23], a[96:99], v[108:111], 0
v_mfma_f32_16x16x32_bf16 v[28:31], a[112:115], v[108:111], 0
s_add_u32 s42, s60, 0
s_or_b32 s42, s42, s30
buffer_load_dwordx4 v[64:67], v1, s[8:11], s42 offen sc1
v_mfma_f32_16x16x32_bf16 v[36:39], a[128:131], v[108:111], 0
v_mfma_f32_16x16x32_bf16 v[44:47], a[144:147], v[108:111], 0
s_add_u32 s42, s60, 4096
s_or_b32 s42, s42, s30
buffer_load_dwordx4 v[68:71], v1, s[8:11], s42 offen sc1
v_mfma_f32_16x16x32_bf16 v[52:55], a[160:163], v[108:111], 0
v_mfma_f32_16x16x32_bf16 v[60:63], a[176:179], v[108:111], 0
s_add_u32 s42, s60, 8192
s_or_b32 s42, s42, s30
buffer_load_dwordx4 v[72:75], v1, s[8:11], s42 offen sc1
s_waitcnt vmcnt(7)
v_mfma_f32_16x16x32_bf16 v[20:23], a[100:103], v[112:115], v[20:23]
v_mfma_f32_16x16x32_bf16 v[28:31], a[116:119], v[112:115], v[28:31]
s_add_u32 s42, s60, 12288
s_or_b32 s42, s42, s30
buffer_load_dwordx4 v[76:79], v1, s[8:11], s42 offen sc1
v_mfma_f32_16x16x32_bf16 v[36:39], a[132:135], v[112:115], v[36:39]
v_mfma_f32_16x16x32_bf16 v[44:47], a[148:151], v[112:115], v[44:47]
s_add_u32 s42, s60, 16384
s_or_b32 s42, s42, s30
s_or_b32 s42, s42, s76
buffer_load_dwordx4 v[80:83], v1, s[8:11], s42 offen sc1
v_mfma_f32_16x16x32_bf16 v[52:55], a[164:167], v[112:115], v[52:55]
v_mfma_f32_16x16x32_bf16 v[60:63], a[180:183], v[112:115], v[60:63]
s_add_u32 s42, s60, 20480
s_or_b32 s42, s42, s30
s_or_b32 s42, s42, s76
buffer_load_dwordx4 v[84:87], v1, s[8:11], s42 offen sc1
s_waitcnt vmcnt(9)
v_mfma_f32_16x16x32_bf16 v[20:23], a[104:107], v[116:119], v[20:23]
s_add_u32 s43, s71, 0
s_or_b32 s43, s43, s31
buffer_load_dwordx4 a[0:3], v1, s[8:11], s43 offen offset:0 sc1
v_mfma_f32_16x16x32_bf16 v[28:31], a[120:123], v[116:119], v[28:31]
buffer_load_dwordx4 a[4:7], v1, s[8:11], s43 offen offset:1024 sc1
v_mfma_f32_16x16x32_bf16 v[36:39], a[136:139], v[116:119], v[36:39]
buffer_load_dwordx4 a[8:11], v1, s[8:11], s43 offen offset:2048 sc1
v_mfma_f32_16x16x32_bf16 v[44:47], a[152:155], v[116:119], v[44:47]
buffer_load_dwordx4 a[12:15], v1, s[8:11], s43 offen offset:3072 sc1
v_mfma_f32_16x16x32_bf16 v[52:55], a[168:171], v[116:119], v[52:55]
s_add_u32 s43, s71, 16384
s_or_b32 s43, s43, s31
buffer_load_dwordx4 a[16:19], v1, s[8:11], s43 offen offset:0 sc1
v_mfma_f32_16x16x32_bf16 v[60:63], a[184:187], v[116:119], v[60:63]
buffer_load_dwordx4 a[20:23], v1, s[8:11], s43 offen offset:1024 sc1
s_waitcnt vmcnt(14)
v_mfma_f32_16x16x32_bf16 v[20:23], a[108:111], v[120:123], v[20:23]
buffer_load_dwordx4 a[24:27], v1, s[8:11], s43 offen offset:2048 sc1
v_mfma_f32_16x16x32_bf16 v[28:31], a[124:127], v[120:123], v[28:31]
buffer_load_dwordx4 a[28:31], v1, s[8:11], s43 offen offset:3072 sc1
v_mfma_f32_16x16x32_bf16 v[36:39], a[140:143], v[120:123], v[36:39]
v_mfma_f32_16x16x32_bf16 v[44:47], a[156:159], v[120:123], v[44:47]
v_mfma_f32_16x16x32_bf16 v[52:55], a[172:175], v[120:123], v[52:55]
v_mfma_f32_16x16x32_bf16 v[60:63], a[188:191], v[120:123], v[60:63]
s_cmp_lg_u32 s70, 0
s_cbranch_scc1 Lo2_154
s_cmp_lg_u32 s32, 3
s_cbranch_scc1 Lpq_178
s_branch Lpg_175
Lpf_174:
s_sleep 2
Lpg_175:
buffer_load_dword v145, v3, s[8:11], s68 offen sc1
s_sub_u32 s36, s36, 1
s_cbranch_scc1 L_timeout_21
s_waitcnt vmcnt(0)
v_cmp_ne_u32 vcc, 1, v145
s_cmp_eq_u32 s98, 0
s_cbranch_scc1 Lpp_179
s_waitcnt vmcnt(0)
v_mov_b32 v145, s96
s_mov_b64 exec, 1
ds_add_rtn_u32 v145, v145, v15 offset:0
s_mov_b64 exec, -1
s_waitcnt lgkmcnt(0)
v_readfirstlane_b32 s45, v145
s_nop 0
s_and_b32 s45, s45, s93
s_cmp_lg_u32 s45, s93
s_cbranch_scc1 Lpn_180
buffer_store_dword v15, off, s[8:11], s99 sc1
Lpn_180:
s_mov_b32 s98, 0
Lpp_179:
s_cbranch_vccnz Lpf_174
v_mov_b32 v145, s94
ds_write_b32 v0, v145 offset:12
s_branch Lpe_177
Lpq_178:
s_cmp_eq_u32 s98, 0
s_cbranch_scc1 Lpp_181
s_waitcnt vmcnt(0)
v_mov_b32 v145, s96
s_mov_b64 exec, 1
ds_add_rtn_u32 v145, v145, v15 offset:0
s_mov_b64 exec, -1
s_waitcnt lgkmcnt(0)
v_readfirstlane_b32 s45, v145
s_nop 0
s_and_b32 s45, s45, s93
s_cmp_lg_u32 s45, s93
s_cbranch_scc1 Lpn_182
buffer_store_dword v15, off, s[8:11], s99 sc1
Lpn_182:
s_mov_b32 s98, 0
Lpp_181:
Lph_176:
s_sleep 1
ds_read_b32 v145, v0 offset:12
s_sub_u32 s92, s92, 1
s_cbranch_scc1 L_timeout_21
s_waitcnt lgkmcnt(0)
v_cmp_gt_u32 vcc, s94, v145
s_nop 0
s_cbranch_vccnz Lph_176
Lpe_177:
s_mov_b32 s30, 0
s_add_u32 s42, s60, 0
s_or_b32 s42, s42, s30
buffer_load_dwordx4 v[64:67], v1, s[8:11], s42 offen sc1
s_add_u32 s42, s60, 4096
s_or_b32 s42, s42, s30
buffer_load_dwordx4 v[68:71], v1, s[8:11], s42 offen sc1
s_add_u32 s42, s60, 8192
s_or_b32 s42, s42, s30
buffer_load_dwordx4 v[72:75], v1, s[8:11], s42 offen sc1
s_add_u32 s42, s60, 12288
s_or_b32 s42, s42, s30
buffer_load_dwordx4 v[76:79], v1, s[8:11], s42 offen sc1
s_add_u32 s42, s60, 16384
s_or_b32 s42, s42, s30
s_or_b32 s42, s42, s76
buffer_load_dwordx4 v[80:83], v1, s[8:11], s42 offen sc1
s_add_u32 s42, s60, 20480
s_or_b32 s42, s42, s30
s_or_b32 s42, s42, s76
buffer_load_dwordx4 v[84:87], v1, s[8:11], s42 offen sc1
buffer_load_dword v147, off, s[8:11], s31 sc1
buffer_load_dword v147, off, s[8:11], s31 sc1
buffer_load_dword v147, off, s[8:11], s31 sc1
buffer_load_dword v147, off, s[8:11], s31 sc1
buffer_load_dword v147, off, s[8:11], s31 sc1
buffer_load_dword v147, off, s[8:11], s31 sc1
buffer_load_dword v147, off, s[8:11], s31 sc1
buffer_load_dword v147, off, s[8:11], s31 sc1
Lo2_154:
s_add_u32 s94, s94, 1
s_add_u32 s68, s67, 32768
s_add_u32 s69, s67, 49152
s_add_u32 s63, s63, 81920
s_add_u32 s64, s64, 81920
s_add_u32 s60, s60, 229376
s_add_u32 s43, s71, 32768
s_or_b32 s43, s43, s29
buffer_load_dwordx4 a[32:35], v1, s[8:11], s43 offen offset:0 sc1
buffer_load_dwordx4 a[36:39], v1, s[8:11], s43 offen offset:1024 sc1
buffer_load_dwordx4 a[40:43], v1, s[8:11], s43 offen offset:2048 sc1
buffer_load_dwordx4 a[44:47], v1, s[8:11], s43 offen offset:3072 sc1
s_waitcnt vmcnt(17)
v_mfma_f32_16x16x32_bf16 v[16:19], v[64:67], v[104:107], v[16:19]
v_mfma_f32_16x16x32_bf16 v[20:23], v[64:67], v[124:127], v[20:23]
s_waitcnt vmcnt(16)
v_mfma_f32_16x16x32_bf16 v[24:27], v[68:71], v[104:107], v[24:27]
v_mfma_f32_16x16x32_bf16 v[28:31], v[68:71], v[124:127], v[28:31]
s_waitcnt vmcnt(15)
v_mfma_f32_16x16x32_bf16 v[32:35], v[72:75], v[104:107], v[32:35]
v_mfma_f32_16x16x32_bf16 v[36:39], v[72:75], v[124:127], v[36:39]
ds_write_b128 v4, v[16:19] offset:0
ds_write_b128 v4, v[20:23] offset:1024
s_waitcnt vmcnt(14)
v_mfma_f32_16x16x32_bf16 v[40:43], v[76:79], v[104:107], v[40:43]
v_mfma_f32_16x16x32_bf16 v[44:47], v[76:79], v[124:127], v[44:47]
ds_write_b128 v4, v[24:27] offset:2048
ds_write_b128 v4, v[28:31] offset:3072
s_waitcnt vmcnt(13)
v_mfma_f32_16x16x32_bf16 v[48:51], v[80:83], v[104:107], v[48:51]
v_mfma_f32_16x16x32_bf16 v[52:55], v[80:83], v[124:127], v[52:55]
ds_write_b128 v4, v[32:35] offset:4096
ds_write_b128 v4, v[36:39] offset:5120
s_waitcnt vmcnt(12)
v_mfma_f32_16x16x32_bf16 v[56:59], v[84:87], v[104:107], v[56:59]
v_mfma_f32_16x16x32_bf16 v[60:63], v[84:87], v[124:127], v[60:63]
ds_write_b128 v4, v[40:43] offset:6144
ds_write_b128 v4, v[44:47] offset:7168
buffer_load_dword v148, v2, s[8:11], s69 offen sc1
ds_write_b128 v4, v[48:51] offset:8192
ds_write_b128 v4, v[52:55] offset:9216
ds_write_b128 v4, v[56:59] offset:10240
s_nop 2
ds_write_b128 v4, v[60:63] offset:11264
s_waitcnt lgkmcnt(0)
s_barrier
ds_read_b128 v[16:19], v5 offset:0
ds_read_b128 v[20:23], v5 offset:2048
ds_read_b128 v[24:27], v5 offset:12288
ds_read_b128 v[28:31], v5 offset:14336
ds_read_b128 v[32:35], v5 offset:24576
ds_read_b128 v[36:39], v5 offset:26624
ds_read_b128 v[40:43], v5 offset:36864
ds_read_b128 v[44:47], v5 offset:38912
ds_read_b128 v[64:67], v7 offset:0
ds_read_b128 v[68:71], v7 offset:2048
ds_read_b128 v[72:75], v7 offset:12288
ds_read_b128 v[76:79], v7 offset:14336
ds_read_b128 v[80:83], v7 offset:24576
ds_read_b128 v[84:87], v7 offset:26624
ds_read_b128 v[88:91], v7 offset:36864
ds_read_b128 v[92:95], v7 offset:38912
s_waitcnt lgkmcnt(8)
v_pk_add_f32 v[16:17], v[16:17], v[24:25]
v_pk_add_f32 v[32:33], v[32:33], v[40:41]
v_pk_add_f32 v[18:19], v[18:19], v[26:27]
v_pk_add_f32 v[34:35], v[34:35], v[42:43]
v_pk_add_f32 v[20:21], v[20:21], v[28:29]
v_pk_add_f32 v[36:37], v[36:37], v[44:45]
v_pk_add_f32 v[22:23], v[22:23], v[30:31]
v_pk_add_f32 v[38:39], v[38:39], v[46:47]
v_pk_add_f32 v[16:17], v[16:17], v[32:33]
v_pk_add_f32 v[18:19], v[18:19], v[34:35]
v_pk_add_f32 v[20:21], v[20:21], v[36:37]
v_pk_add_f32 v[22:23], v[22:23], v[38:39]
v_lshlrev_b32 v8, 16, v136
v_and_b32 v9, 0xffff0000, v136
v_add_f32 v8, v8, v16
v_add_f32 v9, v9, v17
v_cvt_pk_bf16_f32 v24, v8, v9
v_lshlrev_b32 v8, 16, v137
v_and_b32 v9, 0xffff0000, v137
v_add_f32 v8, v8, v18
v_add_f32 v9, v9, v19
v_cvt_pk_bf16_f32 v25, v8, v9
v_lshlrev_b32 v8, 16, v138
v_and_b32 v9, 0xffff0000, v138
v_add_f32 v8, v8, v20
v_add_f32 v9, v9, v21
v_cvt_pk_bf16_f32 v26, v8, v9
v_lshlrev_b32 v8, 16, v139
v_and_b32 v9, 0xffff0000, v139
v_add_f32 v8, v8, v22
v_add_f32 v9, v9, v23
v_cvt_pk_bf16_f32 v27, v8, v9
v_min_u32 v24, -2, v24
v_min_u32 v25, -2, v25
v_min_u32 v26, -2, v26
v_min_u32 v27, -2, v27
buffer_store_dwordx4 v[24:27], v1, s[8:11], s61 offen sc1
v_lshlrev_b32 v8, 16, v24
v_and_b32 v9, 0xffff0000, v24
v_add_f32 v28, v8, v9
v_mul_f32 v29, v8, v8
v_fmac_f32 v29, v9, v9
v_lshlrev_b32 v8, 16, v25
v_and_b32 v9, 0xffff0000, v25
v_add_f32 v28, v28, v8
v_fmac_f32 v29, v8, v8
v_add_f32 v28, v28, v9
v_fmac_f32 v29, v9, v9
v_lshlrev_b32 v8, 16, v26
v_and_b32 v9, 0xffff0000, v26
v_add_f32 v28, v28, v8
v_fmac_f32 v29, v8, v8
v_add_f32 v28, v28, v9
v_fmac_f32 v29, v9, v9
v_lshlrev_b32 v8, 16, v27
v_and_b32 v9, 0xffff0000, v27
v_add_f32 v28, v28, v8
v_fmac_f32 v29, v8, v8
v_add_f32 v28, v28, v9
v_fmac_f32 v29, v9, v9
v_mov_b32 v8, v28
v_mov_b32 v9, v29
s_nop 0
v_permlane16_swap_b32 v28, v8
v_permlane16_swap_b32 v29, v9
v_add_f32 v28, v28, v8
v_add_f32 v29, v29, v9
v_mov_b32 v8, v28
v_mov_b32 v9, v29
s_nop 0
v_permlane32_swap_b32 v28, v8
v_permlane32_swap_b32 v29, v9
v_add_f32 v28, v28, v8
v_add_f32 v29, v29, v9
v_min_u32 v28, -2, v28
v_min_u32 v29, -2, v29
buffer_store_dwordx2 v[28:29], v6, s[8:11], s62 offen sc1
s_cmp_lg_u32 s78, 0
s_cbranch_scc1 Los_183
s_waitcnt lgkmcnt(0)
v_pk_add_f32 v[64:65], v[64:65], v[72:73]
v_pk_add_f32 v[80:81], v[80:81], v[88:89]
v_pk_add_f32 v[66:67], v[66:67], v[74:75]
v_pk_add_f32 v[82:83], v[82:83], v[90:91]
v_pk_add_f32 v[68:69], v[68:69], v[76:77]
v_pk_add_f32 v[84:85], v[84:85], v[92:93]
v_pk_add_f32 v[70:71], v[70:71], v[78:79]
v_pk_add_f32 v[86:87], v[86:87], v[94:95]
v_pk_add_f32 v[64:65], v[64:65], v[80:81]
v_pk_add_f32 v[66:67], v[66:67], v[82:83]
v_pk_add_f32 v[68:69], v[68:69], v[84:85]
v_pk_add_f32 v[70:71], v[70:71], v[86:87]
v_lshlrev_b32 v8, 16, v140
v_and_b32 v9, 0xffff0000, v140
v_add_f32 v8, v8, v64
v_add_f32 v9, v9, v65
v_cvt_pk_bf16_f32 v72, v8, v9
v_lshlrev_b32 v8, 16, v141
v_and_b32 v9, 0xffff0000, v141
v_add_f32 v8, v8, v66
v_add_f32 v9, v9, v67
v_cvt_pk_bf16_f32 v73, v8, v9
v_lshlrev_b32 v8, 16, v142
v_and_b32 v9, 0xffff0000, v142
v_add_f32 v8, v8, v68
v_add_f32 v9, v9, v69
v_cvt_pk_bf16_f32 v74, v8, v9
v_lshlrev_b32 v8, 16, v143
v_and_b32 v9, 0xffff0000, v143
v_add_f32 v8, v8, v70
v_add_f32 v9, v9, v71
v_cvt_pk_bf16_f32 v75, v8, v9
v_min_u32 v72, -2, v72
v_min_u32 v73, -2, v73
v_min_u32 v74, -2, v74
v_min_u32 v75, -2, v75
buffer_store_dwordx4 v[72:75], v1, s[8:11], s74 offen sc1
v_lshlrev_b32 v8, 16, v72
v_and_b32 v9, 0xffff0000, v72
v_add_f32 v76, v8, v9
v_mul_f32 v77, v8, v8
v_fmac_f32 v77, v9, v9
v_lshlrev_b32 v8, 16, v73
v_and_b32 v9, 0xffff0000, v73
v_add_f32 v76, v76, v8
v_fmac_f32 v77, v8, v8
v_add_f32 v76, v76, v9
v_fmac_f32 v77, v9, v9
v_lshlrev_b32 v8, 16, v74
v_and_b32 v9, 0xffff0000, v74
v_add_f32 v76, v76, v8
v_fmac_f32 v77, v8, v8
v_add_f32 v76, v76, v9
v_fmac_f32 v77, v9, v9
v_lshlrev_b32 v8, 16, v75
v_and_b32 v9, 0xffff0000, v75
v_add_f32 v76, v76, v8
v_fmac_f32 v77, v8, v8
v_add_f32 v76, v76, v9
v_fmac_f32 v77, v9, v9
v_mov_b32 v8, v76
v_mov_b32 v9, v77
s_nop 0
v_permlane16_swap_b32 v76, v8
v_permlane16_swap_b32 v77, v9
v_add_f32 v76, v76, v8
v_add_f32 v77, v77, v9
v_mov_b32 v8, v76
v_mov_b32 v9, v77
s_nop 0
v_permlane32_swap_b32 v76, v8
v_permlane32_swap_b32 v77, v9
v_add_f32 v76, v76, v8
v_add_f32 v77, v77, v9
v_min_u32 v76, -2, v76
v_min_u32 v77, -2, v77
buffer_store_dwordx2 v[76:77], v6, s[8:11], s75 offen sc1
Los_183:
s_add_u32 s62, s62, 8192
s_add_u32 s75, s75, 8192
s_waitcnt lgkmcnt(0)
s_barrier
s_add_u32 s43, s71, 49152
s_or_b32 s43, s43, s29
buffer_load_dwordx4 a[48:51], v1, s[8:11], s43 offen offset:0 sc1
buffer_load_dwordx4 a[52:55], v1, s[8:11], s43 offen offset:1024 sc1
buffer_load_dwordx4 a[56:59], v1, s[8:11], s43 offen offset:2048 sc1
buffer_load_dwordx4 a[60:63], v1, s[8:11], s43 offen offset:3072 sc1
s_add_u32 s43, s71, 65536
s_or_b32 s43, s43, s29
s_or_b32 s43, s43, s76
buffer_load_dwordx4 a[64:67], v1, s[8:11], s43 offen offset:0 sc1
buffer_load_dwordx4 a[68:71], v1, s[8:11], s43 offen offset:1024 sc1
buffer_load_dwordx4 a[72:75], v1, s[8:11], s43 offen offset:2048 sc1
buffer_load_dwordx4 a[76:79], v1, s[8:11], s43 offen offset:3072 sc1
s_add_u32 s43, s71, 81920
s_or_b32 s43, s43, s29
s_or_b32 s43, s43, s76
buffer_load_dwordx4 a[80:83], v1, s[8:11], s43 offen offset:0 sc1
buffer_load_dwordx4 a[84:87], v1, s[8:11], s43 offen offset:1024 sc1
buffer_load_dwordx4 a[88:91], v1, s[8:11], s43 offen offset:2048 sc1
buffer_load_dwordx4 a[92:95], v1, s[8:11], s43 offen offset:3072 sc1
s_or_b32 s43, s72, s29
buffer_load_dwordx4 v[128:131], v1, s[8:11], s43 offen sc1
s_or_b32 s43, s73, s29
s_or_b32 s43, s43, s78
buffer_load_dwordx4 v[132:135], v1, s[8:11], s43 offen sc1
s_cmp_lg_u32 s70, 0
s_cbranch_scc1 Lyb_184
s_add_u32 s43, s71, 0
s_or_b32 s43, s43, s29
buffer_load_dwordx4 a[0:3], v1, s[8:11], s43 offen offset:0 sc1
buffer_load_dwordx4 a[4:7], v1, s[8:11], s43 offen offset:1024 sc1
buffer_load_dwordx4 a[8:11], v1, s[8:11], s43 offen offset:2048 sc1
buffer_load_dwordx4 a[12:15], v1, s[8:11], s43 offen offset:3072 sc1
s_add_u32 s43, s71, 16384
s_or_b32 s43, s43, s29
buffer_load_dwordx4 a[16:19], v1, s[8:11], s43 offen offset:0 sc1
buffer_load_dwordx4 a[20:23], v1, s[8:11], s43 offen offset:1024 sc1
buffer_load_dwordx4 a[24:27], v1, s[8:11], s43 offen offset:2048 sc1
buffer_load_dwordx4 a[28:31], v1, s[8:11], s43 offen offset:3072 sc1
Lyb_184:
s_waitcnt vmcnt(16)
v_cmp_ne_u32 vcc, 1, v148
s_nop 0
s_cmp_eq_u64 vcc, 0
s_cselect_b32 s27, 1, 0
s_cselect_b32 s44, 8, 24
v_add_u32 v148, s44, v0
v_mov_b32 v149, s94
ds_write_b32 v148, v149
s_cmp_eq_u32 s66, 0
s_cbranch_scc1 L_done
s_branch LO_loop0
L_roleF:
v_mbcnt_lo_u32_b32 v0, -1, 0
v_mbcnt_hi_u32_b32 v0, -1, v0
v_lshlrev_b32 v1, 4, v0
s_mov_b32 s92, 0x1000000
s_mov_b32 s97, 0
s_mov_b32 s98, 0
s_mov_b32 s95, 0
v_min_u32 v12, 63, v0
v_lshlrev_b32 v12, 7, v12
s_mov_b32 s46, 118571008
s_add_u32 s47, s46, 0
buffer_load_dword v8, v12, s[8:11], s47 offen sc1
s_add_u32 s47, s46, 8192
buffer_load_dword v9, v12, s[8:11], s47 offen sc1
s_add_u32 s47, s46, 16384
buffer_load_dword v10, v12, s[8:11], s47 offen sc1
s_add_u32 s47, s46, 24576
buffer_load_dword v11, v12, s[8:11], s47 offen sc1
s_branch Lwg_186
Lwf_185:
s_sleep 12
s_add_u32 s47, s46, 0
buffer_load_dword v8, v12, s[8:11], s47 offen sc1
s_add_u32 s47, s46, 8192
buffer_load_dword v9, v12, s[8:11], s47 offen sc1
s_add_u32 s47, s46, 16384
buffer_load_dword v10, v12, s[8:11], s47 offen sc1
s_add_u32 s47, s46, 24576
buffer_load_dword v11, v12, s[8:11], s47 offen sc1
s_sub_u32 s36, s36, 1
s_cbranch_scc1 L_timeout_14
Lwg_186:
s_waitcnt vmcnt(0)
v_and_b32 v8, v8, v9
v_and_b32 v8, v8, v10
v_and_b32 v8, v8, v11
v_cmp_ne_u32 vcc, 1, v8
s_nop 0
s_cbranch_vccnz Lwf_185
s_and_b32 s38, s33, 1
s_mov_b32 s37, 0
s_load_dwordx4 s[44:47], s[0:1], 64
s_load_dwordx4 s[48:51], s[0:1], 80
s_waitcnt lgkmcnt(0)
s_cmp_lg_u32 s35, 0
s_cselect_b32 s66, 0, 2146435072
s_cselect_b32 s67, 2146435072, 0
s_mov_b32 s16, s44
s_mov_b32 s17, s45
s_mov_b32 s18, 1605632
s_mov_b32 s19, 0x20000
s_mov_b32 s20, s46
s_mov_b32 s21, s47
s_mov_b32 s22, 1605632
s_mov_b32 s23, 0x20000
s_mov_b32 s24, s48
s_mov_b32 s25, s49
s_mov_b32 s26, 1605632
s_mov_b32 s27, 0x20000
s_mov_b32 s28, s50
s_mov_b32 s29, s51
s_mov_b32 s30, 1835008
s_mov_b32 s31, 0x20000
s_cmp_ge_u32 s34, 14
s_cbranch_scc1 L_roleF2
v_min_u32 v2, 27, v0
v_lshlrev_b32 v2, 7, v2
v_lshrrev_b32 v6, 2, v0
v_mul_u32_u24 v4, 3584, v6
v_and_b32 v7, 3, v0
v_lshl_add_u32 v4, v7, 4, v4
s_lshl2_add_u32 s44, s34, s32
s_lshl_b32 s45, s44, 6
s_mul_i32 s46, s32, 28672
v_lshrrev_b32 v6, 4, v0
v_bfe_u32 v8, v0, 2, 2
v_lshl_add_u32 v6, v6, 3, v8
v_lshlrev_b32 v5, 6, v6
v_lshl_add_u32 v5, v7, 4, v5
v_add_u32 v5, s46, v5
s_add_u32 s40, s45, 0
s_add_u32 m0, s46, 0
s_nop 0
buffer_load_dwordx4 v4, s[16:19], s40 offen lds
s_add_u32 s40, s45, 57344
s_add_u32 m0, s46, 1024
s_nop 0
buffer_load_dwordx4 v4, s[16:19], s40 offen lds
s_add_u32 s40, s45, 114688
s_add_u32 m0, s46, 2048
s_nop 0
buffer_load_dwordx4 v4, s[16:19], s40 offen lds
s_add_u32 s40, s45, 172032
s_add_u32 m0, s46, 3072
s_nop 0
buffer_load_dwordx4 v4, s[16:19], s40 offen lds
s_add_u32 s40, s45, 229376
s_add_u32 m0, s46, 4096
s_nop 0
buffer_load_dwordx4 v4, s[16:19], s40 offen lds
s_add_u32 s40, s45, 286720
s_add_u32 m0, s46, 5120
s_nop 0
buffer_load_dwordx4 v4, s[16:19], s40 offen lds
s_add_u32 s40, s45, 344064
s_add_u32 m0, s46, 6144
s_nop 0
buffer_load_dwordx4 v4, s[16:19], s40 offen lds
s_add_u32 s40, s45, 401408
s_add_u32 m0, s46, 7168
s_nop 0
buffer_load_dwordx4 v4, s[16:19], s40 offen lds
s_add_u32 s40, s45, 458752
s_add_u32 m0, s46, 8192
s_nop 0
buffer_load_dwordx4 v4, s[16:19], s40 offen lds
s_add_u32 s40, s45, 516096
s_add_u32 m0, s46, 9216
s_nop 0
buffer_load_dwordx4 v4, s[16:19], s40 offen lds
s_add_u32 s40, s45, 573440
s_add_u32 m0, s46, 10240
s_nop 0
buffer_load_dwordx4 v4, s[16:19], s40 offen lds
s_add_u32 s40, s45, 630784
s_add_u32 m0, s46, 11264
s_nop 0
buffer_load_dwordx4 v4, s[16:19], s40 offen lds
s_add_u32 s40, s45, 688128
s_add_u32 m0, s46, 12288
s_nop 0
buffer_load_dwordx4 v4, s[16:19], s40 offen lds
s_add_u32 s40, s45, 745472
s_add_u32 m0, s46, 13312
s_nop 0
buffer_load_dwordx4 v4, s[16:19], s40 offen lds
s_add_u32 s40, s45, 802816
s_add_u32 m0, s46, 14336
s_nop 0
buffer_load_dwordx4 v4, s[16:19], s40 offen lds
s_add_u32 s40, s45, 860160
s_add_u32 m0, s46, 15360
s_nop 0
buffer_load_dwordx4 v4, s[16:19], s40 offen lds
s_add_u32 s40, s45, 917504
s_add_u32 m0, s46, 16384
s_nop 0
buffer_load_dwordx4 v4, s[16:19], s40 offen lds
s_add_u32 s40, s45, 974848
s_add_u32 m0, s46, 17408
s_nop 0
buffer_load_dwordx4 v4, s[16:19], s40 offen lds
s_add_u32 s40, s45, 1032192
s_add_u32 m0, s46, 18432
s_nop 0
buffer_load_dwordx4 v4, s[16:19], s40 offen lds
s_add_u32 s40, s45, 1089536
s_add_u32 m0, s46, 19456
s_nop 0
buffer_load_dwordx4 v4, s[16:19], s40 offen lds
s_add_u32 s40, s45, 1146880
s_add_u32 m0, s46, 20480
s_nop 0
buffer_load_dwordx4 v4, s[16:19], s40 offen lds
s_add_u32 s40, s45, 1204224
s_add_u32 m0, s46, 21504
s_nop 0
buffer_load_dwordx4 v4, s[16:19], s40 offen lds
s_add_u32 s40, s45, 1261568
s_add_u32 m0, s46, 22528
s_nop 0
buffer_load_dwordx4 v4, s[16:19], s40 offen lds
s_add_u32 s40, s45, 1318912
s_add_u32 m0, s46, 23552
s_nop 0
buffer_load_dwordx4 v4, s[16:19], s40 offen lds
s_add_u32 s40, s45, 1376256
s_add_u32 m0, s46, 24576
s_nop 0
buffer_load_dwordx4 v4, s[16:19], s40 offen lds
s_add_u32 s40, s45, 1433600
s_add_u32 m0, s46, 25600
s_nop 0
buffer_load_dwordx4 v4, s[16:19], s40 offen lds
s_add_u32 s40, s45, 1490944
s_add_u32 m0, s46, 26624
s_nop 0
buffer_load_dwordx4 v4, s[16:19], s40 offen lds
s_add_u32 s40, s45, 1548288
s_add_u32 m0, s46, 27648
s_nop 0
buffer_load_dwordx4 v4, s[16:19], s40 offen lds
s_waitcnt vmcnt(0)
ds_read_b64_tr_b16 a[0:1], v5 offset:0
ds_read_b64_tr_b16 a[2:3], v5 offset:256
ds_read_b64_tr_b16 a[4:5], v5 offset:2048
ds_read_b64_tr_b16 a[6:7], v5 offset:2304
ds_read_b64_tr_b16 a[8:9], v5 offset:4096
ds_read_b64_tr_b16 a[10:11], v5 offset:4352
ds_read_b64_tr_b16 a[12:13], v5 offset:6144
ds_read_b64_tr_b16 a[14:15], v5 offset:6400
ds_read_b64_tr_b16 a[16:17], v5 offset:8192
ds_read_b64_tr_b16 a[18:19], v5 offset:8448
ds_read_b64_tr_b16 a[20:21], v5 offset:10240
ds_read_b64_tr_b16 a[22:23], v5 offset:10496
ds_read_b64_tr_b16 a[24:25], v5 offset:12288
ds_read_b64_tr_b16 a[26:27], v5 offset:12544
ds_read_b64_tr_b16 a[28:29], v5 offset:14336
ds_read_b64_tr_b16 a[30:31], v5 offset:14592
ds_read_b64_tr_b16 a[32:33], v5 offset:16384
ds_read_b64_tr_b16 a[34:35], v5 offset:16640
ds_read_b64_tr_b16 a[36:37], v5 offset:18432
ds_read_b64_tr_b16 a[38:39], v5 offset:18688
ds_read_b64_tr_b16 a[40:41], v5 offset:20480
ds_read_b64_tr_b16 a[42:43], v5 offset:20736
ds_read_b64_tr_b16 a[44:45], v5 offset:22528
ds_read_b64_tr_b16 a[46:47], v5 offset:22784
ds_read_b64_tr_b16 a[48:49], v5 offset:24576
ds_read_b64_tr_b16 a[50:51], v5 offset:24832
ds_read_b64_tr_b16 a[52:53], v5 offset:26624
ds_read_b64_tr_b16 a[54:55], v5 offset:26880
ds_read_b64_tr_b16 a[56:57], v5 offset:8
ds_read_b64_tr_b16 a[58:59], v5 offset:264
ds_read_b64_tr_b16 a[60:61], v5 offset:2056
ds_read_b64_tr_b16 a[62:63], v5 offset:2312
ds_read_b64_tr_b16 a[64:65], v5 offset:4104
ds_read_b64_tr_b16 a[66:67], v5 offset:4360
ds_read_b64_tr_b16 a[68:69], v5 offset:6152
ds_read_b64_tr_b16 a[70:71], v5 offset:6408
ds_read_b64_tr_b16 a[72:73], v5 offset:8200
ds_read_b64_tr_b16 a[74:75], v5 offset:8456
ds_read_b64_tr_b16 a[76:77], v5 offset:10248
ds_read_b64_tr_b16 a[78:79], v5 offset:10504
ds_read_b64_tr_b16 a[80:81], v5 offset:12296
ds_read_b64_tr_b16 a[82:83], v5 offset:12552
ds_read_b64_tr_b16 a[84:85], v5 offset:14344
ds_read_b64_tr_b16 a[86:87], v5 offset:14600
ds_read_b64_tr_b16 a[88:89], v5 offset:16392
ds_read_b64_tr_b16 a[90:91], v5 offset:16648
ds_read_b64_tr_b16 a[92:93], v5 offset:18440
ds_read_b64_tr_b16 a[94:95], v5 offset:18696
ds_read_b64_tr_b16 a[96:97], v5 offset:20488
ds_read_b64_tr_b16 a[98:99], v5 offset:20744
ds_read_b64_tr_b16 a[100:101], v5 offset:22536
ds_read_b64_tr_b16 a[102:103], v5 offset:22792
ds_read_b64_tr_b16 a[104:105], v5 offset:24584
ds_read_b64_tr_b16 a[106:107], v5 offset:24840
ds_read_b64_tr_b16 a[108:109], v5 offset:26632
ds_read_b64_tr_b16 a[110:111], v5 offset:26888
s_waitcnt lgkmcnt(0)
s_add_u32 s40, s45, 0
s_add_u32 m0, s46, 0
s_nop 0
buffer_load_dwordx4 v4, s[20:23], s40 offen lds
s_add_u32 s40, s45, 57344
s_add_u32 m0, s46, 1024
s_nop 0
buffer_load_dwordx4 v4, s[20:23], s40 offen lds
s_add_u32 s40, s45, 114688
s_add_u32 m0, s46, 2048
s_nop 0
buffer_load_dwordx4 v4, s[20:23], s40 offen lds
s_add_u32 s40, s45, 172032
s_add_u32 m0, s46, 3072
s_nop 0
buffer_load_dwordx4 v4, s[20:23], s40 offen lds
s_add_u32 s40, s45, 229376
s_add_u32 m0, s46, 4096
s_nop 0
buffer_load_dwordx4 v4, s[20:23], s40 offen lds
s_add_u32 s40, s45, 286720
s_add_u32 m0, s46, 5120
s_nop 0
buffer_load_dwordx4 v4, s[20:23], s40 offen lds
s_add_u32 s40, s45, 344064
s_add_u32 m0, s46, 6144
s_nop 0
buffer_load_dwordx4 v4, s[20:23], s40 offen lds
s_add_u32 s40, s45, 401408
s_add_u32 m0, s46, 7168
s_nop 0
buffer_load_dwordx4 v4, s[20:23], s40 offen lds
s_add_u32 s40, s45, 458752
s_add_u32 m0, s46, 8192
s_nop 0
buffer_load_dwordx4 v4, s[20:23], s40 offen lds
s_add_u32 s40, s45, 516096
s_add_u32 m0, s46, 9216
s_nop 0
buffer_load_dwordx4 v4, s[20:23], s40 offen lds
s_add_u32 s40, s45, 573440
s_add_u32 m0, s46, 10240
s_nop 0
buffer_load_dwordx4 v4, s[20:23], s40 offen lds
s_add_u32 s40, s45, 630784
s_add_u32 m0, s46, 11264
s_nop 0
buffer_load_dwordx4 v4, s[20:23], s40 offen lds
s_add_u32 s40, s45, 688128
s_add_u32 m0, s46, 12288
s_nop 0
buffer_load_dwordx4 v4, s[20:23], s40 offen lds
s_add_u32 s40, s45, 745472
s_add_u32 m0, s46, 13312
s_nop 0
buffer_load_dwordx4 v4, s[20:23], s40 offen lds
s_add_u32 s40, s45, 802816
s_add_u32 m0, s46, 14336
s_nop 0
buffer_load_dwordx4 v4, s[20:23], s40 offen lds
s_add_u32 s40, s45, 860160
s_add_u32 m0, s46, 15360
s_nop 0
buffer_load_dwordx4 v4, s[20:23], s40 offen lds
s_add_u32 s40, s45, 917504
s_add_u32 m0, s46, 16384
s_nop 0
buffer_load_dwordx4 v4, s[20:23], s40 offen lds
s_add_u32 s40, s45, 974848
s_add_u32 m0, s46, 17408
s_nop 0
buffer_load_dwordx4 v4, s[20:23], s40 offen lds
s_add_u32 s40, s45, 1032192
s_add_u32 m0, s46, 18432
s_nop 0
buffer_load_dwordx4 v4, s[20:23], s40 offen lds
s_add_u32 s40, s45, 1089536
s_add_u32 m0, s46, 19456
s_nop 0
buffer_load_dwordx4 v4, s[20:23], s40 offen lds
s_add_u32 s40, s45, 1146880
s_add_u32 m0, s46, 20480
s_nop 0
buffer_load_dwordx4 v4, s[20:23], s40 offen lds
s_add_u32 s40, s45, 1204224
s_add_u32 m0, s46, 21504
s_nop 0
buffer_load_dwordx4 v4, s[20:23], s40 offen lds
s_add_u32 s40, s45, 1261568
s_add_u32 m0, s46, 22528
s_nop 0
buffer_load_dwordx4 v4, s[20:23], s40 offen lds
s_add_u32 s40, s45, 1318912
s_add_u32 m0, s46, 23552
s_nop 0
buffer_load_dwordx4 v4, s[20:23], s40 offen lds
s_add_u32 s40, s45, 1376256
s_add_u32 m0, s46, 24576
s_nop 0
buffer_load_dwordx4 v4, s[20:23], s40 offen lds
s_add_u32 s40, s45, 1433600
s_add_u32 m0, s46, 25600
s_nop 0
buffer_load_dwordx4 v4, s[20:23], s40 offen lds
s_add_u32 s40, s45, 1490944
s_add_u32 m0, s46, 26624
s_nop 0
buffer_load_dwordx4 v4, s[20:23], s40 offen lds
s_add_u32 s40, s45, 1548288
s_add_u32 m0, s46, 27648
s_nop 0
buffer_load_dwordx4 v4, s[20:23], s40 offen lds
s_waitcnt vmcnt(0)
ds_read_b64_tr_b16 a[112:113], v5 offset:0
ds_read_b64_tr_b16 a[114:115], v5 offset:256
ds_read_b64_tr_b16 a[116:117], v5 offset:2048
ds_read_b64_tr_b16 a[118:119], v5 offset:2304
ds_read_b64_tr_b16 a[120:121], v5 offset:4096
ds_read_b64_tr_b16 a[122:123], v5 offset:4352
ds_read_b64_tr_b16 a[124:125], v5 offset:6144
ds_read_b64_tr_b16 a[126:127], v5 offset:6400
ds_read_b64_tr_b16 a[128:129], v5 offset:8192
ds_read_b64_tr_b16 a[130:131], v5 offset:8448
ds_read_b64_tr_b16 a[132:133], v5 offset:10240
ds_read_b64_tr_b16 a[134:135], v5 offset:10496
ds_read_b64_tr_b16 a[136:137], v5 offset:12288
ds_read_b64_tr_b16 a[138:139], v5 offset:12544
ds_read_b64_tr_b16 a[140:141], v5 offset:14336
ds_read_b64_tr_b16 a[142:143], v5 offset:14592
ds_read_b64_tr_b16 a[144:145], v5 offset:16384
ds_read_b64_tr_b16 a[146:147], v5 offset:16640
ds_read_b64_tr_b16 a[148:149], v5 offset:18432
ds_read_b64_tr_b16 a[150:151], v5 offset:18688
ds_read_b64_tr_b16 a[152:153], v5 offset:20480
ds_read_b64_tr_b16 a[154:155], v5 offset:20736
ds_read_b64_tr_b16 a[156:157], v5 offset:22528
ds_read_b64_tr_b16 a[158:159], v5 offset:22784
ds_read_b64_tr_b16 a[160:161], v5 offset:24576
ds_read_b64_tr_b16 a[162:163], v5 offset:24832
ds_read_b64_tr_b16 a[164:165], v5 offset:26624
ds_read_b64_tr_b16 a[166:167], v5 offset:26880
ds_read_b64_tr_b16 a[168:169], v5 offset:8
ds_read_b64_tr_b16 a[170:171], v5 offset:264
ds_read_b64_tr_b16 a[172:173], v5 offset:2056
ds_read_b64_tr_b16 a[174:175], v5 offset:2312
ds_read_b64_tr_b16 a[176:177], v5 offset:4104
ds_read_b64_tr_b16 a[178:179], v5 offset:4360
ds_read_b64_tr_b16 a[180:181], v5 offset:6152
ds_read_b64_tr_b16 a[182:183], v5 offset:6408
ds_read_b64_tr_b16 a[184:185], v5 offset:8200
ds_read_b64_tr_b16 a[186:187], v5 offset:8456
ds_read_b64_tr_b16 a[188:189], v5 offset:10248
ds_read_b64_tr_b16 a[190:191], v5 offset:10504
ds_read_b64_tr_b16 a[192:193], v5 offset:12296
ds_read_b64_tr_b16 a[194:195], v5 offset:12552
ds_read_b64_tr_b16 a[196:197], v5 offset:14344
ds_read_b64_tr_b16 a[198:199], v5 offset:14600
ds_read_b64_tr_b16 a[200:201], v5 offset:16392
ds_read_b64_tr_b16 a[202:203], v5 offset:16648
ds_read_b64_tr_b16 a[204:205], v5 offset:18440
ds_read_b64_tr_b16 a[206:207], v5 offset:18696
ds_read_b64_tr_b16 a[208:209], v5 offset:20488
ds_read_b64_tr_b16 a[210:211], v5 offset:20744
ds_read_b64_tr_b16 a[212:213], v5 offset:22536
ds_read_b64_tr_b16 a[214:215], v5 offset:22792
ds_read_b64_tr_b16 a[216:217], v5 offset:24584
ds_read_b64_tr_b16 a[218:219], v5 offset:24840
ds_read_b64_tr_b16 a[220:221], v5 offset:26632
ds_read_b64_tr_b16 a[222:223], v5 offset:26888
s_waitcnt lgkmcnt(0)
v_mov_b32 v48, 0x3f803f80
v_mov_b32 v49, 0x3f803f80
v_mov_b32 v50, 0x3f803f80
v_mov_b32 v51, 0x3f803f80
s_nop 1
v_mfma_f32_16x16x32_bf16 v[88:91], a[0:3], v[48:51], 0
v_mfma_f32_16x16x32_bf16 v[92:95], a[56:59], v[48:51], 0
v_mfma_f32_16x16x32_bf16 v[96:99], a[112:115], v[48:51], 0
v_mfma_f32_16x16x32_bf16 v[100:103], a[168:171], v[48:51], 0
v_mfma_f32_16x16x32_bf16 v[88:91], a[4:7], v[48:51], v[88:91]
v_mfma_f32_16x16x32_bf16 v[92:95], a[60:63], v[48:51], v[92:95]
v_mfma_f32_16x16x32_bf16 v[96:99], a[116:119], v[48:51], v[96:99]
v_mfma_f32_16x16x32_bf16 v[100:103], a[172:175], v[48:51], v[100:103]
v_mfma_f32_16x16x32_bf16 v[88:91], a[8:11], v[48:51], v[88:91]
v_mfma_f32_16x16x32_bf16 v[92:95], a[64:67], v[48:51], v[92:95]
v_mfma_f32_16x16x32_bf16 v[96:99], a[120:123], v[48:51], v[96:99]
v_mfma_f32_16x16x32_bf16 v[100:103], a[176:179], v[48:51], v[100:103]
v_mfma_f32_16x16x32_bf16 v[88:91], a[12:15], v[48:51], v[88:91]
v_mfma_f32_16x16x32_bf16 v[92:95], a[68:71], v[48:51], v[92:95]
v_mfma_f32_16x16x32_bf16 v[96:99], a[124:127], v[48:51], v[96:99]
v_mfma_f32_16x16x32_bf16 v[100:103], a[180:183], v[48:51], v[100:103]
v_mfma_f32_16x16x32_bf16 v[88:91], a[16:19], v[48:51], v[88:91]
v_mfma_f32_16x16x32_bf16 v[92:95], a[72:75], v[48:51], v[92:95]
v_mfma_f32_16x16x32_bf16 v[96:99], a[128:131], v[48:51], v[96:99]
v_mfma_f32_16x16x32_bf16 v[100:103], a[184:187], v[48:51], v[100:103]
v_mfma_f32_16x16x32_bf16 v[88:91], a[20:23], v[48:51], v[88:91]
v_mfma_f32_16x16x32_bf16 v[92:95], a[76:79], v[48:51], v[92:95]
v_mfma_f32_16x16x32_bf16 v[96:99], a[132:135], v[48:51], v[96:99]
v_mfma_f32_16x16x32_bf16 v[100:103], a[188:191], v[48:51], v[100:103]
v_mfma_f32_16x16x32_bf16 v[88:91], a[24:27], v[48:51], v[88:91]
v_mfma_f32_16x16x32_bf16 v[92:95], a[80:83], v[48:51], v[92:95]
v_mfma_f32_16x16x32_bf16 v[96:99], a[136:139], v[48:51], v[96:99]
v_mfma_f32_16x16x32_bf16 v[100:103], a[192:195], v[48:51], v[100:103]
v_mfma_f32_16x16x32_bf16 v[88:91], a[28:31], v[48:51], v[88:91]
v_mfma_f32_16x16x32_bf16 v[92:95], a[84:87], v[48:51], v[92:95]
v_mfma_f32_16x16x32_bf16 v[96:99], a[140:143], v[48:51], v[96:99]
v_mfma_f32_16x16x32_bf16 v[100:103], a[196:199], v[48:51], v[100:103]
v_mfma_f32_16x16x32_bf16 v[88:91], a[32:35], v[48:51], v[88:91]
v_mfma_f32_16x16x32_bf16 v[92:95], a[88:91], v[48:51], v[92:95]
v_mfma_f32_16x16x32_bf16 v[96:99], a[144:147], v[48:51], v[96:99]
v_mfma_f32_16x16x32_bf16 v[100:103], a[200:203], v[48:51], v[100:103]
v_mfma_f32_16x16x32_bf16 v[88:91], a[36:39], v[48:51], v[88:91]
v_mfma_f32_16x16x32_bf16 v[92:95], a[92:95], v[48:51], v[92:95]
v_mfma_f32_16x16x32_bf16 v[96:99], a[148:151], v[48:51], v[96:99]
v_mfma_f32_16x16x32_bf16 v[100:103], a[204:207], v[48:51], v[100:103]
v_mfma_f32_16x16x32_bf16 v[88:91], a[40:43], v[48:51], v[88:91]
v_mfma_f32_16x16x32_bf16 v[92:95], a[96:99], v[48:51], v[92:95]
v_mfma_f32_16x16x32_bf16 v[96:99], a[152:155], v[48:51], v[96:99]
v_mfma_f32_16x16x32_bf16 v[100:103], a[208:211], v[48:51], v[100:103]
v_mfma_f32_16x16x32_bf16 v[88:91], a[44:47], v[48:51], v[88:91]
v_mfma_f32_16x16x32_bf16 v[92:95], a[100:103], v[48:51], v[92:95]
v_mfma_f32_16x16x32_bf16 v[96:99], a[156:159], v[48:51], v[96:99]
v_mfma_f32_16x16x32_bf16 v[100:103], a[212:215], v[48:51], v[100:103]
v_mfma_f32_16x16x32_bf16 v[88:91], a[48:51], v[48:51], v[88:91]
v_mfma_f32_16x16x32_bf16 v[92:95], a[104:107], v[48:51], v[92:95]
v_mfma_f32_16x16x32_bf16 v[96:99], a[160:163], v[48:51], v[96:99]
v_mfma_f32_16x16x32_bf16 v[100:103], a[216:219], v[48:51], v[100:103]
v_mfma_f32_16x16x32_bf16 v[88:91], a[52:55], v[48:51], v[88:91]
v_mfma_f32_16x16x32_bf16 v[92:95], a[108:111], v[48:51], v[92:95]
v_mfma_f32_16x16x32_bf16 v[96:99], a[164:167], v[48:51], v[96:99]
v_mfma_f32_16x16x32_bf16 v[100:103], a[220:223], v[48:51], v[100:103]
s_mul_i32 s59, s38, 3670016
s_add_u32 s59, s59, 14680064
s_mul_i32 s60, s38, 524288
s_add_u32 s60, s60, 118865920
s_mul_i32 s61, s38, 7340032
s_add_u32 s61, s61, 102498304
s_lshl_b32 s40, s44, 10
s_add_u32 s69, s61, s40
v_min_u32 v7, 13, v0
v_lshlrev_b32 v7, 7, v7
v_min_u32 v8, 9, v0
v_lshlrev_b32 v8, 7, v8
s_lshl_b32 s40, s38, 13
s_add_u32 s40, s40, 118489088
Lwa_187:
buffer_load_dword v9, v8, s[8:11], s40 offen sc1
s_sub_u32 s36, s36, 1
s_cbranch_scc1 L_timeout_22
s_sleep 8
s_waitcnt vmcnt(0)
v_cmp_ne_u32 vcc, 1, v9
s_nop 0
s_cbranch_vccnz Lwa_187
s_mov_b32 s62, 2
s_mov_b32 s63, 0
s_lshl_b32 s68, s38, 13
s_add_u32 s68, s68, 118521856
s_add_u32 s73, s68, -16384
s_lshl_b32 s40, s34, 7
s_add_u32 s73, s73, s40
v_mov_b32 v0, 126464
v_mov_b32 v8, 0
v_mov_b32 v9, 0
v_mov_b32 v10, 0
v_mov_b32 v11, 0
ds_write_b128 v0, v[8:11]
ds_write_b128 v0, v[8:11] offset:16
s_mov_b32 s96, 126464
s_mov_b32 s94, 1
s_mov_b32 s93, 3
v_mov_b32 v15, 1
s_waitcnt lgkmcnt(0)
s_barrier
v_lshrrev_b32 v8, 8, v1
v_mul_u32_u24 v6, 896, v8
v_bfe_u32 v8, v1, 4, 4
v_lshl_add_u32 v6, v8, 3, v6
v_add_u32 v6, 28672, v6
s_mov_b32 s70, -7
s_mov_b32 s71, 0
LF1_loop:
s_cmp_eq_u32 s97, 0
s_cbranch_scc1 Lxb_189
s_waitcnt vmcnt(4)
Lxt_188:
Lxv_191:
s_xor_b32 s95, s95, 32768
v_add_u32 v3, s95, v1
v_xor_b32 v6, 32768, v6
s_barrier
ds_read_b128 v[48:51], v3 offset:0
ds_read_b128 v[52:55], v3 offset:1024
ds_read2_b64 v[64:67], v6 offset0:0 offset1:16
ds_read2_b64 v[68:71], v6 offset0:32 offset1:48
ds_read2_b64 v[72:75], v6 offset0:64 offset1:80
ds_read2_b64 v[76:79], v6 offset0:96 offset1:112
s_waitcnt lgkmcnt(5)
v_mfma_f32_16x16x32_bf16 v[16:19], a[0:3], v[48:51], 0
ds_read_b128 v[56:59], v3 offset:2048
v_mfma_f32_16x16x32_bf16 v[24:27], a[56:59], v[48:51], 0
s_add_u32 s94, s94, 1
s_mov_b32 s37, s63
s_add_u32 s63, s63, 1
v_mfma_f32_16x16x32_bf16 v[32:35], a[112:115], v[48:51], 0
s_cmp_lg_u32 s98, 0
s_cselect_b32 s53, s96, 126484
s_cselect_b32 s99, s99, 2146435072
v_mfma_f32_16x16x32_bf16 v[40:43], a[168:171], v[48:51], 0
s_mov_b32 s98, 0
s_add_u32 s59, s59, 28672
s_waitcnt lgkmcnt(5)
v_mfma_f32_16x16x32_bf16 v[16:19], a[4:7], v[52:55], v[16:19]
ds_read_b128 v[48:51], v3 offset:3072
v_mfma_f32_16x16x32_bf16 v[24:27], a[60:63], v[52:55], v[24:27]
s_xor_b32 s49, s95, 32768
s_mul_i32 s50, s32, 7168
s_add_u32 s48, s49, s50
v_mfma_f32_16x16x32_bf16 v[32:35], a[116:119], v[52:55], v[32:35]
s_lshl_b32 s51, s32, 10
s_add_u32 s49, s49, s51
s_add_u32 s49, s49, 28672
v_mfma_f32_16x16x32_bf16 v[40:43], a[172:175], v[52:55], v[40:43]
buffer_load_dword v125, v7, s[8:11], s68 offen sc1
s_waitcnt lgkmcnt(2)
s_waitcnt lgkmcnt(1)
v_mfma_f32_16x16x32_bf16 v[16:19], a[8:11], v[56:59], v[16:19]
ds_read_b128 v[52:55], v3 offset:4096
v_mfma_f32_16x16x32_bf16 v[24:27], a[64:67], v[56:59], v[24:27]
s_add_u32 s60, s60, 4096
v_mov_b32 v13, s53
v_add_f32 v64, v64, v66
v_mfma_f32_16x16x32_bf16 v[32:35], a[120:123], v[56:59], v[32:35]
s_waitcnt vmcnt(1)
s_mov_b64 exec, 1
ds_add_rtn_u32 v13, v13, v15
s_mov_b64 exec, -1
v_mfma_f32_16x16x32_bf16 v[40:43], a[176:179], v[56:59], v[40:43]
v_add_f32 v68, v68, v70
v_add_f32 v72, v72, v74
s_waitcnt lgkmcnt(2)
v_mfma_f32_16x16x32_bf16 v[16:19], a[12:15], v[48:51], v[16:19]
ds_read_b128 v[56:59], v3 offset:5120
v_mfma_f32_16x16x32_bf16 v[24:27], a[68:71], v[48:51], v[24:27]
s_cmp_lt_u32 s63, 64
s_cselect_b32 s62, 2, 0
v_add_f32 v65, v65, v67
v_mfma_f32_16x16x32_bf16 v[32:35], a[124:127], v[48:51], v[32:35]
s_add_u32 s70, s70, 1
v_add_f32 v69, v69, v71
v_add_f32 v73, v73, v75
v_mfma_f32_16x16x32_bf16 v[40:43], a[180:183], v[48:51], v[40:43]
s_waitcnt lgkmcnt(1)
v_readfirstlane_b32 s52, v13
s_waitcnt lgkmcnt(2)
v_mfma_f32_16x16x32_bf16 v[16:19], a[16:19], v[52:55], v[16:19]
ds_read_b128 v[48:51], v3 offset:6144
v_mfma_f32_16x16x32_bf16 v[24:27], a[72:75], v[52:55], v[24:27]
s_and_b32 s52, s52, s93
s_cmp_eq_u32 s52, s93
s_cselect_b32 s52, s99, 2146435072
v_mfma_f32_16x16x32_bf16 v[32:35], a[128:131], v[52:55], v[32:35]
s_or_b32 s58, s52, s66
buffer_store_dword v127, off, s[8:11], s58
v_add_f32 v64, v64, v68
v_mfma_f32_16x16x32_bf16 v[40:43], a[184:187], v[52:55], v[40:43]
s_or_b32 s58, s52, s67
buffer_store_dword v127, off, s[8:11], s58 sc1
s_waitcnt lgkmcnt(1)
v_mfma_f32_16x16x32_bf16 v[16:19], a[20:23], v[56:59], v[16:19]
ds_read_b128 v[52:55], v3 offset:7168
v_mfma_f32_16x16x32_bf16 v[24:27], a[76:79], v[56:59], v[24:27]
s_and_b32 s42, s37, 7
v_add_f32 v72, v72, v76
v_add_f32 v65, v65, v69
v_mfma_f32_16x16x32_bf16 v[32:35], a[132:135], v[56:59], v[32:35]
s_mul_i32 s61, s42, 114688
v_add_f32 v73, v73, v77
v_add_f32 v66, v64, v72
v_mfma_f32_16x16x32_bf16 v[40:43], a[188:191], v[56:59], v[40:43]
v_add_f32 v64, v64, v72
v_add_f32 v67, v65, v73
s_waitcnt lgkmcnt(1)
v_mfma_f32_16x16x32_bf16 v[16:19], a[24:27], v[48:51], v[16:19]
ds_read_b128 v[56:59], v3 offset:8192
v_mfma_f32_16x16x32_bf16 v[24:27], a[80:83], v[48:51], v[24:27]
s_add_u32 s61, s61, s69
v_add_f32 v65, v65, v73
v_mfma_f32_16x16x32_bf16 v[32:35], a[136:139], v[48:51], v[32:35]
s_add_u32 s65, s61, 57344
v_permlane16_swap_b32 v64, v66
v_mfma_f32_16x16x32_bf16 v[40:43], a[192:195], v[48:51], v[40:43]
v_permlane16_swap_b32 v65, v67
s_waitcnt lgkmcnt(1)
v_mfma_f32_16x16x32_bf16 v[16:19], a[28:31], v[52:55], v[16:19]
ds_read_b128 v[48:51], v3 offset:9216
v_mfma_f32_16x16x32_bf16 v[24:27], a[84:87], v[52:55], v[24:27]
buffer_load_dword v124, v2, s[8:11], s60 offen sc1
v_add_f32 v64, v64, v66
v_add_f32 v65, v65, v67
v_mfma_f32_16x16x32_bf16 v[32:35], a[140:143], v[52:55], v[32:35]
v_mul_f32 v64, 0x3b124925, v64
v_mul_f32 v65, 0x3b124925, v65
v_mfma_f32_16x16x32_bf16 v[40:43], a[196:199], v[52:55], v[40:43]
v_fma_f32 v65, -v64, v64, v65
v_max_f32 v65, 0, v65
s_waitcnt lgkmcnt(1)
v_mfma_f32_16x16x32_bf16 v[16:19], a[32:35], v[56:59], v[16:19]
ds_read_b128 v[52:55], v3 offset:10240
v_mfma_f32_16x16x32_bf16 v[24:27], a[88:91], v[56:59], v[24:27]
v_cvt_pk_bf16_f32 v64, v65, v64
v_lshlrev_b32 v65, 16, v64
v_mfma_f32_16x16x32_bf16 v[32:35], a[144:147], v[56:59], v[32:35]
v_and_b32 v82, 0xffff0000, v64
v_add_f32 v65, 0x3727c5ac, v65
v_mfma_f32_16x16x32_bf16 v[40:43], a[200:203], v[56:59], v[40:43]
v_cvt_pk_bf16_f32 v65, v65, v65
v_lshlrev_b32 v65, 16, v65
s_waitcnt lgkmcnt(1)
v_mfma_f32_16x16x32_bf16 v[16:19], a[36:39], v[48:51], v[16:19]
ds_read_b128 v[56:59], v3 offset:11264
v_mfma_f32_16x16x32_bf16 v[24:27], a[92:95], v[48:51], v[24:27]
v_sqrt_f32 v65, v65
v_mfma_f32_16x16x32_bf16 v[32:35], a[148:151], v[48:51], v[32:35]
v_cvt_pk_bf16_f32 v65, v65, v65
v_lshlrev_b32 v65, 16, v65
v_mfma_f32_16x16x32_bf16 v[40:43], a[204:207], v[48:51], v[40:43]
v_rcp_f32 v80, v65
s_waitcnt lgkmcnt(1)
v_mfma_f32_16x16x32_bf16 v[16:19], a[40:43], v[52:55], v[16:19]
ds_read_b128 v[48:51], v3 offset:12288
v_mfma_f32_16x16x32_bf16 v[24:27], a[96:99], v[52:55], v[24:27]
v_mov_b32 v81, v80
v_mov_b32 v83, v82
v_mfma_f32_16x16x32_bf16 v[32:35], a[152:155], v[52:55], v[32:35]
v_permlane32_swap_b32 v80, v81
v_mfma_f32_16x16x32_bf16 v[40:43], a[208:211], v[52:55], v[40:43]
v_permlane32_swap_b32 v82, v83
s_waitcnt lgkmcnt(1)
v_mfma_f32_16x16x32_bf16 v[16:19], a[44:47], v[56:59], v[16:19]
ds_read_b128 v[52:55], v3 offset:13312
v_mfma_f32_16x16x32_bf16 v[24:27], a[100:103], v[56:59], v[24:27]
v_mul_f32 v112, 0xbfb8aa3b, v80
v_mul_f32 v113, v80, v80
v_mfma_f32_16x16x32_bf16 v[32:35], a[156:159], v[56:59], v[32:35]
v_rcp_f32 v113, v113
v_mfma_f32_16x16x32_bf16 v[40:43], a[212:215], v[56:59], v[40:43]
v_mul_f32 v114, 0xbfb8aa3b, v81
v_mul_f32 v115, v81, v81
s_waitcnt lgkmcnt(1)
v_mfma_f32_16x16x32_bf16 v[16:19], a[48:51], v[48:51], v[16:19]
ds_read_b128 v[56:59], v3 offset:14336
v_mfma_f32_16x16x32_bf16 v[24:27], a[104:107], v[48:51], v[24:27]
v_rcp_f32 v115, v115
v_mfma_f32_16x16x32_bf16 v[32:35], a[160:163], v[48:51], v[32:35]
v_mfma_f32_16x16x32_bf16 v[40:43], a[216:219], v[48:51], v[40:43]
s_waitcnt lgkmcnt(1)
v_mfma_f32_16x16x32_bf16 v[16:19], a[52:55], v[52:55], v[16:19]
ds_read_b128 v[48:51], v3 offset:15360
v_mfma_f32_16x16x32_bf16 v[24:27], a[108:111], v[52:55], v[24:27]
v_mfma_f32_16x16x32_bf16 v[32:35], a[164:167], v[52:55], v[32:35]
v_mfma_f32_16x16x32_bf16 v[40:43], a[220:223], v[52:55], v[40:43]
s_waitcnt lgkmcnt(1)
v_mfma_f32_16x16x32_bf16 v[20:23], a[0:3], v[56:59], 0
ds_read_b128 v[52:55], v3 offset:16384
v_mfma_f32_16x16x32_bf16 v[28:31], a[56:59], v[56:59], 0
v_mfma_f32_16x16x32_bf16 v[36:39], a[112:115], v[56:59], 0
v_mfma_f32_16x16x32_bf16 v[44:47], a[168:171], v[56:59], 0
v_fma_f32 v16, -v82, v88, v16
v_fma_f32 v17, -v82, v89, v17
s_waitcnt lgkmcnt(1)
v_mfma_f32_16x16x32_bf16 v[20:23], a[4:7], v[48:51], v[20:23]
ds_read_b128 v[56:59], v3 offset:17408
v_mfma_f32_16x16x32_bf16 v[28:31], a[60:63], v[48:51], v[28:31]
v_fma_f32 v18, -v82, v90, v18
v_fma_f32 v19, -v82, v91, v19
v_mfma_f32_16x16x32_bf16 v[36:39], a[116:119], v[48:51], v[36:39]
v_mul_f32 v104, v112, v16
v_mul_f32 v105, v112, v17
v_mfma_f32_16x16x32_bf16 v[44:47], a[172:175], v[48:51], v[44:47]
v_mul_f32 v106, v112, v18
v_mul_f32 v107, v112, v19
s_waitcnt lgkmcnt(1)
v_mfma_f32_16x16x32_bf16 v[20:23], a[8:11], v[52:55], v[20:23]
ds_read_b128 v[48:51], v3 offset:18432
v_mfma_f32_16x16x32_bf16 v[28:31], a[64:67], v[52:55], v[28:31]
v_exp_f32 v104, v104
v_mfma_f32_16x16x32_bf16 v[36:39], a[120:123], v[52:55], v[36:39]
v_exp_f32 v105, v105
v_mfma_f32_16x16x32_bf16 v[44:47], a[176:179], v[52:55], v[44:47]
v_exp_f32 v106, v106
s_waitcnt lgkmcnt(1)
v_mfma_f32_16x16x32_bf16 v[20:23], a[12:15], v[56:59], v[20:23]
ds_read_b128 v[52:55], v3 offset:19456
v_mfma_f32_16x16x32_bf16 v[28:31], a[68:71], v[56:59], v[28:31]
v_exp_f32 v107, v107
v_mfma_f32_16x16x32_bf16 v[36:39], a[124:127], v[56:59], v[36:39]
s_waitcnt vmcnt(0)
v_subrev_u32 v125, s70, v125
v_ashrrev_i32 v125, 31, v125
v_mfma_f32_16x16x32_bf16 v[44:47], a[180:183], v[56:59], v[44:47]
v_or_b32 v124, v124, v125
v_cmp_eq_u32 vcc, -1, v124
s_waitcnt lgkmcnt(1)
v_mfma_f32_16x16x32_bf16 v[20:23], a[16:19], v[48:51], v[20:23]
ds_read_b128 v[56:59], v3 offset:20480
v_mfma_f32_16x16x32_bf16 v[28:31], a[72:75], v[48:51], v[28:31]
s_cmp_eq_u64 vcc, 0
s_cselect_b32 s97, 3, 1
s_and_b32 s97, s97, s62
v_mfma_f32_16x16x32_bf16 v[36:39], a[128:131], v[48:51], v[36:39]
s_add_u32 s56, s59, s50
s_add_u32 s57, s60, s51
v_fma_f32 v32, -v82, v96, v32
v_mfma_f32_16x16x32_bf16 v[44:47], a[184:187], v[48:51], v[44:47]
v_fma_f32 v33, -v82, v97, v33
v_fma_f32 v34, -v82, v98, v34
s_waitcnt lgkmcnt(1)
v_mfma_f32_16x16x32_bf16 v[20:23], a[20:23], v[52:55], v[20:23]
ds_read_b128 v[48:51], v3 offset:21504
v_mfma_f32_16x16x32_bf16 v[28:31], a[76:79], v[52:55], v[28:31]
s_cmp_lg_u32 s97, 0
s_cselect_b32 s56, s56, 2146435072
s_cselect_b32 s57, s57, 2146435072
v_mfma_f32_16x16x32_bf16 v[36:39], a[132:135], v[52:55], v[36:39]
s_cmp_lg_u32 s97, 0
s_cselect_b32 s52, 4, 24
v_add_u32 v124, s52, v0
v_mfma_f32_16x16x32_bf16 v[44:47], a[188:191], v[52:55], v[44:47]
v_mov_b32 v13, s94
v_fma_f32 v35, -v82, v99, v35
s_waitcnt lgkmcnt(1)
v_mfma_f32_16x16x32_bf16 v[20:23], a[24:27], v[56:59], v[20:23]
ds_read_b128 v[52:55], v3 offset:22528
v_mfma_f32_16x16x32_bf16 v[28:31], a[80:83], v[56:59], v[28:31]
buffer_load_dword v126, v2, s[8:11], s60 offen sc1
ds_write_b32 v124, v13
v_mfma_f32_16x16x32_bf16 v[36:39], a[136:139], v[56:59], v[36:39]
s_mov_b32 m0, s48
v_fma_f32 v104, v104, v113, v113
v_fma_f32 v105, v105, v113, v113
v_mfma_f32_16x16x32_bf16 v[44:47], a[192:195], v[56:59], v[44:47]
buffer_load_dwordx4 v1, s[8:11], s56 offen offset:0 sc1 lds
v_fma_f32 v106, v106, v113, v113
s_waitcnt lgkmcnt(2)
v_mfma_f32_16x16x32_bf16 v[20:23], a[28:31], v[48:51], v[20:23]
ds_read_b128 v[56:59], v3 offset:23552
v_mfma_f32_16x16x32_bf16 v[28:31], a[84:87], v[48:51], v[28:31]
buffer_load_dwordx4 v1, s[8:11], s56 offen offset:1024 sc1 lds
v_fma_f32 v107, v107, v113, v113
v_mfma_f32_16x16x32_bf16 v[36:39], a[140:143], v[48:51], v[36:39]
buffer_load_dwordx4 v1, s[8:11], s56 offen offset:2048 sc1 lds
v_rcp_f32 v104, v104
v_mfma_f32_16x16x32_bf16 v[44:47], a[196:199], v[48:51], v[44:47]
v_rcp_f32 v105, v105
s_waitcnt lgkmcnt(2)
v_mfma_f32_16x16x32_bf16 v[20:23], a[32:35], v[52:55], v[20:23]
ds_read_b128 v[48:51], v3 offset:24576
v_mfma_f32_16x16x32_bf16 v[28:31], a[88:91], v[52:55], v[28:31]
buffer_load_dwordx4 v1, s[8:11], s56 offen offset:3072 sc1 lds
v_rcp_f32 v106, v106
v_mfma_f32_16x16x32_bf16 v[36:39], a[144:147], v[52:55], v[36:39]
v_rcp_f32 v107, v107
v_mfma_f32_16x16x32_bf16 v[44:47], a[200:203], v[52:55], v[44:47]
v_mul_f32 v16, v16, v32
v_mul_f32 v17, v17, v33
s_waitcnt lgkmcnt(1)
v_mfma_f32_16x16x32_bf16 v[20:23], a[36:39], v[56:59], v[20:23]
ds_read_b128 v[52:55], v3 offset:25600
v_mfma_f32_16x16x32_bf16 v[28:31], a[92:95], v[56:59], v[28:31]
s_add_u32 m0, s48, 4096
s_add_u32 s51, s56, 4096
buffer_load_dwordx4 v1, s[8:11], s51 offen offset:0 sc1 lds
v_mfma_f32_16x16x32_bf16 v[36:39], a[148:151], v[56:59], v[36:39]
v_mul_f32 v18, v18, v34
v_mul_f32 v19, v19, v35
v_mfma_f32_16x16x32_bf16 v[44:47], a[204:207], v[56:59], v[44:47]
v_mul_f32 v16, v16, v104
v_mul_f32 v17, v17, v105
s_waitcnt lgkmcnt(1)
v_mfma_f32_16x16x32_bf16 v[20:23], a[40:43], v[48:51], v[20:23]
ds_read_b128 v[56:59], v3 offset:26624
v_mfma_f32_16x16x32_bf16 v[28:31], a[96:99], v[48:51], v[28:31]
buffer_load_dwordx4 v1, s[8:11], s51 offen offset:1024 sc1 lds
v_mul_f32 v18, v18, v106
v_mul_f32 v19, v19, v107
v_mfma_f32_16x16x32_bf16 v[36:39], a[152:155], v[48:51], v[36:39]
v_cvt_pk_bf16_f32 v116, v16, v17
v_cvt_pk_bf16_f32 v117, v18, v19
v_mfma_f32_16x16x32_bf16 v[44:47], a[208:211], v[48:51], v[44:47]
v_fma_f32 v24, -v82, v92, v24
v_fma_f32 v25, -v82, v93, v25
s_waitcnt lgkmcnt(1)
v_mfma_f32_16x16x32_bf16 v[20:23], a[44:47], v[52:55], v[20:23]
ds_read_b128 v[48:51], v3 offset:27648
v_mfma_f32_16x16x32_bf16 v[28:31], a[100:103], v[52:55], v[28:31]
buffer_load_dwordx4 v1, s[8:11], s51 offen offset:2048 sc1 lds
v_fma_f32 v26, -v82, v94, v26
v_fma_f32 v27, -v82, v95, v27
v_mfma_f32_16x16x32_bf16 v[36:39], a[156:159], v[52:55], v[36:39]
v_mul_f32 v108, v112, v24
v_mul_f32 v109, v112, v25
v_mfma_f32_16x16x32_bf16 v[44:47], a[212:215], v[52:55], v[44:47]
v_mul_f32 v110, v112, v26
v_mul_f32 v111, v112, v27
s_waitcnt lgkmcnt(1)
v_mfma_f32_16x16x32_bf16 v[20:23], a[48:51], v[56:59], v[20:23]
s_mov_b32 m0, s49
v_exp_f32 v108, v108
v_mfma_f32_16x16x32_bf16 v[28:31], a[104:107], v[56:59], v[28:31]
buffer_load_dwordx4 v1, s[8:11], s57 offen sc1 lds
v_exp_f32 v109, v109
v_mfma_f32_16x16x32_bf16 v[36:39], a[160:163], v[56:59], v[36:39]
v_exp_f32 v110, v110
v_mfma_f32_16x16x32_bf16 v[44:47], a[216:219], v[56:59], v[44:47]
v_exp_f32 v111, v111
s_waitcnt lgkmcnt(0)
v_mfma_f32_16x16x32_bf16 v[20:23], a[52:55], v[48:51], v[20:23]
v_fma_f32 v40, -v82, v100, v40
v_fma_f32 v41, -v82, v101, v41
v_mfma_f32_16x16x32_bf16 v[28:31], a[108:111], v[48:51], v[28:31]
v_fma_f32 v42, -v82, v102, v42
v_fma_f32 v43, -v82, v103, v43
v_mfma_f32_16x16x32_bf16 v[36:39], a[164:167], v[48:51], v[36:39]
v_fma_f32 v108, v108, v113, v113
v_fma_f32 v109, v109, v113, v113
v_mfma_f32_16x16x32_bf16 v[44:47], a[220:223], v[48:51], v[44:47]
v_fma_f32 v110, v110, v113, v113
v_fma_f32 v111, v111, v113, v113
s_cmp_eq_u32 s97, 0
s_cbranch_scc1 Lf2a_193
Lf2b_194:
v_rcp_f32 v108, v108
v_rcp_f32 v109, v109
v_rcp_f32 v110, v110
v_rcp_f32 v111, v111
v_mul_f32 v24, v24, v40
v_mul_f32 v25, v25, v41
v_mul_f32 v26, v26, v42
v_mul_f32 v27, v27, v43
v_mul_f32 v24, v24, v108
v_mul_f32 v25, v25, v109
v_mul_f32 v26, v26, v110
v_mul_f32 v27, v27, v111
v_cvt_pk_bf16_f32 v118, v24, v25
v_cvt_pk_bf16_f32 v119, v26, v27
s_or_b32 s72, s61, s66
buffer_store_dwordx4 v[116:119], v1, s[8:11], s72 offen
s_or_b32 s72, s61, s67
buffer_store_dwordx4 v[116:119], v1, s[8:11], s72 offen sc1
v_pk_fma_f32 v[20:21], v[82:83], v[88:89], v[20:21] op_sel:[1,0,0] op_sel_hi:[1,1,1] neg_lo:[1,0,0] neg_hi:[1,0,0]
v_pk_fma_f32 v[22:23], v[82:83], v[90:91], v[22:23] op_sel:[1,0,0] op_sel_hi:[1,1,1] neg_lo:[1,0,0] neg_hi:[1,0,0]
v_pk_mul_f32 v[104:105], v[114:115], v[20:21] op_sel_hi:[0,1]
v_pk_mul_f32 v[106:107], v[114:115], v[22:23] op_sel_hi:[0,1]
v_exp_f32 v104, v104
v_exp_f32 v105, v105
v_exp_f32 v106, v106
v_exp_f32 v107, v107
v_pk_fma_f32 v[36:37], v[82:83], v[96:97], v[36:37] op_sel:[1,0,0] op_sel_hi:[1,1,1] neg_lo:[1,0,0] neg_hi:[1,0,0]
v_pk_fma_f32 v[38:39], v[82:83], v[98:99], v[38:39] op_sel:[1,0,0] op_sel_hi:[1,1,1] neg_lo:[1,0,0] neg_hi:[1,0,0]
v_pk_fma_f32 v[104:105], v[104:105], v[114:115], v[114:115] op_sel:[0,1,1] op_sel_hi:[1,1,1]
v_pk_fma_f32 v[106:107], v[106:107], v[114:115], v[114:115] op_sel:[0,1,1] op_sel_hi:[1,1,1]
v_rcp_f32 v104, v104
v_rcp_f32 v105, v105
v_rcp_f32 v106, v106
v_rcp_f32 v107, v107
v_pk_mul_f32 v[20:21], v[20:21], v[36:37]
v_pk_mul_f32 v[22:23], v[22:23], v[38:39]
v_pk_mul_f32 v[20:21], v[20:21], v[104:105]
v_pk_mul_f32 v[22:23], v[22:23], v[106:107]
v_cvt_pk_bf16_f32 v120, v20, v21
v_cvt_pk_bf16_f32 v121, v22, v23
v_pk_fma_f32 v[28:29], v[82:83], v[92:93], v[28:29] op_sel:[1,0,0] op_sel_hi:[1,1,1] neg_lo:[1,0,0] neg_hi:[1,0,0]
v_pk_fma_f32 v[30:31], v[82:83], v[94:95], v[30:31] op_sel:[1,0,0] op_sel_hi:[1,1,1] neg_lo:[1,0,0] neg_hi:[1,0,0]
v_pk_mul_f32 v[108:109], v[114:115], v[28:29] op_sel_hi:[0,1]
v_pk_mul_f32 v[110:111], v[114:115], v[30:31] op_sel_hi:[0,1]
v_exp_f32 v108, v108
v_exp_f32 v109, v109
v_exp_f32 v110, v110
v_exp_f32 v111, v111
v_pk_fma_f32 v[44:45], v[82:83], v[100:101], v[44:45] op_sel:[1,0,0] op_sel_hi:[1,1,1] neg_lo:[1,0,0] neg_hi:[1,0,0]
v_pk_fma_f32 v[46:47], v[82:83], v[102:103], v[46:47] op_sel:[1,0,0] op_sel_hi:[1,1,1] neg_lo:[1,0,0] neg_hi:[1,0,0]
v_pk_fma_f32 v[108:109], v[108:109], v[114:115], v[114:115] op_sel:[0,1,1] op_sel_hi:[1,1,1]
v_pk_fma_f32 v[110:111], v[110:111], v[114:115], v[114:115] op_sel:[0,1,1] op_sel_hi:[1,1,1]
v_rcp_f32 v108, v108
v_rcp_f32 v109, v109
v_rcp_f32 v110, v110
v_rcp_f32 v111, v111
v_pk_mul_f32 v[28:29], v[28:29], v[44:45]
v_pk_mul_f32 v[30:31], v[30:31], v[46:47]
v_pk_mul_f32 v[28:29], v[28:29], v[108:109]
v_pk_mul_f32 v[30:31], v[30:31], v[110:111]
v_cvt_pk_bf16_f32 v122, v28, v29
v_cvt_pk_bf16_f32 v123, v30, v31
s_or_b32 s72, s65, s66
buffer_store_dwordx4 v[120:123], v1, s[8:11], s72 offen
s_or_b32 s72, s65, s67
buffer_store_dwordx4 v[120:123], v1, s[8:11], s72 offen sc1
v_cmp_u_f32 vcc, v16, v20
s_nop 0
s_cbranch_vccnz Lfn_195
Lfo_196:
s_mov_b32 s99, s73
v_mov_b32 v127, s63
s_mov_b32 s98, 1
s_xor_b32 s96, s96, 16
s_cmp_lg_u32 s62, 0
s_cbranch_scc1 LF1_loop
s_cmp_eq_u32 s98, 0
s_cbranch_scc1 Lpp_197
s_waitcnt vmcnt(0)
v_mov_b32 v124, s96
s_mov_b64 exec, 1
ds_add_rtn_u32 v124, v124, v15 offset:0
s_mov_b64 exec, -1
s_waitcnt lgkmcnt(0)
v_readfirstlane_b32 s45, v124
s_nop 0
s_and_b32 s45, s45, s93
s_cmp_lg_u32 s45, s93
s_cbranch_scc1 Lpn_198
s_or_b32 s45, s99, s66
buffer_store_dword v127, off, s[8:11], s45
s_or_b32 s45, s99, s67
buffer_store_dword v127, off, s[8:11], s45 sc1
Lpn_198:
s_mov_b32 s98, 0
Lpp_197:
s_branch L_done
Lxb_189:
s_xor_b32 s44, s95, 32768
s_mul_i32 s45, s32, 7168
s_add_u32 s45, s45, s44
v_add_u32 v8, s45, v1
s_lshl_b32 s45, s32, 10
v_add_u32 v9, s45, v1
v_min_u32 v9, 3568, v9
v_add_u32 v9, s44, v9
s_cmp_lg_u32 s62, 2
s_cbranch_scc1 Lxn_190
s_cmp_eq_u32 s71, 0
s_cbranch_scc1 Lxf_199
v_mov_b32 v124, s94
ds_write_b32 v0, v124 offset:4
s_cmp_eq_u32 s98, 0
s_cbranch_scc1 Lpp_200
s_waitcnt vmcnt(0)
v_mov_b32 v124, s96
s_mov_b64 exec, 1
ds_add_rtn_u32 v124, v124, v15 offset:0
s_mov_b64 exec, -1
s_waitcnt lgkmcnt(0)
v_readfirstlane_b32 s45, v124
s_nop 0
s_and_b32 s45, s45, s93
s_cmp_lg_u32 s45, s93
s_cbranch_scc1 Lpn_201
s_or_b32 s45, s99, s66
buffer_store_dword v127, off, s[8:11], s45
s_or_b32 s45, s99, s67
buffer_store_dword v127, off, s[8:11], s45 sc1
Lpn_201:
s_mov_b32 s98, 0
Lpp_200:
s_branch Lxn_190
Lxe_192:
s_sleep 2
s_branch Lxn_190
Lxf_199:
s_cmp_lg_u32 s32, 3
s_cbranch_scc1 Lpq_206
s_branch Lpg_203
Lpf_202:
s_sleep 2
Lpg_203:
buffer_load_dword v124, v2, s[8:11], s60 offen sc1
buffer_load_dword v125, v7, s[8:11], s68 offen sc1
s_sub_u32 s36, s36, 1
s_cbranch_scc1 L_timeout_22
s_waitcnt vmcnt(0)
v_subrev_u32 v125, s70, v125
v_ashrrev_i32 v125, 31, v125
v_or_b32 v124, v124, v125
v_cmp_eq_u32 vcc, -1, v124
s_cmp_eq_u32 s98, 0
s_cbranch_scc1 Lpp_207
s_waitcnt vmcnt(0)
v_mov_b32 v124, s96
s_mov_b64 exec, 1
ds_add_rtn_u32 v124, v124, v15 offset:0
s_mov_b64 exec, -1
s_waitcnt lgkmcnt(0)
v_readfirstlane_b32 s45, v124
s_nop 0
s_and_b32 s45, s45, s93
s_cmp_lg_u32 s45, s93
s_cbranch_scc1 Lpn_208
s_or_b32 s45, s99, s66
buffer_store_dword v127, off, s[8:11], s45
s_or_b32 s45, s99, s67
buffer_store_dword v127, off, s[8:11], s45 sc1
Lpn_208:
s_mov_b32 s98, 0
Lpp_207:
s_cbranch_vccnz Lpf_202
v_mov_b32 v124, s94
ds_write_b32 v0, v124 offset:4
s_branch Lpe_205
Lpq_206:
s_cmp_eq_u32 s98, 0
s_cbranch_scc1 Lpp_209
s_waitcnt vmcnt(0)
v_mov_b32 v124, s96
s_mov_b64 exec, 1
ds_add_rtn_u32 v124, v124, v15 offset:0
s_mov_b64 exec, -1
s_waitcnt lgkmcnt(0)
v_readfirstlane_b32 s45, v124
s_nop 0
s_and_b32 s45, s45, s93
s_cmp_lg_u32 s45, s93
s_cbranch_scc1 Lpn_210
s_or_b32 s45, s99, s66
buffer_store_dword v127, off, s[8:11], s45
s_or_b32 s45, s99, s67
buffer_store_dword v127, off, s[8:11], s45 sc1
Lpn_210:
s_mov_b32 s98, 0
Lpp_209:
Lph_204:
s_sleep 1
ds_read_b32 v124, v0 offset:4
s_sub_u32 s92, s92, 1
s_cbranch_scc1 L_timeout_22
s_waitcnt lgkmcnt(0)
v_cmp_gt_u32 vcc, s94, v124
s_nop 0
s_cbranch_vccnz Lph_204
Lpe_205:
Lxn_190:
s_sub_u32 s36, s36, 1
s_cbranch_scc1 L_timeout_22
s_xor_b32 s44, s95, 32768
s_mul_i32 s42, s32, 7168
s_add_u32 s43, s59, s42
s_add_u32 s42, s42, s44
s_mov_b32 m0, s42
s_nop 0
buffer_load_dwordx4 v1, s[8:11], s43 offen offset:0 sc1 lds
buffer_load_dwordx4 v1, s[8:11], s43 offen offset:1024 sc1 lds
buffer_load_dwordx4 v1, s[8:11], s43 offen offset:2048 sc1 lds
buffer_load_dwordx4 v1, s[8:11], s43 offen offset:3072 sc1 lds
s_add_u32 s43, s43, 4096
s_add_u32 m0, s42, 4096
s_nop 0
buffer_load_dwordx4 v1, s[8:11], s43 offen offset:0 sc1 lds
buffer_load_dwordx4 v1, s[8:11], s43 offen offset:1024 sc1 lds
buffer_load_dwordx4 v1, s[8:11], s43 offen offset:2048 sc1 lds
s_lshl_b32 s42, s32, 10
s_add_u32 s43, s60, s42
s_add_u32 s42, s42, s44
s_add_u32 m0, s42, 28672
s_nop 0
buffer_load_dwordx4 v1, s[8:11], s43 offen sc1 lds
s_waitcnt vmcnt(0)
s_cmp_eq_u32 s62, 1
s_cbranch_scc1 Lxv_191
ds_read_b128 v[128:131], v8 offset:0
ds_read_b128 v[132:135], v8 offset:1024
ds_read_b128 v[136:139], v8 offset:2048
ds_read_b128 v[140:143], v8 offset:3072
ds_read_b128 v[144:147], v8 offset:4096
ds_read_b128 v[148:151], v8 offset:5120
ds_read_b128 v[152:155], v8 offset:6144
ds_read_b128 v[156:159], v9 offset:28672
s_waitcnt lgkmcnt(6)
v_max3_u32 v10, v128, v129, v130
v_max3_u32 v11, v131, v132, v133
v_max3_u32 v10, v10, v134, v135
s_waitcnt lgkmcnt(4)
v_max3_u32 v10, v10, v136, v137
v_max3_u32 v11, v11, v138, v139
v_max3_u32 v10, v10, v140, v141
v_max3_u32 v11, v11, v142, v143
s_waitcnt lgkmcnt(2)
v_max3_u32 v10, v10, v144, v145
v_max3_u32 v11, v11, v146, v147
v_max3_u32 v10, v10, v148, v149
v_max3_u32 v11, v11, v150, v151
s_waitcnt lgkmcnt(0)
v_max3_u32 v10, v10, v152, v153
v_max3_u32 v11, v11, v154, v155
v_max3_u32 v10, v10, v156, v157
v_max3_u32 v11, v11, v158, v159
v_max_u32 v10, v10, v11
v_cmp_eq_u32 vcc, -1, v10
s_nop 0
s_cbranch_vccnz Lxe_192
s_branch Lxt_188
Lf2a_193:
s_cmp_eq_u32 s62, 0
s_cbranch_scc1 Lf2b_194
v_cmp_ne_u32 vcc, 0, v125
s_nop 0
s_cmp_eq_u64 vcc, 0
s_cselect_b32 s71, 1, 0
s_waitcnt vmcnt(8)
v_or_b32 v126, v126, v125
v_cmp_eq_u32 vcc, -1, v126
s_nop 0
s_cbranch_vccnz Lf2b_194
v_mov_b32 v126, s94
ds_write_b32 v0, v126 offset:4
s_xor_b32 s44, s95, 32768
s_mul_i32 s42, s32, 7168
s_add_u32 s43, s59, s42
s_add_u32 s42, s42, s44
s_mov_b32 m0, s42
s_nop 0
buffer_load_dwordx4 v1, s[8:11], s43 offen offset:0 sc1 lds
buffer_load_dwordx4 v1, s[8:11], s43 offen offset:1024 sc1 lds
buffer_load_dwordx4 v1, s[8:11], s43 offen offset:2048 sc1 lds
buffer_load_dwordx4 v1, s[8:11], s43 offen offset:3072 sc1 lds
s_add_u32 s43, s43, 4096
s_add_u32 m0, s42, 4096
s_nop 0
buffer_load_dwordx4 v1, s[8:11], s43 offen offset:0 sc1 lds
buffer_load_dwordx4 v1, s[8:11], s43 offen offset:1024 sc1 lds
buffer_load_dwordx4 v1, s[8:11], s43 offen offset:2048 sc1 lds
s_lshl_b32 s42, s32, 10
s_add_u32 s43, s60, s42
s_add_u32 s42, s42, s44
s_add_u32 m0, s42, 28672
s_nop 0
buffer_load_dwordx4 v1, s[8:11], s43 offen sc1 lds
s_mov_b32 s97, 1
s_branch Lf2b_194
Lfn_195:
v_min_u32 v9, 496, v1
v_add_u32 v9, s95, v9
v_mov_b32 v10, 0
ds_read_b128 v[128:131], v3 offset:0
s_waitcnt lgkmcnt(0)
v_max3_u32 v10, v10, v128, v129
v_max3_u32 v10, v10, v130, v131
ds_read_b128 v[128:131], v3 offset:1024
s_waitcnt lgkmcnt(0)
v_max3_u32 v10, v10, v128, v129
v_max3_u32 v10, v10, v130, v131
ds_read_b128 v[128:131], v3 offset:2048
s_waitcnt lgkmcnt(0)
v_max3_u32 v10, v10, v128, v129
v_max3_u32 v10, v10, v130, v131
ds_read_b128 v[128:131], v3 offset:3072
s_waitcnt lgkmcnt(0)
v_max3_u32 v10, v10, v128, v129
v_max3_u32 v10, v10, v130, v131
ds_read_b128 v[128:131], v3 offset:4096
s_waitcnt lgkmcnt(0)
v_max3_u32 v10, v10, v128, v129
v_max3_u32 v10, v10, v130, v131
ds_read_b128 v[128:131], v3 offset:5120
s_waitcnt lgkmcnt(0)
v_max3_u32 v10, v10, v128, v129
v_max3_u32 v10, v10, v130, v131
ds_read_b128 v[128:131], v3 offset:6144
s_waitcnt lgkmcnt(0)
v_max3_u32 v10, v10, v128, v129
v_max3_u32 v10, v10, v130, v131
ds_read_b128 v[128:131], v3 offset:7168
s_waitcnt lgkmcnt(0)
v_max3_u32 v10, v10, v128, v129
v_max3_u32 v10, v10, v130, v131
ds_read_b128 v[128:131], v3 offset:8192
s_waitcnt lgkmcnt(0)
v_max3_u32 v10, v10, v128, v129
v_max3_u32 v10, v10, v130, v131
ds_read_b128 v[128:131], v3 offset:9216
s_waitcnt lgkmcnt(0)
v_max3_u32 v10, v10, v128, v129
v_max3_u32 v10, v10, v130, v131
ds_read_b128 v[128:131], v3 offset:10240
s_waitcnt lgkmcnt(0)
v_max3_u32 v10, v10, v128, v129
v_max3_u32 v10, v10, v130, v131
ds_read_b128 v[128:131], v3 offset:11264
s_waitcnt lgkmcnt(0)
v_max3_u32 v10, v10, v128, v129
v_max3_u32 v10, v10, v130, v131
ds_read_b128 v[128:131], v3 offset:12288
s_waitcnt lgkmcnt(0)
v_max3_u32 v10, v10, v128, v129
v_max3_u32 v10, v10, v130, v131
ds_read_b128 v[128:131], v3 offset:13312
s_waitcnt lgkmcnt(0)
v_max3_u32 v10, v10, v128, v129
v_max3_u32 v10, v10, v130, v131
ds_read_b128 v[128:131], v3 offset:14336
s_waitcnt lgkmcnt(0)
v_max3_u32 v10, v10, v128, v129
v_max3_u32 v10, v10, v130, v131
ds_read_b128 v[128:131], v3 offset:15360
s_waitcnt lgkmcnt(0)
v_max3_u32 v10, v10, v128, v129
v_max3_u32 v10, v10, v130, v131
ds_read_b128 v[128:131], v3 offset:16384
s_waitcnt lgkmcnt(0)
v_max3_u32 v10, v10, v128, v129
v_max3_u32 v10, v10, v130, v131
ds_read_b128 v[128:131], v3 offset:17408
s_waitcnt lgkmcnt(0)
v_max3_u32 v10, v10, v128, v129
v_max3_u32 v10, v10, v130, v131
ds_read_b128 v[128:131], v3 offset:18432
s_waitcnt lgkmcnt(0)
v_max3_u32 v10, v10, v128, v129
v_max3_u32 v10, v10, v130, v131
ds_read_b128 v[128:131], v3 offset:19456
s_waitcnt lgkmcnt(0)
v_max3_u32 v10, v10, v128, v129
v_max3_u32 v10, v10, v130, v131
ds_read_b128 v[128:131], v3 offset:20480
s_waitcnt lgkmcnt(0)
v_max3_u32 v10, v10, v128, v129
v_max3_u32 v10, v10, v130, v131
ds_read_b128 v[128:131], v3 offset:21504
s_waitcnt lgkmcnt(0)
v_max3_u32 v10, v10, v128, v129
v_max3_u32 v10, v10, v130, v131
ds_read_b128 v[128:131], v3 offset:22528
s_waitcnt lgkmcnt(0)
v_max3_u32 v10, v10, v128, v129
v_max3_u32 v10, v10, v130, v131
ds_read_b128 v[128:131], v3 offset:23552
s_waitcnt lgkmcnt(0)
v_max3_u32 v10, v10, v128, v129
v_max3_u32 v10, v10, v130, v131
ds_read_b128 v[128:131], v3 offset:24576
s_waitcnt lgkmcnt(0)
v_max3_u32 v10, v10, v128, v129
v_max3_u32 v10, v10, v130, v131
ds_read_b128 v[128:131], v3 offset:25600
s_waitcnt lgkmcnt(0)
v_max3_u32 v10, v10, v128, v129
v_max3_u32 v10, v10, v130, v131
ds_read_b128 v[128:131], v3 offset:26624
s_waitcnt lgkmcnt(0)
v_max3_u32 v10, v10, v128, v129
v_max3_u32 v10, v10, v130, v131
ds_read_b128 v[128:131], v3 offset:27648
s_waitcnt lgkmcnt(0)
v_max3_u32 v10, v10, v128, v129
v_max3_u32 v10, v10, v130, v131
ds_read_b128 v[128:131], v3 offset:28672
s_waitcnt lgkmcnt(0)
v_max3_u32 v10, v10, v128, v129
v_max3_u32 v10, v10, v130, v131
ds_read_b128 v[128:131], v3 offset:29696
s_waitcnt lgkmcnt(0)
v_max3_u32 v10, v10, v128, v129
v_max3_u32 v10, v10, v130, v131
ds_read_b128 v[128:131], v3 offset:30720
s_waitcnt lgkmcnt(0)
v_max3_u32 v10, v10, v128, v129
v_max3_u32 v10, v10, v130, v131
ds_read_b128 v[128:131], v9 offset:31744
s_waitcnt lgkmcnt(0)
v_max3_u32 v10, v10, v128, v129
v_max3_u32 v10, v10, v130, v131
v_cmp_eq_u32 vcc, -1, v10
s_nop 0
s_cbranch_vccz Lfo_196
s_sub_u32 s36, s36, 1
s_cbranch_scc1 L_timeout_22
s_mov_b32 s63, s37
s_sub_u32 s59, s59, 28672
s_sub_u32 s60, s60, 4096
s_sub_u32 s70, s70, 1
s_sub_u32 s94, s94, 1
s_mov_b32 s62, 2
s_mov_b32 s71, 1
s_mov_b32 s97, 0
s_waitcnt vmcnt(0)
s_branch LF1_loop
L_roleF2:
v_min_u32 v2, 13, v0
v_lshlrev_b32 v2, 7, v2
s_sub_u32 s59, s34, 14
s_cmp_ge_u32 s59, 7
s_cselect_b32 s44, 1, 0
s_mul_i32 s40, s44, 7
s_sub_u32 s45, s59, s40
v_lshrrev_b32 v8, 2, v0
v_mul_u32_u24 v4, 896, v8
v_and_b32 v9, 3, v0
v_lshl_add_u32 v4, v9, 4, v4
s_mul_i32 s47, s32, 401408
s_mul_i32 s40, s45, 128
s_add_u32 s47, s47, s40
s_mul_i32 s46, s32, 28672
v_lshrrev_b32 v10, 4, v0
v_bfe_u32 v8, v0, 2, 2
v_lshl_add_u32 v8, v10, 3, v8
v_lshlrev_b32 v5, 6, v8
v_lshl_add_u32 v5, v9, 4, v5
v_add_u32 v5, s46, v5
s_add_u32 s40, s47, 0
s_add_u32 m0, s46, 0
s_nop 0
buffer_load_dwordx4 v4, s[24:27], s40 offen lds
s_add_u32 s40, s47, 14336
s_add_u32 m0, s46, 1024
s_nop 0
buffer_load_dwordx4 v4, s[24:27], s40 offen lds
s_add_u32 s40, s47, 28672
s_add_u32 m0, s46, 2048
s_nop 0
buffer_load_dwordx4 v4, s[24:27], s40 offen lds
s_add_u32 s40, s47, 43008
s_add_u32 m0, s46, 3072
s_nop 0
buffer_load_dwordx4 v4, s[24:27], s40 offen lds
s_add_u32 s40, s47, 57344
s_add_u32 m0, s46, 4096
s_nop 0
buffer_load_dwordx4 v4, s[24:27], s40 offen lds
s_add_u32 s40, s47, 71680
s_add_u32 m0, s46, 5120
s_nop 0
buffer_load_dwordx4 v4, s[24:27], s40 offen lds
s_add_u32 s40, s47, 86016
s_add_u32 m0, s46, 6144
s_nop 0
buffer_load_dwordx4 v4, s[24:27], s40 offen lds
s_add_u32 s40, s47, 100352
s_add_u32 m0, s46, 7168
s_nop 0
buffer_load_dwordx4 v4, s[24:27], s40 offen lds
s_add_u32 s40, s47, 114688
s_add_u32 m0, s46, 8192
s_nop 0
buffer_load_dwordx4 v4, s[24:27], s40 offen lds
s_add_u32 s40, s47, 129024
s_add_u32 m0, s46, 9216
s_nop 0
buffer_load_dwordx4 v4, s[24:27], s40 offen lds
s_add_u32 s40, s47, 143360
s_add_u32 m0, s46, 10240
s_nop 0
buffer_load_dwordx4 v4, s[24:27], s40 offen lds
s_add_u32 s40, s47, 157696
s_add_u32 m0, s46, 11264
s_nop 0
buffer_load_dwordx4 v4, s[24:27], s40 offen lds
s_add_u32 s40, s47, 172032
s_add_u32 m0, s46, 12288
s_nop 0
buffer_load_dwordx4 v4, s[24:27], s40 offen lds
s_add_u32 s40, s47, 186368
s_add_u32 m0, s46, 13312
s_nop 0
buffer_load_dwordx4 v4, s[24:27], s40 offen lds
s_add_u32 s40, s47, 200704
s_add_u32 m0, s46, 14336
s_nop 0
buffer_load_dwordx4 v4, s[24:27], s40 offen lds
s_add_u32 s40, s47, 215040
s_add_u32 m0, s46, 15360
s_nop 0
buffer_load_dwordx4 v4, s[24:27], s40 offen lds
s_add_u32 s40, s47, 229376
s_add_u32 m0, s46, 16384
s_nop 0
buffer_load_dwordx4 v4, s[24:27], s40 offen lds
s_add_u32 s40, s47, 243712
s_add_u32 m0, s46, 17408
s_nop 0
buffer_load_dwordx4 v4, s[24:27], s40 offen lds
s_add_u32 s40, s47, 258048
s_add_u32 m0, s46, 18432
s_nop 0
buffer_load_dwordx4 v4, s[24:27], s40 offen lds
s_add_u32 s40, s47, 272384
s_add_u32 m0, s46, 19456
s_nop 0
buffer_load_dwordx4 v4, s[24:27], s40 offen lds
s_add_u32 s40, s47, 286720
s_add_u32 m0, s46, 20480
s_nop 0
buffer_load_dwordx4 v4, s[24:27], s40 offen lds
s_add_u32 s40, s47, 301056
s_add_u32 m0, s46, 21504
s_nop 0
buffer_load_dwordx4 v4, s[24:27], s40 offen lds
s_add_u32 s40, s47, 315392
s_add_u32 m0, s46, 22528
s_nop 0
buffer_load_dwordx4 v4, s[24:27], s40 offen lds
s_add_u32 s40, s47, 329728
s_add_u32 m0, s46, 23552
s_nop 0
buffer_load_dwordx4 v4, s[24:27], s40 offen lds
s_add_u32 s40, s47, 344064
s_add_u32 m0, s46, 24576
s_nop 0
buffer_load_dwordx4 v4, s[24:27], s40 offen lds
s_add_u32 s40, s47, 358400
s_add_u32 m0, s46, 25600
s_nop 0
buffer_load_dwordx4 v4, s[24:27], s40 offen lds
s_add_u32 s40, s47, 372736
s_add_u32 m0, s46, 26624
s_nop 0
buffer_load_dwordx4 v4, s[24:27], s40 offen lds
s_add_u32 s40, s47, 387072
s_add_u32 m0, s46, 27648
s_nop 0
buffer_load_dwordx4 v4, s[24:27], s40 offen lds
s_waitcnt vmcnt(0)
ds_read_b64_tr_b16 a[0:1], v5 offset:0
ds_read_b64_tr_b16 a[2:3], v5 offset:256
ds_read_b64_tr_b16 a[4:5], v5 offset:2048
ds_read_b64_tr_b16 a[6:7], v5 offset:2304
ds_read_b64_tr_b16 a[8:9], v5 offset:4096
ds_read_b64_tr_b16 a[10:11], v5 offset:4352
ds_read_b64_tr_b16 a[12:13], v5 offset:6144
ds_read_b64_tr_b16 a[14:15], v5 offset:6400
ds_read_b64_tr_b16 a[16:17], v5 offset:8192
ds_read_b64_tr_b16 a[18:19], v5 offset:8448
ds_read_b64_tr_b16 a[20:21], v5 offset:10240
ds_read_b64_tr_b16 a[22:23], v5 offset:10496
ds_read_b64_tr_b16 a[24:25], v5 offset:12288
ds_read_b64_tr_b16 a[26:27], v5 offset:12544
ds_read_b64_tr_b16 a[28:29], v5 offset:14336
ds_read_b64_tr_b16 a[30:31], v5 offset:14592
ds_read_b64_tr_b16 a[32:33], v5 offset:16384
ds_read_b64_tr_b16 a[34:35], v5 offset:16640
ds_read_b64_tr_b16 a[36:37], v5 offset:18432
ds_read_b64_tr_b16 a[38:39], v5 offset:18688
ds_read_b64_tr_b16 a[40:41], v5 offset:20480
ds_read_b64_tr_b16 a[42:43], v5 offset:20736
ds_read_b64_tr_b16 a[44:45], v5 offset:22528
ds_read_b64_tr_b16 a[46:47], v5 offset:22784
ds_read_b64_tr_b16 a[48:49], v5 offset:24576
ds_read_b64_tr_b16 a[50:51], v5 offset:24832
ds_read_b64_tr_b16 a[52:53], v5 offset:26624
ds_read_b64_tr_b16 a[54:55], v5 offset:26880
ds_read_b64_tr_b16 a[56:57], v5 offset:8
ds_read_b64_tr_b16 a[58:59], v5 offset:264
ds_read_b64_tr_b16 a[60:61], v5 offset:2056
ds_read_b64_tr_b16 a[62:63], v5 offset:2312
ds_read_b64_tr_b16 a[64:65], v5 offset:4104
ds_read_b64_tr_b16 a[66:67], v5 offset:4360
ds_read_b64_tr_b16 a[68:69], v5 offset:6152
ds_read_b64_tr_b16 a[70:71], v5 offset:6408
ds_read_b64_tr_b16 a[72:73], v5 offset:8200
ds_read_b64_tr_b16 a[74:75], v5 offset:8456
ds_read_b64_tr_b16 a[76:77], v5 offset:10248
ds_read_b64_tr_b16 a[78:79], v5 offset:10504
ds_read_b64_tr_b16 a[80:81], v5 offset:12296
ds_read_b64_tr_b16 a[82:83], v5 offset:12552
ds_read_b64_tr_b16 a[84:85], v5 offset:14344
ds_read_b64_tr_b16 a[86:87], v5 offset:14600
ds_read_b64_tr_b16 a[88:89], v5 offset:16392
ds_read_b64_tr_b16 a[90:91], v5 offset:16648
ds_read_b64_tr_b16 a[92:93], v5 offset:18440
ds_read_b64_tr_b16 a[94:95], v5 offset:18696
ds_read_b64_tr_b16 a[96:97], v5 offset:20488
ds_read_b64_tr_b16 a[98:99], v5 offset:20744
ds_read_b64_tr_b16 a[100:101], v5 offset:22536
ds_read_b64_tr_b16 a[102:103], v5 offset:22792
ds_read_b64_tr_b16 a[104:105], v5 offset:24584
ds_read_b64_tr_b16 a[106:107], v5 offset:24840
ds_read_b64_tr_b16 a[108:109], v5 offset:26632
ds_read_b64_tr_b16 a[110:111], v5 offset:26888
s_waitcnt lgkmcnt(0)
s_add_u32 s40, s47, 64
s_add_u32 m0, s46, 0
s_nop 0
buffer_load_dwordx4 v4, s[24:27], s40 offen lds
s_add_u32 s40, s47, 14400
s_add_u32 m0, s46, 1024
s_nop 0
buffer_load_dwordx4 v4, s[24:27], s40 offen lds
s_add_u32 s40, s47, 28736
s_add_u32 m0, s46, 2048
s_nop 0
buffer_load_dwordx4 v4, s[24:27], s40 offen lds
s_add_u32 s40, s47, 43072
s_add_u32 m0, s46, 3072
s_nop 0
buffer_load_dwordx4 v4, s[24:27], s40 offen lds
s_add_u32 s40, s47, 57408
s_add_u32 m0, s46, 4096
s_nop 0
buffer_load_dwordx4 v4, s[24:27], s40 offen lds
s_add_u32 s40, s47, 71744
s_add_u32 m0, s46, 5120
s_nop 0
buffer_load_dwordx4 v4, s[24:27], s40 offen lds
s_add_u32 s40, s47, 86080
s_add_u32 m0, s46, 6144
s_nop 0
buffer_load_dwordx4 v4, s[24:27], s40 offen lds
s_add_u32 s40, s47, 100416
s_add_u32 m0, s46, 7168
s_nop 0
buffer_load_dwordx4 v4, s[24:27], s40 offen lds
s_add_u32 s40, s47, 114752
s_add_u32 m0, s46, 8192
s_nop 0
buffer_load_dwordx4 v4, s[24:27], s40 offen lds
s_add_u32 s40, s47, 129088
s_add_u32 m0, s46, 9216
s_nop 0
buffer_load_dwordx4 v4, s[24:27], s40 offen lds
s_add_u32 s40, s47, 143424
s_add_u32 m0, s46, 10240
s_nop 0
buffer_load_dwordx4 v4, s[24:27], s40 offen lds
s_add_u32 s40, s47, 157760
s_add_u32 m0, s46, 11264
s_nop 0
buffer_load_dwordx4 v4, s[24:27], s40 offen lds
s_add_u32 s40, s47, 172096
s_add_u32 m0, s46, 12288
s_nop 0
buffer_load_dwordx4 v4, s[24:27], s40 offen lds
s_add_u32 s40, s47, 186432
s_add_u32 m0, s46, 13312
s_nop 0
buffer_load_dwordx4 v4, s[24:27], s40 offen lds
s_add_u32 s40, s47, 200768
s_add_u32 m0, s46, 14336
s_nop 0
buffer_load_dwordx4 v4, s[24:27], s40 offen lds
s_add_u32 s40, s47, 215104
s_add_u32 m0, s46, 15360
s_nop 0
buffer_load_dwordx4 v4, s[24:27], s40 offen lds
s_add_u32 s40, s47, 229440
s_add_u32 m0, s46, 16384
s_nop 0
buffer_load_dwordx4 v4, s[24:27], s40 offen lds
s_add_u32 s40, s47, 243776
s_add_u32 m0, s46, 17408
s_nop 0
buffer_load_dwordx4 v4, s[24:27], s40 offen lds
s_add_u32 s40, s47, 258112
s_add_u32 m0, s46, 18432
s_nop 0
buffer_load_dwordx4 v4, s[24:27], s40 offen lds
s_add_u32 s40, s47, 272448
s_add_u32 m0, s46, 19456
s_nop 0
buffer_load_dwordx4 v4, s[24:27], s40 offen lds
s_add_u32 s40, s47, 286784
s_add_u32 m0, s46, 20480
s_nop 0
buffer_load_dwordx4 v4, s[24:27], s40 offen lds
s_add_u32 s40, s47, 301120
s_add_u32 m0, s46, 21504
s_nop 0
buffer_load_dwordx4 v4, s[24:27], s40 offen lds
s_add_u32 s40, s47, 315456
s_add_u32 m0, s46, 22528
s_nop 0
buffer_load_dwordx4 v4, s[24:27], s40 offen lds
s_add_u32 s40, s47, 329792
s_add_u32 m0, s46, 23552
s_nop 0
buffer_load_dwordx4 v4, s[24:27], s40 offen lds
s_add_u32 s40, s47, 344128
s_add_u32 m0, s46, 24576
s_nop 0
buffer_load_dwordx4 v4, s[24:27], s40 offen lds
s_add_u32 s40, s47, 358464
s_add_u32 m0, s46, 25600
s_nop 0
buffer_load_dwordx4 v4, s[24:27], s40 offen lds
s_add_u32 s40, s47, 372800
s_add_u32 m0, s46, 26624
s_nop 0
buffer_load_dwordx4 v4, s[24:27], s40 offen lds
s_add_u32 s40, s47, 387136
s_add_u32 m0, s46, 27648
s_nop 0
buffer_load_dwordx4 v4, s[24:27], s40 offen lds
s_waitcnt vmcnt(0)
ds_read_b64_tr_b16 a[112:113], v5 offset:0
ds_read_b64_tr_b16 a[114:115], v5 offset:256
ds_read_b64_tr_b16 a[116:117], v5 offset:2048
ds_read_b64_tr_b16 a[118:119], v5 offset:2304
ds_read_b64_tr_b16 a[120:121], v5 offset:4096
ds_read_b64_tr_b16 a[122:123], v5 offset:4352
ds_read_b64_tr_b16 a[124:125], v5 offset:6144
ds_read_b64_tr_b16 a[126:127], v5 offset:6400
ds_read_b64_tr_b16 a[128:129], v5 offset:8192
ds_read_b64_tr_b16 a[130:131], v5 offset:8448
ds_read_b64_tr_b16 a[132:133], v5 offset:10240
ds_read_b64_tr_b16 a[134:135], v5 offset:10496
ds_read_b64_tr_b16 a[136:137], v5 offset:12288
ds_read_b64_tr_b16 a[138:139], v5 offset:12544
ds_read_b64_tr_b16 a[140:141], v5 offset:14336
ds_read_b64_tr_b16 a[142:143], v5 offset:14592
ds_read_b64_tr_b16 a[144:145], v5 offset:16384
ds_read_b64_tr_b16 a[146:147], v5 offset:16640
ds_read_b64_tr_b16 a[148:149], v5 offset:18432
ds_read_b64_tr_b16 a[150:151], v5 offset:18688
ds_read_b64_tr_b16 a[152:153], v5 offset:20480
ds_read_b64_tr_b16 a[154:155], v5 offset:20736
ds_read_b64_tr_b16 a[156:157], v5 offset:22528
ds_read_b64_tr_b16 a[158:159], v5 offset:22784
ds_read_b64_tr_b16 a[160:161], v5 offset:24576
ds_read_b64_tr_b16 a[162:163], v5 offset:24832
ds_read_b64_tr_b16 a[164:165], v5 offset:26624
ds_read_b64_tr_b16 a[166:167], v5 offset:26880
ds_read_b64_tr_b16 a[168:169], v5 offset:8
ds_read_b64_tr_b16 a[170:171], v5 offset:264
ds_read_b64_tr_b16 a[172:173], v5 offset:2056
ds_read_b64_tr_b16 a[174:175], v5 offset:2312
ds_read_b64_tr_b16 a[176:177], v5 offset:4104
ds_read_b64_tr_b16 a[178:179], v5 offset:4360
ds_read_b64_tr_b16 a[180:181], v5 offset:6152
ds_read_b64_tr_b16 a[182:183], v5 offset:6408
ds_read_b64_tr_b16 a[184:185], v5 offset:8200
ds_read_b64_tr_b16 a[186:187], v5 offset:8456
ds_read_b64_tr_b16 a[188:189], v5 offset:10248
ds_read_b64_tr_b16 a[190:191], v5 offset:10504
ds_read_b64_tr_b16 a[192:193], v5 offset:12296
ds_read_b64_tr_b16 a[194:195], v5 offset:12552
ds_read_b64_tr_b16 a[196:197], v5 offset:14344
ds_read_b64_tr_b16 a[198:199], v5 offset:14600
ds_read_b64_tr_b16 a[200:201], v5 offset:16392
ds_read_b64_tr_b16 a[202:203], v5 offset:16648
ds_read_b64_tr_b16 a[204:205], v5 offset:18440
ds_read_b64_tr_b16 a[206:207], v5 offset:18696
ds_read_b64_tr_b16 a[208:209], v5 offset:20488
ds_read_b64_tr_b16 a[210:211], v5 offset:20744
ds_read_b64_tr_b16 a[212:213], v5 offset:22536
ds_read_b64_tr_b16 a[214:215], v5 offset:22792
ds_read_b64_tr_b16 a[216:217], v5 offset:24584
ds_read_b64_tr_b16 a[218:219], v5 offset:24840
ds_read_b64_tr_b16 a[220:221], v5 offset:26632
ds_read_b64_tr_b16 a[222:223], v5 offset:26888
s_waitcnt lgkmcnt(0)
s_mul_i32 s60, s38, 7340032
s_add_u32 s60, s60, 102498304
s_mul_i32 s61, s38, 3670016
s_add_u32 s61, s61, 14680064
s_mul_i32 s40, s44, 57344
s_add_u32 s60, s60, s40
s_mul_i32 s40, s32, 14336
s_add_u32 s60, s60, s40
s_mov_b32 s42, s32
s_mul_i32 s46, s45, 2
s_add_u32 s46, s46, s42
s_cmp_lt_u32 s42, 2
s_cselect_b32 s74, 1, 0
s_cmp_lt_u32 s46, 14
s_cselect_b32 s74, s74, 0
s_min_u32 s46, s46, 13
s_mul_i32 s40, s44, 14
s_add_u32 s40, s40, s46
s_lshl_b32 s40, s40, 10
s_add_u32 s61, s61, s40
s_add_u32 s62, s40, 16515072
s_mul_i32 s64, s44, 14336
s_lshl_b32 s41, s46, 6
s_add_u32 s64, s64, s41
s_lshl_b32 s63, s46, 7
s_mul_i32 s41, s44, 1792
s_add_u32 s63, s63, s41
s_add_u32 s63, s63, 119128064
s_mul_i32 s40, s32, 4096
v_add_u32 v6, s40, v1
s_lshl_b32 s40, s42, 11
v_add_u32 v7, s40, v1
v_and_b32 v8, 15, v0
v_lshlrev_b32 v3, 3, v8
v_mul_u32_u24 v104, 896, v8
v_lshl_add_u32 v104, v10, 4, v104
v_lshlrev_b32 v9, 7, v0
s_lshl2_add_u32 s40, s59, s32
s_mul_i32 s40, s40, 24576
s_mul_i32 s41, s38, 7340032
s_add_u32 s41, s41, 102498304
s_add_u32 s40, s40, s41
s_add_u32 s41, s40, 8192
buffer_load_dword v10, v9, s[8:11], s40 offen sc1
buffer_load_dword v10, v9, s[8:11], s41 offen sc1
s_add_u32 s41, s41, 8192
buffer_load_dword v10, v9, s[8:11], s41 offen sc1
s_mov_b32 s69, s60
s_cmp_lg_u32 s38, 0
s_cbranch_scc1 Lfa_211
s_cmp_lg_u32 s74, 0
s_cselect_b32 s46, s62, 2146435072
s_cselect_b32 s47, s63, 2146435072
v_mov_b32 v8, -1
v_mov_b32 v9, -1
v_mov_b32 v10, -1
v_mov_b32 v11, -1
s_mov_b32 s40, 0
s_mov_b32 s41, 0
s_mov_b32 s42, 64
Lar_212:
s_add_u32 s43, s46, s40
buffer_store_dwordx4 v[8:11], v1, s[8:11], s43 offen sc1
s_add_u32 s43, s47, s41
buffer_store_dwordx2 v[8:9], v3, s[8:11], s43 offen sc1
s_waitcnt vmcnt(32)
s_add_u32 s40, s40, 28672
s_add_u32 s41, s41, 4096
s_sub_u32 s42, s42, 1
s_cmp_lg_u32 s42, 0
s_cbranch_scc1 Lar_212
s_waitcnt vmcnt(0)
s_barrier
s_lshl_b32 s40, s38, 13
s_lshl_b32 s41, s59, 7
s_add_u32 s40, s40, s41
s_add_u32 s40, s40, 118554624
s_cmp_eq_u32 s32, 0
s_cselect_b32 s40, s40, 2146435072
v_mov_b32 v8, 1
buffer_store_dword v8, off, s[8:11], s40 sc1
Lfa_211:
s_lshl_b32 s100, s38, 13
s_add_u32 s100, s100, 118505472
s_lshl_b32 s70, s59, 7
s_add_u32 s70, s70, s100
s_add_u32 s70, s70, 16384
s_mov_b32 s75, 2146435072
s_cmp_eq_u32 s32, 3
s_cselect_b32 s70, s70, s75
v_mov_b32 v0, 126464
v_mov_b32 v8, 0
v_mov_b32 v9, 0
v_mov_b32 v10, 0
v_mov_b32 v11, 0
ds_write_b128 v0, v[8:11]
ds_write_b128 v0, v[8:11] offset:16
s_mov_b32 s96, 126464
s_mov_b32 s94, 1
s_mov_b32 s93, 1
v_mov_b32 v15, 1
s_waitcnt lgkmcnt(0)
s_barrier
LF2_loop:
s_cmp_lg_u32 s97, 0
s_cbranch_scc1 LF2_go
s_cmp_lg_u32 s32, 3
s_cbranch_scc1 Lpq_217
s_branch Lpg_214
Lpf_213:
s_sleep 1
Lpg_214:
buffer_load_dword v124, v2, s[8:11], s100 offen sc1
s_sub_u32 s36, s36, 1
s_cbranch_scc1 L_timeout_23
s_waitcnt vmcnt(0)
v_cmp_gt_u32 vcc, s94, v124
s_cmp_eq_u32 s98, 0
s_cbranch_scc1 Lpp_218
s_waitcnt vmcnt(0)
v_mov_b32 v124, s96
s_mov_b64 exec, 1
ds_add_rtn_u32 v124, v124, v15 offset:0
s_mov_b64 exec, -1
s_waitcnt lgkmcnt(0)
v_readfirstlane_b32 s45, v124
s_nop 0
s_and_b32 s45, s45, s93
s_cmp_lg_u32 s45, s93
s_cbranch_scc1 Lpn_219
buffer_store_dword v15, off, s[8:11], s99 sc1
Lpn_219:
s_mov_b32 s98, 0
Lpp_218:
s_cbranch_vccnz Lpf_213
v_mov_b32 v124, s94
ds_write_b32 v0, v124 offset:4
s_branch Lpe_216
Lpq_217:
s_cmp_eq_u32 s98, 0
s_cbranch_scc1 Lpp_220
s_waitcnt vmcnt(0)
v_mov_b32 v124, s96
s_mov_b64 exec, 1
ds_add_rtn_u32 v124, v124, v15 offset:0
s_mov_b64 exec, -1
s_waitcnt lgkmcnt(0)
v_readfirstlane_b32 s45, v124
s_nop 0
s_and_b32 s45, s45, s93
s_cmp_lg_u32 s45, s93
s_cbranch_scc1 Lpn_221
buffer_store_dword v15, off, s[8:11], s99 sc1
Lpn_221:
s_mov_b32 s98, 0
Lpp_220:
Lph_215:
s_sleep 1
ds_read_b32 v124, v0 offset:4
s_sub_u32 s92, s92, 1
s_cbranch_scc1 L_timeout_23
s_waitcnt lgkmcnt(0)
v_cmp_gt_u32 vcc, s94, v124
s_nop 0
s_cbranch_vccnz Lph_215
Lpe_216:
s_add_u32 s42, s60, 0
buffer_load_dwordx4 v[40:43], v1, s[8:11], s42 offen offset:0 sc1
buffer_load_dwordx4 v[44:47], v1, s[8:11], s42 offen offset:1024 sc1
buffer_load_dwordx4 v[48:51], v1, s[8:11], s42 offen offset:2048 sc1
buffer_load_dwordx4 v[52:55], v1, s[8:11], s42 offen offset:3072 sc1
buffer_load_dword v106, off, s[8:11], s75 sc1
buffer_load_dword v106, off, s[8:11], s75 sc1
LF2_go:
v_mov_b32 v105, s94
s_add_u32 s94, s94, 1
s_waitcnt vmcnt(5)
v_mfma_f32_16x16x32_bf16 v[16:19], a[0:3], v[40:43], 0
s_add_u32 s42, s60, 4096
buffer_load_dwordx4 v[56:59], v1, s[8:11], s42 offen offset:0 sc1
v_mfma_f32_16x16x32_bf16 v[20:23], a[56:59], v[40:43], 0
v_mfma_f32_16x16x32_bf16 v[24:27], a[112:115], v[40:43], 0
v_mfma_f32_16x16x32_bf16 v[28:31], a[168:171], v[40:43], 0
s_waitcnt vmcnt(5)
v_mfma_f32_16x16x32_bf16 v[16:19], a[4:7], v[44:47], v[16:19]
buffer_load_dwordx4 v[60:63], v1, s[8:11], s42 offen offset:1024 sc1
v_mfma_f32_16x16x32_bf16 v[20:23], a[60:63], v[44:47], v[20:23]
v_mfma_f32_16x16x32_bf16 v[24:27], a[116:119], v[44:47], v[24:27]
v_mfma_f32_16x16x32_bf16 v[28:31], a[172:175], v[44:47], v[28:31]
s_waitcnt vmcnt(5)
v_mfma_f32_16x16x32_bf16 v[16:19], a[8:11], v[48:51], v[16:19]
buffer_load_dwordx4 v[40:43], v1, s[8:11], s42 offen offset:2048 sc1
v_mfma_f32_16x16x32_bf16 v[20:23], a[64:67], v[48:51], v[20:23]
v_mfma_f32_16x16x32_bf16 v[24:27], a[120:123], v[48:51], v[24:27]
v_mfma_f32_16x16x32_bf16 v[28:31], a[176:179], v[48:51], v[28:31]
s_waitcnt vmcnt(5)
v_mfma_f32_16x16x32_bf16 v[16:19], a[12:15], v[52:55], v[16:19]
buffer_load_dwordx4 v[44:47], v1, s[8:11], s42 offen offset:3072 sc1
v_mfma_f32_16x16x32_bf16 v[20:23], a[68:71], v[52:55], v[20:23]
v_mfma_f32_16x16x32_bf16 v[24:27], a[124:127], v[52:55], v[24:27]
v_mfma_f32_16x16x32_bf16 v[28:31], a[180:183], v[52:55], v[28:31]
s_waitcnt vmcnt(3)
v_mfma_f32_16x16x32_bf16 v[16:19], a[16:19], v[56:59], v[16:19]
s_add_u32 s42, s60, 8192
buffer_load_dwordx4 v[48:51], v1, s[8:11], s42 offen offset:0 sc1
v_mfma_f32_16x16x32_bf16 v[20:23], a[72:75], v[56:59], v[20:23]
v_mfma_f32_16x16x32_bf16 v[24:27], a[128:131], v[56:59], v[24:27]
v_mfma_f32_16x16x32_bf16 v[28:31], a[184:187], v[56:59], v[28:31]
s_waitcnt vmcnt(3)
v_mfma_f32_16x16x32_bf16 v[16:19], a[20:23], v[60:63], v[16:19]
buffer_load_dwordx4 v[52:55], v1, s[8:11], s42 offen offset:1024 sc1
v_mfma_f32_16x16x32_bf16 v[20:23], a[76:79], v[60:63], v[20:23]
v_mfma_f32_16x16x32_bf16 v[24:27], a[132:135], v[60:63], v[24:27]
v_mfma_f32_16x16x32_bf16 v[28:31], a[188:191], v[60:63], v[28:31]
s_waitcnt vmcnt(3)
v_mfma_f32_16x16x32_bf16 v[16:19], a[24:27], v[40:43], v[16:19]
buffer_load_dwordx4 v[56:59], v1, s[8:11], s42 offen offset:2048 sc1
v_mfma_f32_16x16x32_bf16 v[20:23], a[80:83], v[40:43], v[20:23]
v_mfma_f32_16x16x32_bf16 v[24:27], a[136:139], v[40:43], v[24:27]
v_mfma_f32_16x16x32_bf16 v[28:31], a[192:195], v[40:43], v[28:31]
s_waitcnt vmcnt(3)
v_mfma_f32_16x16x32_bf16 v[16:19], a[28:31], v[44:47], v[16:19]
buffer_load_dwordx4 v[60:63], v1, s[8:11], s42 offen offset:3072 sc1
v_mfma_f32_16x16x32_bf16 v[20:23], a[84:87], v[44:47], v[20:23]
v_mfma_f32_16x16x32_bf16 v[24:27], a[140:143], v[44:47], v[24:27]
buffer_load_dword v124, v2, s[8:11], s100 offen sc1
v_mfma_f32_16x16x32_bf16 v[28:31], a[196:199], v[44:47], v[28:31]
s_waitcnt vmcnt(4)
v_mfma_f32_16x16x32_bf16 v[16:19], a[32:35], v[48:51], v[16:19]
s_add_u32 s42, s60, 12288
buffer_load_dwordx4 v[40:43], v1, s[8:11], s42 offen offset:0 sc1
v_mfma_f32_16x16x32_bf16 v[20:23], a[88:91], v[48:51], v[20:23]
v_mfma_f32_16x16x32_bf16 v[24:27], a[144:147], v[48:51], v[24:27]
v_mfma_f32_16x16x32_bf16 v[28:31], a[200:203], v[48:51], v[28:31]
s_waitcnt vmcnt(4)
v_mfma_f32_16x16x32_bf16 v[16:19], a[36:39], v[52:55], v[16:19]
buffer_load_dwordx4 v[44:47], v1, s[8:11], s42 offen offset:1024 sc1
v_mfma_f32_16x16x32_bf16 v[20:23], a[92:95], v[52:55], v[20:23]
v_mfma_f32_16x16x32_bf16 v[24:27], a[148:151], v[52:55], v[24:27]
v_mfma_f32_16x16x32_bf16 v[28:31], a[204:207], v[52:55], v[28:31]
s_waitcnt vmcnt(4)
v_mfma_f32_16x16x32_bf16 v[16:19], a[40:43], v[56:59], v[16:19]
buffer_load_dwordx4 v[96:99], v1, s[8:11], s61 offen sc1
v_mfma_f32_16x16x32_bf16 v[20:23], a[96:99], v[56:59], v[20:23]
v_mfma_f32_16x16x32_bf16 v[24:27], a[152:155], v[56:59], v[24:27]
v_mfma_f32_16x16x32_bf16 v[28:31], a[208:211], v[56:59], v[28:31]
s_waitcnt vmcnt(4)
v_mfma_f32_16x16x32_bf16 v[16:19], a[44:47], v[60:63], v[16:19]
v_mfma_f32_16x16x32_bf16 v[20:23], a[100:103], v[60:63], v[20:23]
v_mfma_f32_16x16x32_bf16 v[24:27], a[156:159], v[60:63], v[24:27]
v_mfma_f32_16x16x32_bf16 v[28:31], a[212:215], v[60:63], v[28:31]
s_waitcnt vmcnt(2)
v_mfma_f32_16x16x32_bf16 v[16:19], a[48:51], v[40:43], v[16:19]
v_mfma_f32_16x16x32_bf16 v[20:23], a[104:107], v[40:43], v[20:23]
v_mfma_f32_16x16x32_bf16 v[24:27], a[160:163], v[40:43], v[24:27]
v_mfma_f32_16x16x32_bf16 v[28:31], a[216:219], v[40:43], v[28:31]
s_waitcnt vmcnt(1)
v_mfma_f32_16x16x32_bf16 v[16:19], a[52:55], v[44:47], v[16:19]
v_mfma_f32_16x16x32_bf16 v[20:23], a[108:111], v[44:47], v[20:23]
v_mfma_f32_16x16x32_bf16 v[24:27], a[164:167], v[44:47], v[24:27]
v_mfma_f32_16x16x32_bf16 v[28:31], a[220:223], v[44:47], v[28:31]
v_cmp_gt_u32 vcc, s94, v124
s_add_u32 s42, s37, 1
s_and_b32 s42, s42, 7
s_mul_i32 s60, s42, 114688
s_add_u32 s60, s60, s69
s_cmp_eq_u64 vcc, 0
s_cselect_b32 s97, 1, 0
s_cmp_lg_u32 s97, 0
s_cselect_b32 s42, s60, 2146435072
s_cselect_b32 s44, 4, 24
buffer_load_dwordx4 v[40:43], v1, s[8:11], s42 offen offset:0 sc1
buffer_load_dwordx4 v[44:47], v1, s[8:11], s42 offen offset:1024 sc1
buffer_load_dwordx4 v[48:51], v1, s[8:11], s42 offen offset:2048 sc1
buffer_load_dwordx4 v[52:55], v1, s[8:11], s42 offen offset:3072 sc1
v_add_u32 v106, s44, v0
v_mov_b32 v107, s94
ds_write_b32 v106, v107
ds_write_b128 v6, v[16:19] offset:0
ds_write_b128 v6, v[20:23] offset:1024
ds_write_b128 v6, v[24:27] offset:2048
ds_write_b128 v6, v[28:31] offset:3072
v_xor_b32 v6, 32768, v6
s_waitcnt lgkmcnt(0)
s_barrier
s_cmp_eq_u32 s74, 0
s_cbranch_scc1 LF2_w23
ds_read_b128 v[64:67], v7 offset:0
ds_read_b128 v[68:71], v7 offset:1024
ds_read_b128 v[72:75], v7 offset:4096
ds_read_b128 v[76:79], v7 offset:5120
ds_read_b128 v[80:83], v7 offset:8192
ds_read_b128 v[84:87], v7 offset:9216
ds_read_b128 v[88:91], v7 offset:12288
ds_read_b128 v[92:95], v7 offset:13312
v_xor_b32 v7, 32768, v7
s_waitcnt vmcnt(4) lgkmcnt(0)
v_pk_add_f32 v[64:65], v[64:65], v[72:73]
v_pk_add_f32 v[80:81], v[80:81], v[88:89]
v_pk_add_f32 v[66:67], v[66:67], v[74:75]
v_pk_add_f32 v[82:83], v[82:83], v[90:91]
v_pk_add_f32 v[68:69], v[68:69], v[76:77]
v_pk_add_f32 v[84:85], v[84:85], v[92:93]
v_pk_add_f32 v[70:71], v[70:71], v[78:79]
v_pk_add_f32 v[86:87], v[86:87], v[94:95]
v_pk_add_f32 v[64:65], v[64:65], v[80:81]
v_pk_add_f32 v[66:67], v[66:67], v[82:83]
v_pk_add_f32 v[68:69], v[68:69], v[84:85]
v_pk_add_f32 v[70:71], v[70:71], v[86:87]
v_lshlrev_b32 v8, 16, v96
v_and_b32 v9, 0xffff0000, v96
v_add_f32 v8, v8, v64
v_add_f32 v9, v9, v65
v_cvt_pk_bf16_f32 v100, v8, v9
v_lshlrev_b32 v8, 16, v97
v_and_b32 v9, 0xffff0000, v97
v_add_f32 v8, v8, v66
v_add_f32 v9, v9, v67
v_cvt_pk_bf16_f32 v101, v8, v9
v_lshlrev_b32 v8, 16, v98
v_and_b32 v9, 0xffff0000, v98
v_add_f32 v8, v8, v68
v_add_f32 v9, v9, v69
v_cvt_pk_bf16_f32 v102, v8, v9
v_lshlrev_b32 v8, 16, v99
v_and_b32 v9, 0xffff0000, v99
v_add_f32 v8, v8, v70
v_add_f32 v9, v9, v71
v_cvt_pk_bf16_f32 v103, v8, v9
v_min_u32 v100, -2, v100
v_min_u32 v101, -2, v101
v_min_u32 v102, -2, v102
v_min_u32 v103, -2, v103
s_cmp_eq_u32 s38, 0
s_cbranch_scc1 LF2_mid
buffer_store_dwordx4 v[100:103], v104, s[28:31], s64 offen sc1
buffer_load_dword v106, off, s[8:11], s75 sc1
s_branch LF2_post
LF2_mid:
buffer_store_dwordx4 v[100:103], v1, s[8:11], s62 offen sc1
v_lshlrev_b32 v8, 16, v100
v_and_b32 v9, 0xffff0000, v100
v_add_f32 v12, v8, v9
v_mul_f32 v13, v8, v8
v_fmac_f32 v13, v9, v9
v_lshlrev_b32 v8, 16, v101
v_and_b32 v9, 0xffff0000, v101
v_add_f32 v12, v12, v8
v_fmac_f32 v13, v8, v8
v_add_f32 v12, v12, v9
v_fmac_f32 v13, v9, v9
v_lshlrev_b32 v8, 16, v102
v_and_b32 v9, 0xffff0000, v102
v_add_f32 v12, v12, v8
v_fmac_f32 v13, v8, v8
v_add_f32 v12, v12, v9
v_fmac_f32 v13, v9, v9
v_lshlrev_b32 v8, 16, v103
v_and_b32 v9, 0xffff0000, v103
v_add_f32 v12, v12, v8
v_fmac_f32 v13, v8, v8
v_add_f32 v12, v12, v9
v_fmac_f32 v13, v9, v9
v_mov_b32 v8, v12
v_mov_b32 v9, v13
s_nop 0
v_permlane16_swap_b32 v12, v8
v_permlane16_swap_b32 v13, v9
v_add_f32 v12, v12, v8
v_add_f32 v13, v13, v9
v_mov_b32 v8, v12
v_mov_b32 v9, v13
s_nop 0
v_permlane32_swap_b32 v12, v8
v_permlane32_swap_b32 v13, v9
v_add_f32 v12, v12, v8
v_add_f32 v13, v13, v9
v_min_u32 v12, -2, v12
v_min_u32 v13, -2, v13
buffer_store_dwordx2 v[12:13], v3, s[8:11], s63 offen sc1
LF2_post:
s_add_u32 s61, s61, 28672
s_add_u32 s62, s62, 28672
s_add_u32 s63, s63, 4096
s_add_u32 s64, s64, 28672
s_add_u32 s37, s37, 1
s_cmp_lt_u32 s37, 64
s_cbranch_scc1 LF2_loop
s_branch L_done
LF2_w23:
s_or_b32 s45, s70, s66
buffer_store_dword v105, off, s[8:11], s45
s_or_b32 s45, s70, s67
buffer_store_dword v105, off, s[8:11], s45 sc1
s_branch LF2_post
L_code_end:
.section .rodata,"a"
.p2align 6
.amdhsa_kernel interleave_layers__memory_aug_recurrent_mem_tr__swiglu_ffn__prompt_kernel
  .amdhsa_next_free_vgpr 512
  .amdhsa_next_free_sgpr 102
  .amdhsa_accum_offset 256
  .amdhsa_group_segment_fixed_size 0
  .amdhsa_kernarg_size 112
  .amdhsa_user_sgpr_count 2
  .amdhsa_user_sgpr_kernarg_segment_ptr 1
  .amdhsa_system_sgpr_workgroup_id_x 1
  .amdhsa_float_denorm_mode_32 3
  .amdhsa_float_denorm_mode_16_64 3
.end_amdhsa_kernel
```
